```python
import torch

def _softmax(x, axis=-1):
    return torch.softmax(x, dim=axis)
def _gelu(x):
    return torch.nn.functional.gelu(x, approximate="tanh")
def _silu(x):
    return torch.nn.functional.silu(x)
def _sigmoid(x):
    return torch.sigmoid(x)
def _layernorm(x, axis=-1, eps=1e-5):
    m = x.mean(dim=axis, keepdim=True)
    v = x.var(dim=axis, keepdim=True, unbiased=False)
    return (x - m) / torch.sqrt(v + eps)
def _scatter_add(tgt, idx, src, axis=0):
    return tgt.clone().index_add_(axis, idx, src)
def _segment_sum(src, seg, n):
    out = torch.zeros((n,) + src.shape[1:], dtype=src.dtype)
    return out.index_add_(0, seg, src)
def _pad(x, pw):
    flat = tuple(v for pair in reversed(pw) for v in pair)
    return torch.nn.functional.pad(x, flat)

kernel_name = 'gated_mix__mha_block__glu_gated_reglu__prompt'

def setup_inputs():

    _w = (lambda a: (lambda t: t.to(torch.bfloat16) if t.is_floating_point() else t)(torch.as_tensor(a)))
    def _A_setup():
        B, S, D, H = 1, 2048, 448, 16
        return {
            "x": _w((lambda *s: torch.randn(*s, dtype=torch.bfloat16) * 0.05)(B, S, D)),
            "wqkv": _w((lambda *s: torch.randn(*s, dtype=torch.bfloat16) * 0.8)(D, 3 * D)),
            "wo": _w((lambda *s: torch.randn(*s, dtype=torch.bfloat16) * 0.05)(D, D)),
        }
    _A_in = _A_setup()

    def _B_setup():
        B, S, D, F = 1, 2048, 448, 1792
        return {
            "x": _w((lambda *s: torch.randn(*s, dtype=torch.bfloat16) * 0.05)(B, S, D)),
            "W_gate": _w((lambda *s: torch.randn(*s, dtype=torch.bfloat16) * 1.6)(D, F) * (2.0 / D) ** 0.5),
            "W_up": _w((lambda *s: torch.randn(*s, dtype=torch.bfloat16) * 1.6)(D, F) * (2.0 / D) ** 0.5),
            "W_down": _w((lambda *s: torch.randn(*s, dtype=torch.bfloat16) * 1.6)(F, D) * (1.0 / F) ** 0.5),
        }
    _B_in = _B_setup()

    return {
        "A_x": _A_in["x"],
        "A_wqkv": _A_in["wqkv"],
        "A_wo": _A_in["wo"],
        "B_x": _B_in["x"],
        "B_W_gate": _B_in["W_gate"],
        "B_W_up": _B_in["W_up"],
        "B_W_down": _B_in["W_down"],
        "gate_w": _w((lambda *s: torch.randn(*s, dtype=torch.bfloat16) * 0.05)(448) * 16.0),
    }

def reference(A_x, A_wqkv, A_wo, B_x, B_W_gate, B_W_up, B_W_down, gate_w):
    def _A_ref(x, wqkv, wo):
        B, S, D = x.shape
        H = 16
        Dh = D // H
        qkv = (lambda x, *d: x.permute(*d))((x @ wqkv).reshape(B, S, 3, H, Dh), 2, 0, 3, 1, 4)
        q, k, v = qkv[0], qkv[1], qkv[2]
        scores = torch.einsum("bhqd,bhkd->bhqk", q, k) * (Dh ** -0.5)
        p = _softmax(scores, axis=-1)
        o = torch.einsum("bhqk,bhkd->bhqd", p, v)
        return (lambda x, *d: x.permute(*d))(o, 0, 2, 1, 3).reshape(B, S, D) @ wo

    def _B_ref(x, W_gate, W_up, W_down):
        gate = torch.einsum("bsd,df->bsf", x, W_gate)
        up = torch.einsum("bsd,df->bsf", x, W_up)
        gate = gate * (lambda x, dt: x.to(dt))(gate > 0, gate.dtype)
        h = gate * up
        return torch.einsum("bsf,fd->bsd", h, W_down)

    x = A_x
    g = _sigmoid((x * gate_w).sum(-1, keepdims=True))
    a = _A_ref(x, A_wqkv, A_wo)
    b = _B_ref(x, B_W_gate, B_W_up, B_W_down)
    return g * a + (1 - g) * b
```

```asm
; @launch grid=(256,1,1) block=(512,1,1) lds=163840
.amdgcn_target "amdgcn-amd-amdhsa--gfx950"
.text
.globl gated_mix__mha_block__glu_gated_reglu__prompt_kernel
.p2align 8
.type gated_mix__mha_block__glu_gated_reglu__prompt_kernel,@function
gated_mix__mha_block__glu_gated_reglu__prompt_kernel:
    s_cmp_ge_u32 s2, 256
    s_cbranch_scc1 L_exit
    s_load_dwordx4 s[76:79], s[0:1], 0
    v_lshrrev_b32 v12, 6, v0
    v_and_b32 v1, 63, v0
    v_readfirstlane_b32 s58, v12
    s_and_b32 s56, s2, 1
    s_lshl_b32 s56, s56, 3
    s_bfe_u32 s60, s2, 0x30003
    s_add_u32 s56, s56, s60
    s_bfe_u32 s57, s2, 0x20001
    s_lshr_b32 s60, s2, 6
    s_lshl_b32 s60, s60, 2
    s_add_u32 s57, s57, s60
    s_lshl_b32 s7, s57, 1
    s_sub_u32 s7, s7, 11
    s_cmp_le_u32 s57, 12
    s_cselect_b32 s7, s57, s7
    s_lshl_b32 s66, s7, 7
    s_mul_i32 s62, s56, 114688
    s_lshr_b32 s60, s57, 2
    s_lshl_b32 s60, s60, 1
    s_and_b32 s61, s56, 7
    s_add_u32 s60, s60, s61
    s_cmp_ge_u32 s60, 7
    s_cselect_b32 s61, 7, 0
    s_sub_u32 s60, s60, s61
    s_lshl_b32 s60, s60, 2
    s_mov_b32 s4, 0x6543210
    s_mov_b32 s5, 0x654321
    s_lshr_b64 s[4:5], s[4:5], s60
    s_mov_b32 s75, s4
    s_mov_b32 s10, 0x1c0000
    s_mov_b32 s11, 0x20000
    s_mov_b32 s14, 0x126000
    s_mov_b32 s15, 0x20000
    v_lshrrev_b32 v193, 3, v1
    v_and_b32 v194, 7, v1
    s_lshl_b32 s65, s58, 11
    s_lshl_b32 s55, s58, 12
    v_bfe_u32 v195, v1, 4, 1
    v_lshlrev_b32 v195, 2, v195
    v_xor_b32 v196, v195, v194
    s_lshl_b32 s60, s58, 4
    v_add_u32 v197, s60, v193
    v_mul_u32_u24 v202, 2688, v197
    v_lshl_add_u32 v202, v196, 4, v202
    v_lshrrev_b32 v195, 4, v1
    v_xor_b32 v195, v195, v194
    v_add_u32 v12, s60, v197
    v_mul_u32_u24 v12, 896, v12
    v_lshl_add_u32 v4, v195, 4, v12
    v_xor_b32 v195, 4, v195
    v_lshl_add_u32 v5, v195, 4, v12
    v_add_u32 v5, 7168, v5
    s_waitcnt lgkmcnt(0)
    s_mov_b32 s8, s76
    s_and_b32 s9, s77, 0xffff
    s_mov_b32 s12, s78
    s_and_b32 s13, s79, 0xffff
    s_load_dwordx8 s[80:87], s[0:1], 16
    s_load_dwordx8 s[88:95], s[0:1], 48
    s_load_dwordx2 s[96:97], s[0:1], 80
    s_cmp_ge_u32 s58, 4
    s_cbranch_scc1 L_nold
    s_add_u32 m0, s65, 114688
    s_bfe_u32 s61, s75, 0x40000
    s_mul_i32 s61, s61, 172032
    s_add_u32 s61, s61, s66
    buffer_load_dwordx4 v202, s[12:15], s61 offen lds
    s_add_u32 m0, s65, 115712
    s_add_u32 s61, s61, 21504
    buffer_load_dwordx4 v202, s[12:15], s61 offen lds
    s_add_u32 m0, s55, 0
    s_bfe_u32 s60, s75, 0x40000
    s_mul_i32 s60, s60, 128
    s_add_u32 s60, s60, s62
    buffer_load_dwordx4 v4, s[8:11], s60 offen lds
    s_add_u32 m0, s55, 1024
    s_nop 0
    buffer_load_dwordx4 v5, s[8:11], s60 offen lds
    s_add_u32 m0, s55, 2048
    s_add_u32 s60, s60, 14336
    buffer_load_dwordx4 v4, s[8:11], s60 offen lds
    s_add_u32 m0, s55, 3072
    s_nop 0
    buffer_load_dwordx4 v5, s[8:11], s60 offen lds
    s_add_u32 m0, s65, 122880
    s_bfe_u32 s61, s75, 0x40004
    s_mul_i32 s61, s61, 172032
    s_add_u32 s61, s61, s66
    buffer_load_dwordx4 v202, s[12:15], s61 offen lds
    s_add_u32 m0, s65, 123904
    s_add_u32 s61, s61, 21504
    buffer_load_dwordx4 v202, s[12:15], s61 offen lds
    s_add_u32 m0, s55, 16384
    s_bfe_u32 s60, s75, 0x40004
    s_mul_i32 s60, s60, 128
    s_add_u32 s60, s60, s62
    buffer_load_dwordx4 v4, s[8:11], s60 offen lds
    s_add_u32 m0, s55, 17408
    s_nop 0
    buffer_load_dwordx4 v5, s[8:11], s60 offen lds
    s_add_u32 m0, s55, 18432
    s_add_u32 s60, s60, 14336
    buffer_load_dwordx4 v4, s[8:11], s60 offen lds
    s_add_u32 m0, s55, 19456
    s_nop 0
    buffer_load_dwordx4 v5, s[8:11], s60 offen lds
L_nold:
    s_getpc_b64 s[4:5]
L_pc:
    v_cmp_le_u32 vcc, 448, v0
    s_cbranch_vccz L_nocp
    s_lshr_b32 s6, s2, 3
    s_lshl_b32 s6, s6, 11
    v_and_b32 v192, 15, v0
    v_lshlrev_b32 v192, 7, v192
    v_add_u32 v192, s6, v192
    v_min_u32 v192, L_code_end-L_pc-4, v192
    global_load_dword v203, v192, s[4:5]
L_nocp:
    s_waitcnt lgkmcnt(0)
    s_mov_b32 s16, s84
    s_and_b32 s17, s85, 0xffff
    s_mov_b32 s18, 0x188000
    s_mov_b32 s19, 0x20000
    s_mov_b32 s20, s86
    s_and_b32 s21, s87, 0xffff
    s_mov_b32 s22, 0x188000
    s_mov_b32 s23, 0x20000
    s_lshl_b32 s59, s58, 10
    s_lshr_b32 s64, s58, 2
    s_and_b32 s60, s58, 3
    s_lshl_b32 s63, s56, 2
    s_add_u32 s63, s63, s60
    v_mul_u32_u24 v201, 3584, v197
    v_lshl_add_u32 v201, v196, 4, v201
    s_lshl_b32 s60, s58, 3
    v_add_u32 v12, s60, v193
    v_mul_u32_u24 v2, 2688, v12
    v_lshl_add_u32 v2, v196, 4, v2
    v_mul_u32_u24 v3, 3584, v12
    v_lshl_add_u32 v3, v196, 4, v3
    v_lshlrev_b32 v11, 4, v1
    s_mov_b32 s32, s80
    s_and_b32 s33, s81, 0xffff
    s_mov_b32 s34, 0x62000
    s_mov_b32 s35, 0x20000
    s_mov_b32 s28, s88
    s_and_b32 s29, s89, 0xffff
    s_mov_b32 s30, 0x188000
    s_mov_b32 s31, 0x20000
    s_mov_b32 s40, s90
    s_and_b32 s41, s91, 0xffff
    s_mov_b32 s42, 0x380
    s_mov_b32 s43, 0x20000
    s_mov_b32 s36, s92
    s_and_b32 s37, s93, 0xffff
    s_mov_b32 s38, 0x1c0000
    s_mov_b32 s39, 0x20000
    s_mov_b32 s48, s94
    s_and_b32 s49, s95, 0xffff
    s_mov_b32 s50, 0x100
    s_mov_b32 s51, 0x20000
    s_mov_b32 s24, s96
    s_and_b32 s25, s97, 0xffff
    s_mov_b32 s26, 0x1200000
    s_mov_b32 s27, 0x20000
    s_mov_b32 s44, s96
    s_and_b32 s45, s97, 0xffff
    s_mov_b32 s46, 0x1200000
    s_mov_b32 s47, 0x20000
    v_mov_b32 v14, 0
    v_mov_b32 v240, 0
    v_mov_b32 v241, 0
    v_mov_b32 v242, 0
    v_mov_b32 v243, 0
    v_mov_b32 v244, 0
    v_mov_b32 v245, 0
    v_mov_b32 v246, 0
    v_mov_b32 v247, 0
    v_mov_b32 v248, 0
    v_mov_b32 v249, 0
    v_mov_b32 v250, 0
    s_or_b32 s60, s2, s58
    s_cmp_lg_u32 s60, 0
    s_cbranch_scc1 L_nn1
    s_memrealtime s[4:5]
    s_waitcnt lgkmcnt(0)
    s_or_b32 s4, s4, 1
    v_mov_b32 v200, s4
    s_mov_b64 exec, 1
    buffer_store_dword v200, v14, s[48:51], 0 offen sc1
    s_mov_b64 exec, -1
L_nn1:
    v_lshrrev_b32 v193, 5, v1
    v_bfe_u32 v194, v1, 2, 2
    v_lshl_add_u32 v195, v193, 3, v194
    v_lshlrev_b32 v6, 7, v195
    v_lshrrev_b32 v194, 1, v194
    v_xor_b32 v194, s64, v194
    v_lshl_add_u32 v6, v194, 6, v6
    v_bfe_u32 v194, v1, 4, 1
    v_lshl_add_u32 v6, v194, 5, v6
    v_and_b32 v194, 3, v1
    v_lshl_add_u32 v6, v194, 3, v6
    v_add_u32 v7, 0x10000, v6
    v_add_u32 v8, 0x20000, v6
    v_and_b32 v194, 31, v1
    s_and_b32 s60, s58, 3
    s_lshl_b32 s60, s60, 5
    v_add_u32 v195, s60, v194
    v_lshlrev_b32 v12, 7, v195
    v_bfe_u32 v13, v1, 1, 3
    v_xor_b32 v13, v13, v193
    v_xor_b32 v208, 0, v13
    v_lshl_add_u32 v208, v208, 4, v12
    v_xor_b32 v209, 2, v13
    v_lshl_add_u32 v209, v209, 4, v12
    v_xor_b32 v210, 4, v13
    v_lshl_add_u32 v210, v210, 4, v12
    v_xor_b32 v211, 6, v13
    v_lshl_add_u32 v211, v211, 4, v12
    s_lshl_b32 s60, s63, 5
    v_add_u32 v195, s60, v194
    v_lshlrev_b32 v9, 4, v195
    v_lshl_add_u32 v9, v193, 15, v9
    v_lshlrev_b32 v13, 2, v195
    v_mul_u32_u24 v10, 7168, v193
    v_lshl_add_u32 v10, v194, 4, v10
    v_xor_b32 v204, 64, v7
    v_xor_b32 v205, 64, v8
    s_cmp_eq_u32 s57, 12
    s_cbranch_scc1 L_B
    s_cmp_eq_u32 s57, 14
    s_cbranch_scc1 L_C
    s_cmp_gt_u32 s57, 12
    s_cbranch_scc1 L_D
    s_mov_b32 s7, s57
    s_lshl_b32 s66, s7, 7
    s_lshl_b32 s61, s7, 1
    s_lshl_b32 s70, s61, 17
    s_cmp_lt_u32 s7, 7
    s_cselect_b32 s74, 0x3e8b97f6, 1.0
    s_lshl_b32 s78, s61, 6
    s_add_u32 s78, s78, s63
    s_lshl_b32 s78, s78, 3
    s_add_u32 s78, s78, 15007744
    s_lshl_b32 s7, s57, 1
    s_add_u32 s7, s7, 0
    s_lshl_b32 s67, s7, 7
    s_lshl_b32 s61, s7, 1
    s_add_u32 s61, s61, s64
    s_lshl_b32 s71, s61, 11
    s_mul_i32 s60, s63, 147456
    s_add_u32 s71, s71, s60
    s_add_u32 s71, s71, 5505024
    s_lshl_b32 s79, s63, 6
    s_add_u32 s79, s79, s61
    s_lshl_b32 s79, s79, 3
    s_add_u32 s79, s79, 15032320
    s_lshl_b32 s7, s57, 1
    s_add_u32 s7, s7, 1
    s_lshl_b32 s68, s7, 7
    s_lshl_b32 s61, s7, 1
    s_add_u32 s61, s61, s64
    s_lshl_b32 s72, s61, 11
    s_mul_i32 s60, s63, 147456
    s_add_u32 s72, s72, s60
    s_add_u32 s72, s72, 5505024
    s_lshl_b32 s80, s63, 6
    s_add_u32 s80, s80, s61
    s_lshl_b32 s80, s80, 3
    s_add_u32 s80, s80, 15032320
    s_mov_b32 s53, s72
    s_mov_b32 s54, s80
    s_cmp_ge_u32 s58, 4
    s_cbranch_scc1 L_g0c2
    s_waitcnt vmcnt(6) lgkmcnt(4)
    s_barrier
    v_add_u32 v212, 0, v208
    v_add_u32 v213, 0, v209
    v_add_u32 v214, 0, v210
    v_add_u32 v215, 0, v211
    ds_read_b128 v[16:19], v212
    ds_read_b128 v[20:23], v213
    ds_read_b128 v[24:27], v214
    ds_read_b128 v[28:31], v215
    s_add_u32 m0, s65, 131072
    s_bfe_u32 s61, s75, 0x40008
    s_mul_i32 s61, s61, 172032
    s_add_u32 s61, s61, s66
    buffer_load_dwordx4 v202, s[12:15], s61 offen lds
    s_add_u32 m0, s65, 132096
    s_add_u32 s61, s61, 21504
    buffer_load_dwordx4 v202, s[12:15], s61 offen lds
    s_add_u32 m0, s55, 32768
    s_bfe_u32 s60, s75, 0x40008
    s_mul_i32 s60, s60, 128
    s_add_u32 s60, s60, s62
    buffer_load_dwordx4 v4, s[8:11], s60 offen lds
    s_add_u32 m0, s55, 33792
    s_nop 0
    buffer_load_dwordx4 v5, s[8:11], s60 offen lds
    s_add_u32 m0, s55, 34816
    s_add_u32 s60, s60, 14336
    buffer_load_dwordx4 v4, s[8:11], s60 offen lds
    s_add_u32 m0, s55, 35840
    s_nop 0
    buffer_load_dwordx4 v5, s[8:11], s60 offen lds
    s_add_u32 m0, s65, 139264
    s_bfe_u32 s61, s75, 0x4000c
    s_mul_i32 s61, s61, 172032
    s_add_u32 s61, s61, s66
    buffer_load_dwordx4 v202, s[12:15], s61 offen lds
    s_add_u32 m0, s65, 140288
    s_add_u32 s61, s61, 21504
    buffer_load_dwordx4 v202, s[12:15], s61 offen lds
    s_add_u32 m0, s55, 49152
    s_bfe_u32 s60, s75, 0x4000c
    s_mul_i32 s60, s60, 128
    s_add_u32 s60, s60, s62
    buffer_load_dwordx4 v4, s[8:11], s60 offen lds
    s_add_u32 m0, s55, 50176
    s_nop 0
    buffer_load_dwordx4 v5, s[8:11], s60 offen lds
    s_add_u32 m0, s55, 51200
    s_add_u32 s60, s60, 14336
    buffer_load_dwordx4 v4, s[8:11], s60 offen lds
    s_add_u32 m0, s55, 52224
    s_nop 0
    buffer_load_dwordx4 v5, s[8:11], s60 offen lds
    s_waitcnt vmcnt(12) lgkmcnt(4)
    s_barrier
    v_add_u32 v212, 16384, v208
    v_add_u32 v213, 16384, v209
    v_add_u32 v214, 16384, v210
    v_add_u32 v215, 16384, v211
    ds_read_b128 v[32:35], v212
    ds_read_b128 v[36:39], v213
    ds_read_b128 v[40:43], v214
    ds_read_b128 v[44:47], v215
    s_add_u32 m0, s65, 147456
    s_bfe_u32 s61, s75, 0x40010
    s_mul_i32 s61, s61, 172032
    s_add_u32 s61, s61, s66
    buffer_load_dwordx4 v202, s[12:15], s61 offen lds
    s_add_u32 m0, s65, 148480
    s_add_u32 s61, s61, 21504
    buffer_load_dwordx4 v202, s[12:15], s61 offen lds
    s_add_u32 m0, s55, 65536
    s_bfe_u32 s60, s75, 0x40010
    s_mul_i32 s60, s60, 128
    s_add_u32 s60, s60, s62
    buffer_load_dwordx4 v4, s[8:11], s60 offen lds
    s_add_u32 m0, s55, 66560
    s_nop 0
    buffer_load_dwordx4 v5, s[8:11], s60 offen lds
    s_add_u32 m0, s55, 67584
    s_add_u32 s60, s60, 14336
    buffer_load_dwordx4 v4, s[8:11], s60 offen lds
    s_add_u32 m0, s55, 68608
    s_nop 0
    buffer_load_dwordx4 v5, s[8:11], s60 offen lds
    s_waitcnt vmcnt(12) lgkmcnt(4)
    s_barrier
    v_add_u32 v212, 32768, v208
    v_add_u32 v213, 32768, v209
    v_add_u32 v214, 32768, v210
    v_add_u32 v215, 32768, v211
    ds_read_b128 v[48:51], v212
    ds_read_b128 v[52:55], v213
    ds_read_b128 v[56:59], v214
    ds_read_b128 v[60:63], v215
    s_add_u32 m0, s65, 155648
    s_bfe_u32 s61, s75, 0x40014
    s_mul_i32 s61, s61, 172032
    s_add_u32 s61, s61, s66
    buffer_load_dwordx4 v202, s[12:15], s61 offen lds
    s_add_u32 m0, s65, 156672
    s_add_u32 s61, s61, 21504
    buffer_load_dwordx4 v202, s[12:15], s61 offen lds
    s_add_u32 m0, s55, 81920
    s_bfe_u32 s60, s75, 0x40014
    s_mul_i32 s60, s60, 128
    s_add_u32 s60, s60, s62
    buffer_load_dwordx4 v4, s[8:11], s60 offen lds
    s_add_u32 m0, s55, 82944
    s_nop 0
    buffer_load_dwordx4 v5, s[8:11], s60 offen lds
    s_add_u32 m0, s55, 83968
    s_add_u32 s60, s60, 14336
    buffer_load_dwordx4 v4, s[8:11], s60 offen lds
    s_add_u32 m0, s55, 84992
    s_nop 0
    buffer_load_dwordx4 v5, s[8:11], s60 offen lds
    s_waitcnt vmcnt(12) lgkmcnt(4)
    s_barrier
    v_add_u32 v212, 49152, v208
    v_add_u32 v213, 49152, v209
    v_add_u32 v214, 49152, v210
    v_add_u32 v215, 49152, v211
    ds_read_b128 v[64:67], v212
    ds_read_b128 v[68:71], v213
    ds_read_b128 v[72:75], v214
    ds_read_b128 v[76:79], v215
    s_add_u32 m0, s65, 114688
    s_bfe_u32 s61, s75, 0x40018
    s_mul_i32 s61, s61, 172032
    s_add_u32 s61, s61, s66
    buffer_load_dwordx4 v202, s[12:15], s61 offen lds
    s_add_u32 m0, s65, 115712
    s_add_u32 s61, s61, 21504
    buffer_load_dwordx4 v202, s[12:15], s61 offen lds
    s_add_u32 m0, s55, 98304
    s_bfe_u32 s60, s75, 0x40018
    s_mul_i32 s60, s60, 128
    s_add_u32 s60, s60, s62
    buffer_load_dwordx4 v4, s[8:11], s60 offen lds
    s_add_u32 m0, s55, 99328
    s_nop 0
    buffer_load_dwordx4 v5, s[8:11], s60 offen lds
    s_add_u32 m0, s55, 100352
    s_add_u32 s60, s60, 14336
    buffer_load_dwordx4 v4, s[8:11], s60 offen lds
    s_add_u32 m0, s55, 101376
    s_nop 0
    buffer_load_dwordx4 v5, s[8:11], s60 offen lds
    s_bfe_u32 s60, s75, 0x40000
    s_mul_i32 s60, s60, 229376
    s_add_u32 s60, s60, s67
    s_add_u32 s61, s60, 28672
    s_add_u32 m0, s65, 0
    s_nop 0
    buffer_load_dwordx4 v201, s[16:19], s60 offen lds
    s_add_u32 m0, s65, 1024
    s_nop 0
    buffer_load_dwordx4 v201, s[16:19], s61 offen lds
    s_add_u32 m0, s65, 8192
    s_nop 0
    buffer_load_dwordx4 v201, s[20:23], s60 offen lds
    s_add_u32 m0, s65, 9216
    s_nop 0
    buffer_load_dwordx4 v201, s[20:23], s61 offen lds
    s_waitcnt vmcnt(16) lgkmcnt(4)
    s_barrier
    v_add_u32 v212, 65536, v208
    v_add_u32 v213, 65536, v209
    v_add_u32 v214, 65536, v210
    v_add_u32 v215, 65536, v211
    ds_read_b128 v[80:83], v212
    ds_read_b128 v[84:87], v213
    ds_read_b128 v[88:91], v214
    ds_read_b128 v[92:95], v215
    s_bfe_u32 s60, s75, 0x40004
    s_mul_i32 s60, s60, 229376
    s_add_u32 s60, s60, s67
    s_add_u32 s61, s60, 28672
    s_add_u32 m0, s65, 122880
    s_nop 0
    buffer_load_dwordx4 v201, s[16:19], s60 offen lds
    s_add_u32 m0, s65, 123904
    s_nop 0
    buffer_load_dwordx4 v201, s[16:19], s61 offen lds
    s_add_u32 m0, s65, 16384
    s_nop 0
    buffer_load_dwordx4 v201, s[20:23], s60 offen lds
    s_add_u32 m0, s65, 17408
    s_nop 0
    buffer_load_dwordx4 v201, s[20:23], s61 offen lds
    s_waitcnt vmcnt(14) lgkmcnt(4)
    s_barrier
    v_add_u32 v212, 81920, v208
    v_add_u32 v213, 81920, v209
    v_add_u32 v214, 81920, v210
    v_add_u32 v215, 81920, v211
    ds_read_b128 v[96:99], v212
    ds_read_b128 v[100:103], v213
    ds_read_b128 v[104:107], v214
    ds_read_b128 v[108:111], v215
    s_bfe_u32 s60, s75, 0x40008
    s_mul_i32 s60, s60, 229376
    s_add_u32 s60, s60, s67
    s_add_u32 s61, s60, 28672
    s_add_u32 m0, s65, 24576
    s_nop 0
    buffer_load_dwordx4 v201, s[16:19], s60 offen lds
    s_add_u32 m0, s65, 25600
    s_nop 0
    buffer_load_dwordx4 v201, s[16:19], s61 offen lds
    s_add_u32 m0, s65, 131072
    s_nop 0
    buffer_load_dwordx4 v201, s[20:23], s60 offen lds
    s_add_u32 m0, s65, 132096
    s_nop 0
    buffer_load_dwordx4 v201, s[20:23], s61 offen lds
    s_waitcnt vmcnt(12) lgkmcnt(4)
    s_barrier
    v_add_u32 v212, 98304, v208
    v_add_u32 v213, 98304, v209
    v_add_u32 v214, 98304, v210
    v_add_u32 v215, 98304, v211
    ds_read_b128 v[112:115], v212
    ds_read_b128 v[116:119], v213
    ds_read_b128 v[120:123], v214
    ds_read_b128 v[124:127], v215
    s_bfe_u32 s60, s75, 0x4000c
    s_mul_i32 s60, s60, 229376
    s_add_u32 s60, s60, s67
    s_add_u32 s61, s60, 28672
    s_add_u32 m0, s65, 32768
    s_nop 0
    buffer_load_dwordx4 v201, s[16:19], s60 offen lds
    s_add_u32 m0, s65, 33792
    s_nop 0
    buffer_load_dwordx4 v201, s[16:19], s61 offen lds
    s_add_u32 m0, s65, 40960
    s_nop 0
    buffer_load_dwordx4 v201, s[20:23], s60 offen lds
    s_add_u32 m0, s65, 41984
    s_nop 0
    buffer_load_dwordx4 v201, s[20:23], s61 offen lds
    s_branch L_g0j3
L_g0c2:
    s_barrier
    v_add_u32 v212, 0, v208
    v_add_u32 v213, 0, v209
    v_add_u32 v214, 0, v210
    v_add_u32 v215, 0, v211
    ds_read_b128 v[16:19], v212
    ds_read_b128 v[20:23], v213
    ds_read_b128 v[24:27], v214
    ds_read_b128 v[28:31], v215
    ds_read_b64_tr_b16 v[216:217], v204 offset:49152
    ds_read_b64_tr_b16 v[218:219], v204 offset:49664
    ds_read_b64_tr_b16 v[220:221], v7 offset:49152
    ds_read_b64_tr_b16 v[222:223], v7 offset:49664
    ds_read_b64_tr_b16 v[224:225], v204 offset:51200
    ds_read_b64_tr_b16 v[226:227], v204 offset:51712
    ds_read_b64_tr_b16 v[228:229], v7 offset:51200
    ds_read_b64_tr_b16 v[230:231], v7 offset:51712
    ds_read_b64_tr_b16 v[232:233], v204 offset:53248
    ds_read_b64_tr_b16 v[234:235], v204 offset:53760
    ds_read_b64_tr_b16 v[236:237], v7 offset:53248
    ds_read_b64_tr_b16 v[238:239], v7 offset:53760
    ds_read_b64_tr_b16 v[240:241], v204 offset:55296
    ds_read_b64_tr_b16 v[242:243], v204 offset:55808
    ds_read_b64_tr_b16 v[244:245], v7 offset:55296
    ds_read_b64_tr_b16 v[246:247], v7 offset:55808
    s_barrier
    v_add_u32 v212, 16384, v208
    v_add_u32 v213, 16384, v209
    v_add_u32 v214, 16384, v210
    v_add_u32 v215, 16384, v211
    s_waitcnt lgkmcnt(14)
    v_mfma_f32_32x32x16_bf16 v[128:143], v[216:219], v[16:19], 0
    ds_read_b128 v[32:35], v212
    ds_read_b128 v[36:39], v213
    ds_read_b128 v[40:43], v214
    s_waitcnt lgkmcnt(15)
    v_mfma_f32_32x32x16_bf16 v[144:159], v[220:223], v[16:19], 0
    ds_read_b128 v[44:47], v215
    ds_read_b64_tr_b16 v[160:161], v204 offset:57344
    ds_read_b64_tr_b16 v[162:163], v204 offset:57856
    s_waitcnt lgkmcnt(15)
    v_mfma_f32_32x32x16_bf16 v[128:143], v[224:227], v[20:23], v[128:143]
    ds_read_b64_tr_b16 v[164:165], v7 offset:57344
    ds_read_b64_tr_b16 v[166:167], v7 offset:57856
    ds_read_b64_tr_b16 v[168:169], v204 offset:59392
    s_waitcnt lgkmcnt(15)
    v_mfma_f32_32x32x16_bf16 v[144:159], v[228:231], v[20:23], v[144:159]
    ds_read_b64_tr_b16 v[170:171], v204 offset:59904
    ds_read_b64_tr_b16 v[172:173], v7 offset:59392
    ds_read_b64_tr_b16 v[174:175], v7 offset:59904
    s_waitcnt lgkmcnt(15)
    v_mfma_f32_32x32x16_bf16 v[128:143], v[232:235], v[24:27], v[128:143]
    ds_read_b64_tr_b16 v[176:177], v204 offset:61440
    ds_read_b64_tr_b16 v[178:179], v204 offset:61952
    s_waitcnt lgkmcnt(15)
    v_mfma_f32_32x32x16_bf16 v[144:159], v[236:239], v[24:27], v[144:159]
    ds_read_b64_tr_b16 v[180:181], v7 offset:61440
    ds_read_b64_tr_b16 v[182:183], v7 offset:61952
    s_waitcnt lgkmcnt(15)
    v_mfma_f32_32x32x16_bf16 v[128:143], v[240:243], v[28:31], v[128:143]
    ds_read_b64_tr_b16 v[184:185], v204 offset:63488
    ds_read_b64_tr_b16 v[186:187], v204 offset:64000
    s_waitcnt lgkmcnt(15)
    v_mfma_f32_32x32x16_bf16 v[144:159], v[244:247], v[28:31], v[144:159]
    ds_read_b64_tr_b16 v[188:189], v7 offset:63488
    ds_read_b64_tr_b16 v[190:191], v7 offset:64000
    s_barrier
    v_add_u32 v212, 32768, v208
    v_add_u32 v213, 32768, v209
    v_add_u32 v214, 32768, v210
    v_add_u32 v215, 32768, v211
    s_waitcnt lgkmcnt(14)
    v_mfma_f32_32x32x16_bf16 v[128:143], v[160:163], v[32:35], v[128:143]
    ds_read_b128 v[48:51], v212
    ds_read_b128 v[52:55], v213
    ds_read_b128 v[56:59], v214
    s_waitcnt lgkmcnt(15)
    v_mfma_f32_32x32x16_bf16 v[144:159], v[164:167], v[32:35], v[144:159]
    ds_read_b128 v[60:63], v215
    ds_read_b64_tr_b16 v[216:217], v205 offset:0
    ds_read_b64_tr_b16 v[218:219], v205 offset:512
    s_waitcnt lgkmcnt(15)
    v_mfma_f32_32x32x16_bf16 v[128:143], v[168:171], v[36:39], v[128:143]
    ds_read_b64_tr_b16 v[220:221], v8 offset:0
    ds_read_b64_tr_b16 v[222:223], v8 offset:512
    ds_read_b64_tr_b16 v[224:225], v205 offset:2048
    s_waitcnt lgkmcnt(15)
    v_mfma_f32_32x32x16_bf16 v[144:159], v[172:175], v[36:39], v[144:159]
    ds_read_b64_tr_b16 v[226:227], v205 offset:2560
    ds_read_b64_tr_b16 v[228:229], v8 offset:2048
    ds_read_b64_tr_b16 v[230:231], v8 offset:2560
    s_waitcnt lgkmcnt(15)
    v_mfma_f32_32x32x16_bf16 v[128:143], v[176:179], v[40:43], v[128:143]
    ds_read_b64_tr_b16 v[232:233], v205 offset:4096
    ds_read_b64_tr_b16 v[234:235], v205 offset:4608
    s_waitcnt lgkmcnt(15)
    v_mfma_f32_32x32x16_bf16 v[144:159], v[180:183], v[40:43], v[144:159]
    ds_read_b64_tr_b16 v[236:237], v8 offset:4096
    ds_read_b64_tr_b16 v[238:239], v8 offset:4608
    s_waitcnt lgkmcnt(15)
    v_mfma_f32_32x32x16_bf16 v[128:143], v[184:187], v[44:47], v[128:143]
    ds_read_b64_tr_b16 v[240:241], v205 offset:6144
    ds_read_b64_tr_b16 v[242:243], v205 offset:6656
    s_waitcnt lgkmcnt(15)
    v_mfma_f32_32x32x16_bf16 v[144:159], v[188:191], v[44:47], v[144:159]
    ds_read_b64_tr_b16 v[244:245], v8 offset:6144
    ds_read_b64_tr_b16 v[246:247], v8 offset:6656
    s_barrier
    v_add_u32 v212, 49152, v208
    v_add_u32 v213, 49152, v209
    v_add_u32 v214, 49152, v210
    v_add_u32 v215, 49152, v211
    s_waitcnt lgkmcnt(14)
    v_mfma_f32_32x32x16_bf16 v[128:143], v[216:219], v[48:51], v[128:143]
    ds_read_b128 v[64:67], v212
    ds_read_b128 v[68:71], v213
    ds_read_b128 v[72:75], v214
    s_waitcnt lgkmcnt(15)
    v_mfma_f32_32x32x16_bf16 v[144:159], v[220:223], v[48:51], v[144:159]
    ds_read_b128 v[76:79], v215
    ds_read_b64_tr_b16 v[160:161], v205 offset:8192
    ds_read_b64_tr_b16 v[162:163], v205 offset:8704
    s_waitcnt lgkmcnt(15)
    v_mfma_f32_32x32x16_bf16 v[128:143], v[224:227], v[52:55], v[128:143]
    ds_read_b64_tr_b16 v[164:165], v8 offset:8192
    ds_read_b64_tr_b16 v[166:167], v8 offset:8704
    ds_read_b64_tr_b16 v[168:169], v205 offset:10240
    s_waitcnt lgkmcnt(15)
    v_mfma_f32_32x32x16_bf16 v[144:159], v[228:231], v[52:55], v[144:159]
    ds_read_b64_tr_b16 v[170:171], v205 offset:10752
    ds_read_b64_tr_b16 v[172:173], v8 offset:10240
    ds_read_b64_tr_b16 v[174:175], v8 offset:10752
    s_waitcnt lgkmcnt(15)
    v_mfma_f32_32x32x16_bf16 v[128:143], v[232:235], v[56:59], v[128:143]
    ds_read_b64_tr_b16 v[176:177], v205 offset:12288
    ds_read_b64_tr_b16 v[178:179], v205 offset:12800
    s_waitcnt lgkmcnt(15)
    v_mfma_f32_32x32x16_bf16 v[144:159], v[236:239], v[56:59], v[144:159]
    ds_read_b64_tr_b16 v[180:181], v8 offset:12288
    ds_read_b64_tr_b16 v[182:183], v8 offset:12800
    s_waitcnt lgkmcnt(15)
    v_mfma_f32_32x32x16_bf16 v[128:143], v[240:243], v[60:63], v[128:143]
    ds_read_b64_tr_b16 v[184:185], v205 offset:14336
    ds_read_b64_tr_b16 v[186:187], v205 offset:14848
    s_waitcnt lgkmcnt(15)
    v_mfma_f32_32x32x16_bf16 v[144:159], v[244:247], v[60:63], v[144:159]
    ds_read_b64_tr_b16 v[188:189], v8 offset:14336
    ds_read_b64_tr_b16 v[190:191], v8 offset:14848
    s_barrier
    v_add_u32 v212, 65536, v208
    v_add_u32 v213, 65536, v209
    v_add_u32 v214, 65536, v210
    v_add_u32 v215, 65536, v211
    s_waitcnt lgkmcnt(14)
    v_mfma_f32_32x32x16_bf16 v[128:143], v[160:163], v[64:67], v[128:143]
    ds_read_b128 v[80:83], v212
    ds_read_b128 v[84:87], v213
    ds_read_b128 v[88:91], v214
    s_waitcnt lgkmcnt(15)
    v_mfma_f32_32x32x16_bf16 v[144:159], v[164:167], v[64:67], v[144:159]
    ds_read_b128 v[92:95], v215
    ds_read_b64_tr_b16 v[216:217], v205 offset:16384
    ds_read_b64_tr_b16 v[218:219], v205 offset:16896
    s_waitcnt lgkmcnt(15)
    v_mfma_f32_32x32x16_bf16 v[128:143], v[168:171], v[68:71], v[128:143]
    ds_read_b64_tr_b16 v[220:221], v8 offset:16384
    ds_read_b64_tr_b16 v[222:223], v8 offset:16896
    ds_read_b64_tr_b16 v[224:225], v205 offset:18432
    s_waitcnt lgkmcnt(15)
    v_mfma_f32_32x32x16_bf16 v[144:159], v[172:175], v[68:71], v[144:159]
    ds_read_b64_tr_b16 v[226:227], v205 offset:18944
    ds_read_b64_tr_b16 v[228:229], v8 offset:18432
    ds_read_b64_tr_b16 v[230:231], v8 offset:18944
    s_waitcnt lgkmcnt(15)
    v_mfma_f32_32x32x16_bf16 v[128:143], v[176:179], v[72:75], v[128:143]
    ds_read_b64_tr_b16 v[232:233], v205 offset:20480
    ds_read_b64_tr_b16 v[234:235], v205 offset:20992
    s_waitcnt lgkmcnt(15)
    v_mfma_f32_32x32x16_bf16 v[144:159], v[180:183], v[72:75], v[144:159]
    ds_read_b64_tr_b16 v[236:237], v8 offset:20480
    ds_read_b64_tr_b16 v[238:239], v8 offset:20992
    s_waitcnt lgkmcnt(15)
    v_mfma_f32_32x32x16_bf16 v[128:143], v[184:187], v[76:79], v[128:143]
    ds_read_b64_tr_b16 v[240:241], v205 offset:22528
    ds_read_b64_tr_b16 v[242:243], v205 offset:23040
    s_waitcnt lgkmcnt(15)
    v_mfma_f32_32x32x16_bf16 v[144:159], v[188:191], v[76:79], v[144:159]
    ds_read_b64_tr_b16 v[244:245], v8 offset:22528
    ds_read_b64_tr_b16 v[246:247], v8 offset:23040
    s_barrier
    v_add_u32 v212, 81920, v208
    v_add_u32 v213, 81920, v209
    v_add_u32 v214, 81920, v210
    v_add_u32 v215, 81920, v211
    s_waitcnt lgkmcnt(14)
    v_mfma_f32_32x32x16_bf16 v[128:143], v[216:219], v[80:83], v[128:143]
    ds_read_b128 v[96:99], v212
    ds_read_b128 v[100:103], v213
    ds_read_b128 v[104:107], v214
    s_waitcnt lgkmcnt(15)
    v_mfma_f32_32x32x16_bf16 v[144:159], v[220:223], v[80:83], v[144:159]
    ds_read_b128 v[108:111], v215
    ds_read_b64_tr_b16 v[160:161], v205 offset:24576
    ds_read_b64_tr_b16 v[162:163], v205 offset:25088
    s_waitcnt lgkmcnt(15)
    v_mfma_f32_32x32x16_bf16 v[128:143], v[224:227], v[84:87], v[128:143]
    ds_read_b64_tr_b16 v[164:165], v8 offset:24576
    ds_read_b64_tr_b16 v[166:167], v8 offset:25088
    ds_read_b64_tr_b16 v[168:169], v205 offset:26624
    s_waitcnt lgkmcnt(15)
    v_mfma_f32_32x32x16_bf16 v[144:159], v[228:231], v[84:87], v[144:159]
    ds_read_b64_tr_b16 v[170:171], v205 offset:27136
    ds_read_b64_tr_b16 v[172:173], v8 offset:26624
    ds_read_b64_tr_b16 v[174:175], v8 offset:27136
    s_waitcnt lgkmcnt(15)
    v_mfma_f32_32x32x16_bf16 v[128:143], v[232:235], v[88:91], v[128:143]
    ds_read_b64_tr_b16 v[176:177], v205 offset:28672
    ds_read_b64_tr_b16 v[178:179], v205 offset:29184
    s_waitcnt lgkmcnt(15)
    v_mfma_f32_32x32x16_bf16 v[144:159], v[236:239], v[88:91], v[144:159]
    ds_read_b64_tr_b16 v[180:181], v8 offset:28672
    ds_read_b64_tr_b16 v[182:183], v8 offset:29184
    s_waitcnt lgkmcnt(15)
    v_mfma_f32_32x32x16_bf16 v[128:143], v[240:243], v[92:95], v[128:143]
    ds_read_b64_tr_b16 v[184:185], v205 offset:30720
    ds_read_b64_tr_b16 v[186:187], v205 offset:31232
    s_waitcnt lgkmcnt(15)
    v_mfma_f32_32x32x16_bf16 v[144:159], v[244:247], v[92:95], v[144:159]
    ds_read_b64_tr_b16 v[188:189], v8 offset:30720
    ds_read_b64_tr_b16 v[190:191], v8 offset:31232
    s_barrier
    v_add_u32 v212, 98304, v208
    v_add_u32 v213, 98304, v209
    v_add_u32 v214, 98304, v210
    v_add_u32 v215, 98304, v211
    s_waitcnt lgkmcnt(14)
    v_mfma_f32_32x32x16_bf16 v[128:143], v[160:163], v[96:99], v[128:143]
    ds_read_b128 v[112:115], v212
    ds_read_b128 v[116:119], v213
    ds_read_b128 v[120:123], v214
    s_waitcnt lgkmcnt(15)
    v_mfma_f32_32x32x16_bf16 v[144:159], v[164:167], v[96:99], v[144:159]
    ds_read_b128 v[124:127], v215
    ds_read_b64_tr_b16 v[216:217], v204 offset:49152
    ds_read_b64_tr_b16 v[218:219], v204 offset:49664
    s_waitcnt lgkmcnt(15)
    v_mfma_f32_32x32x16_bf16 v[128:143], v[168:171], v[100:103], v[128:143]
    ds_read_b64_tr_b16 v[220:221], v7 offset:49152
    ds_read_b64_tr_b16 v[222:223], v7 offset:49664
    ds_read_b64_tr_b16 v[224:225], v204 offset:51200
    s_waitcnt lgkmcnt(15)
    v_mfma_f32_32x32x16_bf16 v[144:159], v[172:175], v[100:103], v[144:159]
    ds_read_b64_tr_b16 v[226:227], v204 offset:51712
    ds_read_b64_tr_b16 v[228:229], v7 offset:51200
    ds_read_b64_tr_b16 v[230:231], v7 offset:51712
    s_waitcnt lgkmcnt(15)
    v_mfma_f32_32x32x16_bf16 v[128:143], v[176:179], v[104:107], v[128:143]
    ds_read_b64_tr_b16 v[232:233], v204 offset:53248
    ds_read_b64_tr_b16 v[234:235], v204 offset:53760
    s_waitcnt lgkmcnt(15)
    v_mfma_f32_32x32x16_bf16 v[144:159], v[180:183], v[104:107], v[144:159]
    ds_read_b64_tr_b16 v[236:237], v7 offset:53248
    ds_read_b64_tr_b16 v[238:239], v7 offset:53760
    s_waitcnt lgkmcnt(15)
    v_mfma_f32_32x32x16_bf16 v[128:143], v[184:187], v[108:111], v[128:143]
    ds_read_b64_tr_b16 v[240:241], v204 offset:55296
    ds_read_b64_tr_b16 v[242:243], v204 offset:55808
    s_waitcnt lgkmcnt(15)
    v_mfma_f32_32x32x16_bf16 v[144:159], v[188:191], v[108:111], v[144:159]
    ds_read_b64_tr_b16 v[244:245], v7 offset:55296
    ds_read_b64_tr_b16 v[246:247], v7 offset:55808
L_g0j3:
    s_cmp_ge_u32 s58, 4
    s_cbranch_scc1 L_vw4
    s_waitcnt vmcnt(12)
L_vw4:
    s_barrier
    buffer_load_dword v200, v14, s[48:51], 0 offen sc1
    ds_read_b64_tr_b16 v[160:161], v6 offset:0
    ds_read_b64_tr_b16 v[162:163], v6 offset:512
    s_add_u32 m0, s59, 139264
    s_bfe_u32 s96, s75, 0x40010
    s_mul_i32 s96, s96, 229376
    s_add_u32 s96, s96, s67
    buffer_load_dwordx4 v3, s[16:19], s96 offen lds
    ds_read_b64_tr_b16 v[164:165], v6 offset:8192
    ds_read_b64_tr_b16 v[166:167], v6 offset:8704
    ds_read_b64_tr_b16 v[168:169], v6 offset:2048
    ds_read_b64_tr_b16 v[170:171], v6 offset:2560
    ds_read_b64_tr_b16 v[172:173], v6 offset:10240
    ds_read_b64_tr_b16 v[174:175], v6 offset:10752
    s_cmp_ge_u32 s58, 4
    s_cbranch_scc1 L_e06
    v_lshrrev_b32 v204, 5, v1
    v_and_b32 v205, 31, v1
    s_and_b32 s60, s2, 7
    s_lshr_b32 s61, s2, 3
    s_and_b32 s82, s61, 1
    s_lshl_b32 s82, s82, 3
    s_add_u32 s82, s82, s60
    s_lshr_b32 s83, s61, 1
    s_mul_i32 s89, s82, 7
    s_lshr_b32 s89, s89, 1
    v_lshlrev_b32 v240, 4, v205
    v_lshl_add_u32 v240, v204, 15, v240
    s_mul_i32 s60, s82, 448
    v_add_u32 v241, s60, v10
    s_mov_b32 s87, 0x4e800000
    s_add_u32 s4, s89, 56
    s_lshl_b32 s4, s4, 15
    s_lshl_b32 s5, s58, 13
    s_add_u32 s4, s4, s5
    s_mov_b32 s85, s4
    v_add_u32 v248, s4, v240
    v_mov_b32 v250, v240
    v_mov_b32 v240, v248
    v_add_u32 v248, 65536, v248
    v_add_u32 v249, 14336, v241
    v_lshlrev_b32 v206, 4, v205
    v_add_u32 v206, 28224, v206
    v_cmp_gt_u32 vcc, 28, v205
    s_nop 1
    v_cndmask_b32 v241, v206, v241, vcc
    v_cndmask_b32 v249, v206, v249, vcc
    s_mul_i32 s4, s58, 466944
    s_add_u32 s4, s4, 16777216
    v_add_u32 v241, s4, v241
    v_add_u32 v249, s4, v249
    s_lshl_b32 s84, s83, 9
    s_mul_i32 s86, s84, 57
    s_and_b32 s60, s82, 1
    v_cmp_le_u32 vcc, s60, v204
    s_nop 1
    v_cndmask_b32 v244, 0, -1, vcc
    v_cmp_ge_u32 vcc, s60, v204
    s_nop 1
    v_cndmask_b32 v245, 0, -1, vcc
    s_add_u32 s4, s89, 56
    s_lshr_b32 s4, s4, 2
    s_add_u32 s5, s89, 59
    s_lshr_b32 s5, s5, 2
    s_mul_i32 s6, s82, 28
    s_add_u32 s7, s6, 27
    s_lshr_b32 s6, s6, 5
    s_lshr_b32 s7, s7, 5
    s_add_u32 s6, s6, 28
    s_add_u32 s7, s7, 28
    v_mov_b32 v242, s7
    v_mov_b32 v206, s6
    v_cmp_gt_u32 vcc, 48, v1
    s_nop 1
    v_cndmask_b32 v242, v242, v206, vcc
    v_mov_b32 v206, s5
    v_cmp_gt_u32 vcc, 32, v1
    s_nop 1
    v_cndmask_b32 v242, v242, v206, vcc
    v_mov_b32 v206, s4
    v_cmp_gt_u32 vcc, 16, v1
    s_nop 1
    v_cndmask_b32 v242, v242, v206, vcc
    v_and_b32 v206, 15, v1
    v_lshl_add_u32 v242, v242, 6, v206
    s_lshl_b32 s4, s58, 4
    v_add_u32 v242, s4, v242
    v_lshlrev_b32 v242, 3, v242
    s_lshr_b32 s4, s89, 2
    s_add_u32 s5, s89, 3
    s_lshr_b32 s5, s5, 2
    s_lshl_b32 s6, s83, 2
    v_and_b32 v206, 3, v1
    v_add_u32 v206, s6, v206
    v_mov_b32 v243, s5
    v_mov_b32 v12, s4
    v_cmp_gt_u32 vcc, 4, v1
    s_nop 1
    v_cndmask_b32 v243, v243, v12, vcc
    v_lshl_add_u32 v243, v243, 6, v206
    v_lshlrev_b32 v243, 3, v243
    v_lshlrev_b32 v206, 9, v206
    v_add_u32 v206, 25024, v206
    v_cmp_gt_u32 vcc, 8, v1
    s_nop 1
    v_cndmask_b32 v243, v206, v243, vcc
    s_branch L_e05
L_e06:
    s_waitcnt lgkmcnt(15)
    v_mfma_f32_32x32x16_bf16 v[128:143], v[216:219], v[112:115], v[128:143]
    s_waitcnt lgkmcnt(15)
    v_mfma_f32_32x32x16_bf16 v[144:159], v[220:223], v[112:115], v[144:159]
    s_waitcnt lgkmcnt(15)
    v_mfma_f32_32x32x16_bf16 v[128:143], v[224:227], v[116:119], v[128:143]
    s_waitcnt lgkmcnt(15)
    v_mfma_f32_32x32x16_bf16 v[144:159], v[228:231], v[116:119], v[144:159]
    s_waitcnt lgkmcnt(14)
    v_mfma_f32_32x32x16_bf16 v[128:143], v[232:235], v[120:123], v[128:143]
    s_waitcnt lgkmcnt(12)
    v_mfma_f32_32x32x16_bf16 v[144:159], v[236:239], v[120:123], v[144:159]
    s_waitcnt lgkmcnt(10)
    v_mfma_f32_32x32x16_bf16 v[128:143], v[240:243], v[124:127], v[128:143]
    s_waitcnt lgkmcnt(8)
    v_mfma_f32_32x32x16_bf16 v[144:159], v[244:247], v[124:127], v[144:159]
    s_nop 9
    v_mul_f32 v128, s74, v128
    v_mul_f32 v129, s74, v129
    v_mul_f32 v130, s74, v130
    v_mul_f32 v131, s74, v131
    v_mul_f32 v132, s74, v132
    v_mul_f32 v133, s74, v133
    v_mul_f32 v134, s74, v134
    v_mul_f32 v135, s74, v135
    v_mul_f32 v136, s74, v136
    v_mul_f32 v137, s74, v137
    v_mul_f32 v138, s74, v138
    v_mul_f32 v139, s74, v139
    v_mul_f32 v140, s74, v140
    v_mul_f32 v141, s74, v141
    v_mul_f32 v142, s74, v142
    v_mul_f32 v143, s74, v143
    v_cvt_pk_bf16_f32 v192, v128, v129
    v_cvt_pk_bf16_f32 v193, v130, v131
    v_cvt_pk_bf16_f32 v194, v132, v133
    v_cvt_pk_bf16_f32 v195, v134, v135
    v_cvt_pk_bf16_f32 v196, v136, v137
    v_cvt_pk_bf16_f32 v197, v138, v139
    v_cvt_pk_bf16_f32 v198, v140, v141
    v_cvt_pk_bf16_f32 v199, v142, v143
    v_permlane32_swap_b32 v192, v194
    v_permlane32_swap_b32 v193, v195
    s_add_u32 s60, s70, 0
    buffer_store_dwordx4 v[192:195], v9, s[24:27], s60 offen sc1
    v_permlane32_swap_b32 v196, v198
    v_permlane32_swap_b32 v197, v199
    s_add_u32 s60, s70, 65536
    buffer_store_dwordx4 v[196:199], v9, s[24:27], s60 offen sc1
    s_add_u32 s70, s70, 131072
    v_mul_f32 v144, s74, v144
    v_mul_f32 v145, s74, v145
    v_mul_f32 v146, s74, v146
    v_mul_f32 v147, s74, v147
    v_mul_f32 v148, s74, v148
    v_mul_f32 v149, s74, v149
    v_mul_f32 v150, s74, v150
    v_mul_f32 v151, s74, v151
    v_mul_f32 v152, s74, v152
    v_mul_f32 v153, s74, v153
    v_mul_f32 v154, s74, v154
    v_mul_f32 v155, s74, v155
    v_mul_f32 v156, s74, v156
    v_mul_f32 v157, s74, v157
    v_mul_f32 v158, s74, v158
    v_mul_f32 v159, s74, v159
    v_cvt_pk_bf16_f32 v192, v144, v145
    v_cvt_pk_bf16_f32 v193, v146, v147
    v_cvt_pk_bf16_f32 v194, v148, v149
    v_cvt_pk_bf16_f32 v195, v150, v151
    v_cvt_pk_bf16_f32 v196, v152, v153
    v_cvt_pk_bf16_f32 v197, v154, v155
    v_cvt_pk_bf16_f32 v198, v156, v157
    v_cvt_pk_bf16_f32 v199, v158, v159
    v_permlane32_swap_b32 v192, v194
    v_permlane32_swap_b32 v193, v195
    s_add_u32 s60, s70, 0
    buffer_store_dwordx4 v[192:195], v9, s[24:27], s60 offen sc1
    v_permlane32_swap_b32 v196, v198
    v_permlane32_swap_b32 v197, v199
    s_add_u32 s60, s70, 65536
    buffer_store_dwordx4 v[196:199], v9, s[24:27], s60 offen sc1
L_e05:
    s_waitcnt lgkmcnt(6)
    v_mfma_f32_32x32x16_bf16 v[128:143], v[160:163], v[16:19], 0
    ds_read_b64_tr_b16 v[176:177], v6 offset:4096
    ds_read_b64_tr_b16 v[178:179], v6 offset:4608
    s_waitcnt lgkmcnt(6)
    v_mfma_f32_32x32x16_bf16 v[144:159], v[164:167], v[16:19], 0
    s_add_u32 m0, s59, 49152
    s_nop 0
    buffer_load_dwordx4 v3, s[20:23], s96 offen lds
    ds_read_b64_tr_b16 v[180:181], v6 offset:12288
    ds_read_b64_tr_b16 v[182:183], v6 offset:12800
    s_waitcnt lgkmcnt(6)
    v_mfma_f32_32x32x16_bf16 v[128:143], v[168:171], v[20:23], v[128:143]
    ds_read_b64_tr_b16 v[184:185], v6 offset:6144
    ds_read_b64_tr_b16 v[186:187], v6 offset:6656
    s_waitcnt lgkmcnt(6)
    v_mfma_f32_32x32x16_bf16 v[144:159], v[172:175], v[20:23], v[144:159]
    ds_read_b64_tr_b16 v[188:189], v6 offset:14336
    ds_read_b64_tr_b16 v[190:191], v6 offset:14848
    s_waitcnt lgkmcnt(6)
    v_mfma_f32_32x32x16_bf16 v[128:143], v[176:179], v[24:27], v[128:143]
    s_cmp_ge_u32 s58, 4
    s_cbranch_scc1 L_vw7
    s_waitcnt vmcnt(11)
L_vw7:
    s_barrier
    ds_read_b64_tr_b16 v[160:161], v7 offset:57344
    ds_read_b64_tr_b16 v[162:163], v7 offset:57856
    s_waitcnt lgkmcnt(6)
    v_mfma_f32_32x32x16_bf16 v[144:159], v[180:183], v[24:27], v[144:159]
    s_add_u32 m0, s59, 57344
    s_bfe_u32 s96, s75, 0x40014
    s_mul_i32 s96, s96, 229376
    s_add_u32 s96, s96, s67
    buffer_load_dwordx4 v3, s[16:19], s96 offen lds
    ds_read_b64_tr_b16 v[164:165], v6 offset:16384
    ds_read_b64_tr_b16 v[166:167], v6 offset:16896
    s_waitcnt lgkmcnt(6)
    v_mfma_f32_32x32x16_bf16 v[128:143], v[184:187], v[28:31], v[128:143]
    ds_read_b64_tr_b16 v[168:169], v7 offset:59392
    ds_read_b64_tr_b16 v[170:171], v7 offset:59904
    s_waitcnt lgkmcnt(6)
    v_mfma_f32_32x32x16_bf16 v[144:159], v[188:191], v[28:31], v[144:159]
    ds_read_b64_tr_b16 v[172:173], v6 offset:18432
    ds_read_b64_tr_b16 v[174:175], v6 offset:18944
    s_waitcnt lgkmcnt(6)
    v_mfma_f32_32x32x16_bf16 v[128:143], v[160:163], v[32:35], v[128:143]
    ds_read_b64_tr_b16 v[176:177], v7 offset:61440
    ds_read_b64_tr_b16 v[178:179], v7 offset:61952
    s_waitcnt lgkmcnt(6)
    v_mfma_f32_32x32x16_bf16 v[144:159], v[164:167], v[32:35], v[144:159]
    s_add_u32 m0, s59, 147456
    s_nop 0
    buffer_load_dwordx4 v3, s[20:23], s96 offen lds
    ds_read_b64_tr_b16 v[180:181], v6 offset:20480
    ds_read_b64_tr_b16 v[182:183], v6 offset:20992
    s_waitcnt lgkmcnt(6)
    v_mfma_f32_32x32x16_bf16 v[128:143], v[168:171], v[36:39], v[128:143]
    ds_read_b64_tr_b16 v[184:185], v7 offset:63488
    ds_read_b64_tr_b16 v[186:187], v7 offset:64000
    s_waitcnt lgkmcnt(6)
    v_mfma_f32_32x32x16_bf16 v[144:159], v[172:175], v[36:39], v[144:159]
    ds_read_b64_tr_b16 v[188:189], v6 offset:22528
    ds_read_b64_tr_b16 v[190:191], v6 offset:23040
    s_waitcnt lgkmcnt(6)
    v_mfma_f32_32x32x16_bf16 v[128:143], v[176:179], v[40:43], v[128:143]
    s_cmp_ge_u32 s58, 4
    s_cbranch_scc1 L_vw8
    s_waitcnt vmcnt(9)
L_vw8:
    s_barrier
    ds_read_b64_tr_b16 v[160:161], v6 offset:24576
    ds_read_b64_tr_b16 v[162:163], v6 offset:25088
    s_waitcnt lgkmcnt(6)
    v_mfma_f32_32x32x16_bf16 v[144:159], v[180:183], v[40:43], v[144:159]
    s_add_u32 m0, s59, 65536
    s_bfe_u32 s96, s75, 0x40018
    s_mul_i32 s96, s96, 229376
    s_add_u32 s96, s96, s67
    buffer_load_dwordx4 v3, s[16:19], s96 offen lds
    ds_read_b64_tr_b16 v[164:165], v8 offset:0
    ds_read_b64_tr_b16 v[166:167], v8 offset:512
    s_waitcnt lgkmcnt(6)
    v_mfma_f32_32x32x16_bf16 v[128:143], v[184:187], v[44:47], v[128:143]
    ds_read_b64_tr_b16 v[168:169], v6 offset:26624
    ds_read_b64_tr_b16 v[170:171], v6 offset:27136
    s_waitcnt lgkmcnt(6)
    v_mfma_f32_32x32x16_bf16 v[144:159], v[188:191], v[44:47], v[144:159]
    ds_read_b64_tr_b16 v[172:173], v8 offset:2048
    ds_read_b64_tr_b16 v[174:175], v8 offset:2560
    s_waitcnt lgkmcnt(6)
    v_mfma_f32_32x32x16_bf16 v[128:143], v[160:163], v[48:51], v[128:143]
    ds_read_b64_tr_b16 v[176:177], v6 offset:28672
    ds_read_b64_tr_b16 v[178:179], v6 offset:29184
    s_waitcnt lgkmcnt(6)
    v_mfma_f32_32x32x16_bf16 v[144:159], v[164:167], v[48:51], v[144:159]
    s_add_u32 m0, s59, 73728
    s_nop 0
    buffer_load_dwordx4 v3, s[20:23], s96 offen lds
    ds_read_b64_tr_b16 v[180:181], v8 offset:4096
    ds_read_b64_tr_b16 v[182:183], v8 offset:4608
    s_waitcnt lgkmcnt(6)
    v_mfma_f32_32x32x16_bf16 v[128:143], v[168:171], v[52:55], v[128:143]
    ds_read_b64_tr_b16 v[184:185], v6 offset:30720
    ds_read_b64_tr_b16 v[186:187], v6 offset:31232
    s_waitcnt lgkmcnt(6)
    v_mfma_f32_32x32x16_bf16 v[144:159], v[172:175], v[52:55], v[144:159]
    ds_read_b64_tr_b16 v[188:189], v8 offset:6144
    ds_read_b64_tr_b16 v[190:191], v8 offset:6656
    s_waitcnt lgkmcnt(6)
    v_mfma_f32_32x32x16_bf16 v[128:143], v[176:179], v[56:59], v[128:143]
    s_waitcnt vmcnt(5)
    s_barrier
    v_readfirstlane_b32 s76, v200
    s_nop 0
    s_cmp_lg_u32 s76, 0
    s_cbranch_scc1 L_tagok9
    s_mov_b32 s52, 0x8000
L_tagspin10:
    buffer_load_dword v200, v14, s[48:51], 0 offen sc1
    s_waitcnt vmcnt(0)
    v_readfirstlane_b32 s76, v200
    s_nop 0
    s_cmp_lg_u32 s76, 0
    s_cbranch_scc1 L_tagok9
    s_sleep 2
    s_sub_u32 s52, s52, 1
    s_cmp_lg_u32 s52, 0
    s_cbranch_scc1 L_tagspin10
L_tagok9:
    s_xor_b32 s77, s76, 0x5bd1e995
    v_mov_b32 v222, s76
    v_mov_b32 v223, s77
    s_cmp_lt_u32 s58, 4
    s_cbranch_scc1 L_p011
    s_add_u32 s60, s78, 512
    s_mov_b64 exec, 1
    buffer_store_dwordx2 v[222:223], v14, s[24:27], s78 offen sc1
    s_mov_b64 exec, -1
    s_mov_b64 exec, 1
    buffer_store_dwordx2 v[222:223], v14, s[24:27], s60 offen sc1
    s_mov_b64 exec, -1
L_p011:
    s_cmp_lt_u32 s58, 4
    s_cbranch_scc1 L_rdone12
    v_lshrrev_b32 v204, 5, v1
    v_and_b32 v205, 31, v1
    s_and_b32 s60, s2, 7
    s_lshr_b32 s61, s2, 3
    s_mul_i32 s82, s61, 37
    s_lshr_b32 s82, s82, 8
    s_mul_i32 s83, s82, 7
    s_sub_u32 s83, s61, s83
    s_lshl_b32 s60, s60, 2
    s_add_u32 s82, s82, s60
    s_and_b32 s60, s58, 3
    s_mul_i32 s87, s60, 26624
    v_lshrrev_b32 v206, 3, v1
    v_mul_u32_u24 v240, 896, v206
    v_and_b32 v206, 7, v1
    v_bfe_u32 v12, v1, 4, 1
    v_lshlrev_b32 v12, 2, v12
    v_xor_b32 v206, v206, v12
    v_lshl_add_u32 v240, v206, 4, v240
    v_bfe_u32 v206, v1, 2, 2
    v_lshl_add_u32 v12, v204, 2, v206
    v_lshlrev_b32 v242, 7, v12
    v_lshrrev_b32 v206, 1, v206
    v_lshl_add_u32 v242, v206, 6, v242
    v_bfe_u32 v206, v1, 4, 1
    v_lshl_add_u32 v242, v206, 5, v242
    v_and_b32 v206, 3, v1
    v_lshl_add_u32 v242, v206, 3, v242
    v_xor_b32 v243, 64, v242
    v_add_u32 v242, s87, v242
    v_add_u32 v243, s87, v243
    s_and_b32 s4, s82, 3
    s_lshl_b32 s4, s4, 1
    s_add_u32 s6, s4, s83
    s_cmp_ge_u32 s6, 7
    s_cselect_b32 s4, 7, 0
    s_sub_u32 s6, s6, s4
    s_lshl_b32 s6, s6, 2
    s_mov_b32 s4, 0x6543210
    s_mov_b32 s5, 0x654321
    s_lshr_b64 s[4:5], s[4:5], s6
    s_mov_b32 s88, s4
    s_mul_i32 s4, s60, 14
    v_add_u32 v206, s4, v205
    v_cmp_gt_u32 vcc, 14, v205
    s_nop 1
    v_cndmask_b32 v206, 56, v206, vcc
    s_lshl_b32 s5, s82, 1
    v_add_u32 v12, s5, v204
    v_lshl_add_u32 v244, v12, 6, v206
    v_lshlrev_b32 v244, 3, v244
    v_add_u32 v244, 24576, v244
    s_lshl_b32 s4, s60, 2
    v_and_b32 v206, 3, v1
    v_add_u32 v206, s4, v206
    v_lshl_add_u32 v245, v12, 4, v206
    v_lshlrev_b32 v245, 3, v245
    v_add_u32 v245, 57344, v245
L_rdone12:
    ds_read_b64_tr_b16 v[160:161], v6 offset:32768
    ds_read_b64_tr_b16 v[162:163], v6 offset:33280
    s_waitcnt lgkmcnt(6)
    v_mfma_f32_32x32x16_bf16 v[144:159], v[180:183], v[56:59], v[144:159]
    s_add_u32 m0, s59, 155648
    s_bfe_u32 s96, s75, 0x40000
    s_mul_i32 s96, s96, 229376
    s_add_u32 s96, s96, s68
    buffer_load_dwordx4 v3, s[16:19], s96 offen lds
    ds_read_b64_tr_b16 v[164:165], v6 offset:40960
    ds_read_b64_tr_b16 v[166:167], v6 offset:41472
    s_waitcnt lgkmcnt(6)
    v_mfma_f32_32x32x16_bf16 v[128:143], v[184:187], v[60:63], v[128:143]
    ds_read_b64_tr_b16 v[168:169], v6 offset:34816
    ds_read_b64_tr_b16 v[170:171], v6 offset:35328
    s_waitcnt lgkmcnt(6)
    v_mfma_f32_32x32x16_bf16 v[144:159], v[188:191], v[60:63], v[144:159]
    ds_read_b64_tr_b16 v[172:173], v6 offset:43008
    ds_read_b64_tr_b16 v[174:175], v6 offset:43520
    s_waitcnt lgkmcnt(6)
    v_mfma_f32_32x32x16_bf16 v[128:143], v[160:163], v[64:67], v[128:143]
    ds_read_b64_tr_b16 v[176:177], v6 offset:36864
    ds_read_b64_tr_b16 v[178:179], v6 offset:37376
    s_waitcnt lgkmcnt(6)
    v_mfma_f32_32x32x16_bf16 v[144:159], v[164:167], v[64:67], v[144:159]
    s_add_u32 m0, s59, 81920
    s_nop 0
    buffer_load_dwordx4 v3, s[20:23], s96 offen lds
    ds_read_b64_tr_b16 v[180:181], v6 offset:45056
    ds_read_b64_tr_b16 v[182:183], v6 offset:45568
    s_waitcnt lgkmcnt(6)
    v_mfma_f32_32x32x16_bf16 v[128:143], v[168:171], v[68:71], v[128:143]
    ds_read_b64_tr_b16 v[184:185], v6 offset:38912
    ds_read_b64_tr_b16 v[186:187], v6 offset:39424
    s_waitcnt lgkmcnt(6)
    v_mfma_f32_32x32x16_bf16 v[144:159], v[172:175], v[68:71], v[144:159]
    ds_read_b64_tr_b16 v[188:189], v6 offset:47104
    ds_read_b64_tr_b16 v[190:191], v6 offset:47616
    s_waitcnt lgkmcnt(6)
    v_mfma_f32_32x32x16_bf16 v[128:143], v[176:179], v[72:75], v[128:143]
    s_waitcnt vmcnt(6)
    s_barrier
    ds_read_b64_tr_b16 v[160:161], v8 offset:8192
    ds_read_b64_tr_b16 v[162:163], v8 offset:8704
    s_waitcnt lgkmcnt(6)
    v_mfma_f32_32x32x16_bf16 v[144:159], v[180:183], v[72:75], v[144:159]
    s_add_u32 m0, s59, 90112
    s_bfe_u32 s96, s75, 0x40004
    s_mul_i32 s96, s96, 229376
    s_add_u32 s96, s96, s68
    buffer_load_dwordx4 v3, s[16:19], s96 offen lds
    ds_read_b64_tr_b16 v[164:165], v6 offset:49152
    ds_read_b64_tr_b16 v[166:167], v6 offset:49664
    s_waitcnt lgkmcnt(6)
    v_mfma_f32_32x32x16_bf16 v[128:143], v[184:187], v[76:79], v[128:143]
    ds_read_b64_tr_b16 v[168:169], v8 offset:10240
    ds_read_b64_tr_b16 v[170:171], v8 offset:10752
    s_waitcnt lgkmcnt(6)
    v_mfma_f32_32x32x16_bf16 v[144:159], v[188:191], v[76:79], v[144:159]
    ds_read_b64_tr_b16 v[172:173], v6 offset:51200
    ds_read_b64_tr_b16 v[174:175], v6 offset:51712
    s_waitcnt lgkmcnt(6)
    v_mfma_f32_32x32x16_bf16 v[128:143], v[160:163], v[80:83], v[128:143]
    ds_read_b64_tr_b16 v[176:177], v8 offset:12288
    ds_read_b64_tr_b16 v[178:179], v8 offset:12800
    s_waitcnt lgkmcnt(6)
    v_mfma_f32_32x32x16_bf16 v[144:159], v[164:167], v[80:83], v[144:159]
    s_add_u32 m0, s59, 114688
    s_nop 0
    buffer_load_dwordx4 v3, s[20:23], s96 offen lds
    ds_read_b64_tr_b16 v[180:181], v6 offset:53248
    ds_read_b64_tr_b16 v[182:183], v6 offset:53760
    s_waitcnt lgkmcnt(6)
    v_mfma_f32_32x32x16_bf16 v[128:143], v[168:171], v[84:87], v[128:143]
    ds_read_b64_tr_b16 v[184:185], v8 offset:14336
    ds_read_b64_tr_b16 v[186:187], v8 offset:14848
    s_waitcnt lgkmcnt(6)
    v_mfma_f32_32x32x16_bf16 v[144:159], v[172:175], v[84:87], v[144:159]
    ds_read_b64_tr_b16 v[188:189], v6 offset:55296
    ds_read_b64_tr_b16 v[190:191], v6 offset:55808
    s_waitcnt lgkmcnt(6)
    v_mfma_f32_32x32x16_bf16 v[128:143], v[176:179], v[88:91], v[128:143]
    s_waitcnt vmcnt(6)
    s_barrier
    s_lshl_b32 s60, s2, 13
    v_lshlrev_b32 v192, 7, v1
    s_cmp_lg_u32 s58, 0
    s_cbranch_scc1 L_pwn14
    buffer_load_dword v203, v192, s[28:31], s60 offen
L_pwn14:
    s_cmp_lg_u32 s58, 1
    s_cbranch_scc1 L_pwn15
    buffer_load_dword v203, v192, s[32:35], s60 offen
L_pwn15:
    ds_read_b64_tr_b16 v[160:161], v6 offset:57344
    ds_read_b64_tr_b16 v[162:163], v6 offset:57856
    s_waitcnt lgkmcnt(6)
    v_mfma_f32_32x32x16_bf16 v[144:159], v[180:183], v[88:91], v[144:159]
    s_add_u32 m0, s59, 98304
    s_bfe_u32 s96, s75, 0x40008
    s_mul_i32 s96, s96, 229376
    s_add_u32 s96, s96, s68
    buffer_load_dwordx4 v3, s[16:19], s96 offen lds
    ds_read_b64_tr_b16 v[164:165], v8 offset:16384
    ds_read_b64_tr_b16 v[166:167], v8 offset:16896
    s_waitcnt lgkmcnt(6)
    v_mfma_f32_32x32x16_bf16 v[128:143], v[184:187], v[92:95], v[128:143]
    ds_read_b64_tr_b16 v[168:169], v6 offset:59392
    ds_read_b64_tr_b16 v[170:171], v6 offset:59904
    s_waitcnt lgkmcnt(6)
    v_mfma_f32_32x32x16_bf16 v[144:159], v[188:191], v[92:95], v[144:159]
    ds_read_b64_tr_b16 v[172:173], v8 offset:18432
    ds_read_b64_tr_b16 v[174:175], v8 offset:18944
    s_waitcnt lgkmcnt(6)
    v_mfma_f32_32x32x16_bf16 v[128:143], v[160:163], v[96:99], v[128:143]
    ds_read_b64_tr_b16 v[176:177], v6 offset:61440
    ds_read_b64_tr_b16 v[178:179], v6 offset:61952
    s_waitcnt lgkmcnt(6)
    v_mfma_f32_32x32x16_bf16 v[144:159], v[164:167], v[96:99], v[144:159]
    s_add_u32 m0, s59, 106496
    s_nop 0
    buffer_load_dwordx4 v3, s[20:23], s96 offen lds
    ds_read_b64_tr_b16 v[180:181], v8 offset:20480
    ds_read_b64_tr_b16 v[182:183], v8 offset:20992
    s_waitcnt lgkmcnt(6)
    v_mfma_f32_32x32x16_bf16 v[128:143], v[168:171], v[100:103], v[128:143]
    ds_read_b64_tr_b16 v[184:185], v6 offset:63488
    ds_read_b64_tr_b16 v[186:187], v6 offset:64000
    s_waitcnt lgkmcnt(6)
    v_mfma_f32_32x32x16_bf16 v[144:159], v[172:175], v[100:103], v[144:159]
    ds_read_b64_tr_b16 v[188:189], v8 offset:22528
    ds_read_b64_tr_b16 v[190:191], v8 offset:23040
    s_waitcnt lgkmcnt(6)
    v_mfma_f32_32x32x16_bf16 v[128:143], v[176:179], v[104:107], v[128:143]
    s_waitcnt vmcnt(6)
    s_barrier
    ds_read_b64_tr_b16 v[160:161], v7 offset:0
    ds_read_b64_tr_b16 v[162:163], v7 offset:512
    s_waitcnt lgkmcnt(6)
    v_mfma_f32_32x32x16_bf16 v[144:159], v[180:183], v[104:107], v[144:159]
    s_add_u32 m0, s59, 0
    s_bfe_u32 s96, s75, 0x4000c
    s_mul_i32 s96, s96, 229376
    s_add_u32 s96, s96, s68
    buffer_load_dwordx4 v3, s[16:19], s96 offen lds
    ds_read_b64_tr_b16 v[164:165], v7 offset:8192
    ds_read_b64_tr_b16 v[166:167], v7 offset:8704
    s_waitcnt lgkmcnt(6)
    v_mfma_f32_32x32x16_bf16 v[128:143], v[184:187], v[108:111], v[128:143]
    ds_read_b64_tr_b16 v[168:169], v7 offset:2048
    ds_read_b64_tr_b16 v[170:171], v7 offset:2560
    s_waitcnt lgkmcnt(6)
    v_mfma_f32_32x32x16_bf16 v[144:159], v[188:191], v[108:111], v[144:159]
    ds_read_b64_tr_b16 v[172:173], v7 offset:10240
    ds_read_b64_tr_b16 v[174:175], v7 offset:10752
    s_waitcnt lgkmcnt(6)
    v_mfma_f32_32x32x16_bf16 v[128:143], v[160:163], v[112:115], v[128:143]
    ds_read_b64_tr_b16 v[176:177], v7 offset:4096
    ds_read_b64_tr_b16 v[178:179], v7 offset:4608
    s_waitcnt lgkmcnt(6)
    v_mfma_f32_32x32x16_bf16 v[144:159], v[164:167], v[112:115], v[144:159]
    s_add_u32 m0, s59, 8192
    s_nop 0
    buffer_load_dwordx4 v3, s[20:23], s96 offen lds
    ds_read_b64_tr_b16 v[180:181], v7 offset:12288
    ds_read_b64_tr_b16 v[182:183], v7 offset:12800
    s_waitcnt lgkmcnt(6)
    v_mfma_f32_32x32x16_bf16 v[128:143], v[168:171], v[116:119], v[128:143]
    ds_read_b64_tr_b16 v[184:185], v7 offset:6144
    ds_read_b64_tr_b16 v[186:187], v7 offset:6656
    s_waitcnt lgkmcnt(6)
    v_mfma_f32_32x32x16_bf16 v[144:159], v[172:175], v[116:119], v[144:159]
    ds_read_b64_tr_b16 v[188:189], v7 offset:14336
    ds_read_b64_tr_b16 v[190:191], v7 offset:14848
    s_waitcnt lgkmcnt(6)
    v_mfma_f32_32x32x16_bf16 v[128:143], v[176:179], v[120:123], v[128:143]
    s_waitcnt vmcnt(6)
    s_barrier
    ds_read_b64_tr_b16 v[160:161], v8 offset:24576
    ds_read_b64_tr_b16 v[162:163], v8 offset:25088
    s_waitcnt lgkmcnt(6)
    v_mfma_f32_32x32x16_bf16 v[144:159], v[180:183], v[120:123], v[144:159]
    s_add_u32 m0, s59, 122880
    s_bfe_u32 s96, s75, 0x40010
    s_mul_i32 s96, s96, 229376
    s_add_u32 s96, s96, s68
    buffer_load_dwordx4 v3, s[16:19], s96 offen lds
    ds_read_b64_tr_b16 v[164:165], v7 offset:16384
    ds_read_b64_tr_b16 v[166:167], v7 offset:16896
    s_waitcnt lgkmcnt(6)
    v_mfma_f32_32x32x16_bf16 v[128:143], v[184:187], v[124:127], v[128:143]
    ds_read_b64_tr_b16 v[168:169], v8 offset:26624
    ds_read_b64_tr_b16 v[170:171], v8 offset:27136
    s_waitcnt lgkmcnt(6)
    v_mfma_f32_32x32x16_bf16 v[144:159], v[188:191], v[124:127], v[144:159]
    ds_read_b64_tr_b16 v[172:173], v7 offset:18432
    ds_read_b64_tr_b16 v[174:175], v7 offset:18944
    s_nop 5
    v_max_f32 v128, 0, v128
    v_max_f32 v129, 0, v129
    v_max_f32 v130, 0, v130
    v_max_f32 v131, 0, v131
    v_max_f32 v132, 0, v132
    v_max_f32 v133, 0, v133
    v_max_f32 v134, 0, v134
    v_max_f32 v135, 0, v135
    v_max_f32 v136, 0, v136
    v_max_f32 v137, 0, v137
    v_max_f32 v138, 0, v138
    v_max_f32 v139, 0, v139
    v_max_f32 v140, 0, v140
    v_max_f32 v141, 0, v141
    v_max_f32 v142, 0, v142
    v_max_f32 v143, 0, v143
    v_mul_f32 v128, v128, v144
    v_mul_f32 v129, v129, v145
    v_mul_f32 v130, v130, v146
    v_mul_f32 v131, v131, v147
    v_mul_f32 v132, v132, v148
    v_mul_f32 v133, v133, v149
    v_mul_f32 v134, v134, v150
    v_mul_f32 v135, v135, v151
    v_mul_f32 v136, v136, v152
    v_mul_f32 v137, v137, v153
    v_mul_f32 v138, v138, v154
    v_mul_f32 v139, v139, v155
    v_mul_f32 v140, v140, v156
    v_mul_f32 v141, v141, v157
    v_mul_f32 v142, v142, v158
    v_mul_f32 v143, v143, v159
    v_cvt_pk_bf16_f32 v192, v128, v129
    v_cvt_pk_bf16_f32 v193, v130, v131
    v_cvt_pk_bf16_f32 v194, v132, v133
    v_cvt_pk_bf16_f32 v195, v134, v135
    buffer_store_dwordx4 v[192:195], v11, s[24:27], s71 offen sc1
    v_cvt_pk_bf16_f32 v196, v136, v137
    v_cvt_pk_bf16_f32 v197, v138, v139
    v_cvt_pk_bf16_f32 v198, v140, v141
    v_cvt_pk_bf16_f32 v199, v142, v143
    buffer_store_dwordx4 v[196:199], v11, s[24:27], s71 offen offset:1024 sc1
    s_waitcnt lgkmcnt(6)
    v_mfma_f32_32x32x16_bf16 v[128:143], v[160:163], v[16:19], 0
    ds_read_b64_tr_b16 v[176:177], v8 offset:28672
    ds_read_b64_tr_b16 v[178:179], v8 offset:29184
    s_waitcnt lgkmcnt(6)
    v_mfma_f32_32x32x16_bf16 v[144:159], v[164:167], v[16:19], 0
    s_add_u32 m0, s59, 16384
    s_nop 0
    buffer_load_dwordx4 v3, s[20:23], s96 offen lds
    ds_read_b64_tr_b16 v[180:181], v7 offset:20480
    ds_read_b64_tr_b16 v[182:183], v7 offset:20992
    s_waitcnt lgkmcnt(6)
    v_mfma_f32_32x32x16_bf16 v[128:143], v[168:171], v[20:23], v[128:143]
    ds_read_b64_tr_b16 v[184:185], v8 offset:30720
    ds_read_b64_tr_b16 v[186:187], v8 offset:31232
    s_waitcnt lgkmcnt(6)
    v_mfma_f32_32x32x16_bf16 v[144:159], v[172:175], v[20:23], v[144:159]
    ds_read_b64_tr_b16 v[188:189], v7 offset:22528
    ds_read_b64_tr_b16 v[190:191], v7 offset:23040
    s_waitcnt lgkmcnt(6)
    v_mfma_f32_32x32x16_bf16 v[128:143], v[176:179], v[24:27], v[128:143]
    s_waitcnt vmcnt(8)
    s_barrier
    ds_read_b64_tr_b16 v[160:161], v7 offset:24576
    ds_read_b64_tr_b16 v[162:163], v7 offset:25088
    s_waitcnt lgkmcnt(6)
    v_mfma_f32_32x32x16_bf16 v[144:159], v[180:183], v[24:27], v[144:159]
    s_add_u32 m0, s59, 24576
    s_bfe_u32 s96, s75, 0x40014
    s_mul_i32 s96, s96, 229376
    s_add_u32 s96, s96, s68
    buffer_load_dwordx4 v3, s[16:19], s96 offen lds
    ds_read_b64_tr_b16 v[164:165], v7 offset:49152
    ds_read_b64_tr_b16 v[166:167], v7 offset:49664
    s_waitcnt lgkmcnt(6)
    v_mfma_f32_32x32x16_bf16 v[128:143], v[184:187], v[28:31], v[128:143]
    ds_read_b64_tr_b16 v[168:169], v7 offset:26624
    ds_read_b64_tr_b16 v[170:171], v7 offset:27136
    s_waitcnt lgkmcnt(6)
    v_mfma_f32_32x32x16_bf16 v[144:159], v[188:191], v[28:31], v[144:159]
    ds_read_b64_tr_b16 v[172:173], v7 offset:51200
    ds_read_b64_tr_b16 v[174:175], v7 offset:51712
    s_waitcnt lgkmcnt(6)
    v_mfma_f32_32x32x16_bf16 v[128:143], v[160:163], v[32:35], v[128:143]
    ds_read_b64_tr_b16 v[176:177], v7 offset:28672
    ds_read_b64_tr_b16 v[178:179], v7 offset:29184
    s_waitcnt lgkmcnt(6)
    v_mfma_f32_32x32x16_bf16 v[144:159], v[164:167], v[32:35], v[144:159]
    s_add_u32 m0, s59, 131072
    s_nop 0
    buffer_load_dwordx4 v3, s[20:23], s96 offen lds
    ds_read_b64_tr_b16 v[180:181], v7 offset:53248
    ds_read_b64_tr_b16 v[182:183], v7 offset:53760
    s_waitcnt lgkmcnt(6)
    v_mfma_f32_32x32x16_bf16 v[128:143], v[168:171], v[36:39], v[128:143]
    ds_read_b64_tr_b16 v[184:185], v7 offset:30720
    ds_read_b64_tr_b16 v[186:187], v7 offset:31232
    s_waitcnt lgkmcnt(6)
    v_mfma_f32_32x32x16_bf16 v[144:159], v[172:175], v[36:39], v[144:159]
    ds_read_b64_tr_b16 v[188:189], v7 offset:55296
    ds_read_b64_tr_b16 v[190:191], v7 offset:55808
    s_waitcnt lgkmcnt(6)
    v_mfma_f32_32x32x16_bf16 v[128:143], v[176:179], v[40:43], v[128:143]
    s_waitcnt vmcnt(8)
    s_barrier
    ds_read_b64_tr_b16 v[160:161], v7 offset:32768
    ds_read_b64_tr_b16 v[162:163], v7 offset:33280
    s_waitcnt lgkmcnt(6)
    v_mfma_f32_32x32x16_bf16 v[144:159], v[180:183], v[40:43], v[144:159]
    s_add_u32 m0, s59, 32768
    s_bfe_u32 s96, s75, 0x40018
    s_mul_i32 s96, s96, 229376
    s_add_u32 s96, s96, s68
    buffer_load_dwordx4 v3, s[16:19], s96 offen lds
    ds_read_b64_tr_b16 v[164:165], v7 offset:40960
    ds_read_b64_tr_b16 v[166:167], v7 offset:41472
    s_waitcnt lgkmcnt(6)
    v_mfma_f32_32x32x16_bf16 v[128:143], v[184:187], v[44:47], v[128:143]
    ds_read_b64_tr_b16 v[168:169], v7 offset:34816
    ds_read_b64_tr_b16 v[170:171], v7 offset:35328
    s_waitcnt lgkmcnt(6)
    v_mfma_f32_32x32x16_bf16 v[144:159], v[188:191], v[44:47], v[144:159]
    ds_read_b64_tr_b16 v[172:173], v7 offset:43008
    ds_read_b64_tr_b16 v[174:175], v7 offset:43520
    s_waitcnt lgkmcnt(6)
    v_mfma_f32_32x32x16_bf16 v[128:143], v[160:163], v[48:51], v[128:143]
    ds_read_b64_tr_b16 v[176:177], v7 offset:36864
    ds_read_b64_tr_b16 v[178:179], v7 offset:37376
    s_waitcnt lgkmcnt(6)
    v_mfma_f32_32x32x16_bf16 v[144:159], v[164:167], v[48:51], v[144:159]
    s_add_u32 m0, s59, 40960
    s_nop 0
    buffer_load_dwordx4 v3, s[20:23], s96 offen lds
    ds_read_b64_tr_b16 v[180:181], v7 offset:45056
    ds_read_b64_tr_b16 v[182:183], v7 offset:45568
    s_waitcnt lgkmcnt(6)
    v_mfma_f32_32x32x16_bf16 v[128:143], v[168:171], v[52:55], v[128:143]
    ds_read_b64_tr_b16 v[184:185], v7 offset:38912
    ds_read_b64_tr_b16 v[186:187], v7 offset:39424
    s_waitcnt lgkmcnt(6)
    v_mfma_f32_32x32x16_bf16 v[144:159], v[172:175], v[52:55], v[144:159]
    ds_read_b64_tr_b16 v[188:189], v7 offset:47104
    ds_read_b64_tr_b16 v[190:191], v7 offset:47616
    s_waitcnt lgkmcnt(6)
    v_mfma_f32_32x32x16_bf16 v[128:143], v[176:179], v[56:59], v[128:143]
    s_waitcnt vmcnt(5)
    s_barrier
    s_mov_b64 exec, 1
    buffer_store_dwordx2 v[222:223], v14, s[24:27], s79 offen sc1
    s_mov_b64 exec, -1
    ds_read_b64_tr_b16 v[160:161], v6 offset:0
    ds_read_b64_tr_b16 v[162:163], v6 offset:512
    s_waitcnt lgkmcnt(6)
    v_mfma_f32_32x32x16_bf16 v[144:159], v[180:183], v[56:59], v[144:159]
    ds_read_b64_tr_b16 v[164:165], v6 offset:8192
    ds_read_b64_tr_b16 v[166:167], v6 offset:8704
    s_waitcnt lgkmcnt(6)
    v_mfma_f32_32x32x16_bf16 v[128:143], v[184:187], v[60:63], v[128:143]
    ds_read_b64_tr_b16 v[168:169], v6 offset:2048
    ds_read_b64_tr_b16 v[170:171], v6 offset:2560
    s_waitcnt lgkmcnt(6)
    v_mfma_f32_32x32x16_bf16 v[144:159], v[188:191], v[60:63], v[144:159]
    ds_read_b64_tr_b16 v[172:173], v6 offset:10240
    ds_read_b64_tr_b16 v[174:175], v6 offset:10752
    s_waitcnt lgkmcnt(6)
    v_mfma_f32_32x32x16_bf16 v[128:143], v[160:163], v[64:67], v[128:143]
    ds_read_b64_tr_b16 v[176:177], v6 offset:4096
    ds_read_b64_tr_b16 v[178:179], v6 offset:4608
    s_waitcnt lgkmcnt(6)
    v_mfma_f32_32x32x16_bf16 v[144:159], v[164:167], v[64:67], v[144:159]
    ds_read_b64_tr_b16 v[180:181], v6 offset:12288
    ds_read_b64_tr_b16 v[182:183], v6 offset:12800
    s_waitcnt lgkmcnt(6)
    v_mfma_f32_32x32x16_bf16 v[128:143], v[168:171], v[68:71], v[128:143]
    ds_read_b64_tr_b16 v[184:185], v6 offset:6144
    ds_read_b64_tr_b16 v[186:187], v6 offset:6656
    s_waitcnt lgkmcnt(6)
    v_mfma_f32_32x32x16_bf16 v[144:159], v[172:175], v[68:71], v[144:159]
    ds_read_b64_tr_b16 v[188:189], v6 offset:14336
    ds_read_b64_tr_b16 v[190:191], v6 offset:14848
    s_waitcnt lgkmcnt(6)
    v_mfma_f32_32x32x16_bf16 v[128:143], v[176:179], v[72:75], v[128:143]
    s_waitcnt vmcnt(5)
    s_barrier
    ds_read_b64_tr_b16 v[160:161], v7 offset:57344
    ds_read_b64_tr_b16 v[162:163], v7 offset:57856
    s_waitcnt lgkmcnt(6)
    v_mfma_f32_32x32x16_bf16 v[144:159], v[180:183], v[72:75], v[144:159]
    ds_read_b64_tr_b16 v[164:165], v6 offset:16384
    ds_read_b64_tr_b16 v[166:167], v6 offset:16896
    s_waitcnt lgkmcnt(6)
    v_mfma_f32_32x32x16_bf16 v[128:143], v[184:187], v[76:79], v[128:143]
    ds_read_b64_tr_b16 v[168:169], v7 offset:59392
    ds_read_b64_tr_b16 v[170:171], v7 offset:59904
    s_waitcnt lgkmcnt(6)
    v_mfma_f32_32x32x16_bf16 v[144:159], v[188:191], v[76:79], v[144:159]
    ds_read_b64_tr_b16 v[172:173], v6 offset:18432
    ds_read_b64_tr_b16 v[174:175], v6 offset:18944
    s_waitcnt lgkmcnt(6)
    v_mfma_f32_32x32x16_bf16 v[128:143], v[160:163], v[80:83], v[128:143]
    ds_read_b64_tr_b16 v[176:177], v7 offset:61440
    ds_read_b64_tr_b16 v[178:179], v7 offset:61952
    s_waitcnt lgkmcnt(6)
    v_mfma_f32_32x32x16_bf16 v[144:159], v[164:167], v[80:83], v[144:159]
    ds_read_b64_tr_b16 v[180:181], v6 offset:20480
    ds_read_b64_tr_b16 v[182:183], v6 offset:20992
    s_waitcnt lgkmcnt(6)
    v_mfma_f32_32x32x16_bf16 v[128:143], v[168:171], v[84:87], v[128:143]
    ds_read_b64_tr_b16 v[184:185], v7 offset:63488
    ds_read_b64_tr_b16 v[186:187], v7 offset:64000
    s_waitcnt lgkmcnt(6)
    v_mfma_f32_32x32x16_bf16 v[144:159], v[172:175], v[84:87], v[144:159]
    ds_read_b64_tr_b16 v[188:189], v6 offset:22528
    ds_read_b64_tr_b16 v[190:191], v6 offset:23040
    s_waitcnt lgkmcnt(6)
    v_mfma_f32_32x32x16_bf16 v[128:143], v[176:179], v[88:91], v[128:143]
    s_waitcnt vmcnt(3)
    s_barrier
    s_mov_b32 s60, 15007744
    buffer_load_dwordx2 v[216:217], v242, s[24:27], s60 offen sc1
    buffer_load_dwordx2 v[218:219], v243, s[24:27], s60 offen sc1
    ds_read_b64_tr_b16 v[160:161], v6 offset:24576
    ds_read_b64_tr_b16 v[162:163], v6 offset:25088
    s_waitcnt lgkmcnt(6)
    v_mfma_f32_32x32x16_bf16 v[144:159], v[180:183], v[88:91], v[144:159]
    ds_read_b64_tr_b16 v[164:165], v8 offset:0
    ds_read_b64_tr_b16 v[166:167], v8 offset:512
    s_waitcnt lgkmcnt(6)
    v_mfma_f32_32x32x16_bf16 v[128:143], v[184:187], v[92:95], v[128:143]
    ds_read_b64_tr_b16 v[168:169], v6 offset:26624
    ds_read_b64_tr_b16 v[170:171], v6 offset:27136
    s_waitcnt lgkmcnt(6)
    v_mfma_f32_32x32x16_bf16 v[144:159], v[188:191], v[92:95], v[144:159]
    ds_read_b64_tr_b16 v[172:173], v8 offset:2048
    ds_read_b64_tr_b16 v[174:175], v8 offset:2560
    s_waitcnt lgkmcnt(6)
    v_mfma_f32_32x32x16_bf16 v[128:143], v[160:163], v[96:99], v[128:143]
    ds_read_b64_tr_b16 v[176:177], v6 offset:28672
    ds_read_b64_tr_b16 v[178:179], v6 offset:29184
    s_waitcnt lgkmcnt(6)
    v_mfma_f32_32x32x16_bf16 v[144:159], v[164:167], v[96:99], v[144:159]
    ds_read_b64_tr_b16 v[180:181], v8 offset:4096
    ds_read_b64_tr_b16 v[182:183], v8 offset:4608
    s_waitcnt lgkmcnt(6)
    v_mfma_f32_32x32x16_bf16 v[128:143], v[168:171], v[100:103], v[128:143]
    ds_read_b64_tr_b16 v[184:185], v6 offset:30720
    ds_read_b64_tr_b16 v[186:187], v6 offset:31232
    s_waitcnt lgkmcnt(6)
    v_mfma_f32_32x32x16_bf16 v[144:159], v[172:175], v[100:103], v[144:159]
    ds_read_b64_tr_b16 v[188:189], v8 offset:6144
    ds_read_b64_tr_b16 v[190:191], v8 offset:6656
    s_waitcnt lgkmcnt(6)
    v_mfma_f32_32x32x16_bf16 v[128:143], v[176:179], v[104:107], v[128:143]
    s_waitcnt vmcnt(3)
    s_barrier
    s_mov_b32 s3, 159744
    v_mov_b32 v204, s3
    ds_write_b32 v204, v14
    ds_write_b32 v204, v14 offset:4
    ds_read_b64_tr_b16 v[160:161], v6 offset:32768
    ds_read_b64_tr_b16 v[162:163], v6 offset:33280
    s_waitcnt lgkmcnt(8)
    v_mfma_f32_32x32x16_bf16 v[144:159], v[180:183], v[104:107], v[144:159]
    ds_read_b64_tr_b16 v[164:165], v6 offset:40960
    ds_read_b64_tr_b16 v[166:167], v6 offset:41472
    s_waitcnt lgkmcnt(8)
    v_mfma_f32_32x32x16_bf16 v[128:143], v[184:187], v[108:111], v[128:143]
    ds_read_b64_tr_b16 v[168:169], v6 offset:34816
    ds_read_b64_tr_b16 v[170:171], v6 offset:35328
    s_waitcnt lgkmcnt(8)
    v_mfma_f32_32x32x16_bf16 v[144:159], v[188:191], v[108:111], v[144:159]
    ds_read_b64_tr_b16 v[172:173], v6 offset:43008
    ds_read_b64_tr_b16 v[174:175], v6 offset:43520
    s_waitcnt lgkmcnt(6)
    v_mfma_f32_32x32x16_bf16 v[128:143], v[160:163], v[112:115], v[128:143]
    ds_read_b64_tr_b16 v[176:177], v6 offset:36864
    ds_read_b64_tr_b16 v[178:179], v6 offset:37376
    s_waitcnt lgkmcnt(6)
    v_mfma_f32_32x32x16_bf16 v[144:159], v[164:167], v[112:115], v[144:159]
    ds_read_b64_tr_b16 v[180:181], v6 offset:45056
    ds_read_b64_tr_b16 v[182:183], v6 offset:45568
    s_waitcnt lgkmcnt(6)
    v_mfma_f32_32x32x16_bf16 v[128:143], v[168:171], v[116:119], v[128:143]
    ds_read_b64_tr_b16 v[184:185], v6 offset:38912
    ds_read_b64_tr_b16 v[186:187], v6 offset:39424
    s_waitcnt lgkmcnt(6)
    v_mfma_f32_32x32x16_bf16 v[144:159], v[172:175], v[116:119], v[144:159]
    ds_read_b64_tr_b16 v[188:189], v6 offset:47104
    ds_read_b64_tr_b16 v[190:191], v6 offset:47616
    s_mov_b32 s91, 0
    s_cmp_ge_u32 s58, 4
    s_cbranch_scc1 L_eh16
    s_waitcnt vmcnt(0)
    v_cmp_ne_u32 vcc, s76, v216
    v_cmp_ne_u32 s[4:5], s77, v217
    s_nop 0
    s_or_b64 vcc, vcc, s[4:5]
    s_cbranch_vccnz L_eh16
    v_cmp_ne_u32 vcc, s76, v218
    v_cmp_ne_u32 s[4:5], s77, v219
    s_nop 0
    s_or_b64 vcc, vcc, s[4:5]
    s_cbranch_vccnz L_eh16
    buffer_load_dwordx4 v[48:51], v240, s[44:47], s84 offen sc1
    buffer_load_dwordx4 v[52:55], v248, s[44:47], s84 offen sc1
    buffer_load_dwordx4 v[56:59], v241, s[44:47], s86 offen sc1
    buffer_load_dwordx4 v[60:63], v249, s[44:47], s86 offen sc1
    s_add_u32 s84, s84, 512
    s_and_b32 s84, s84, 8191
    s_mul_i32 s86, s84, 57
    s_lshl_b32 s4, s89, 15
    s_lshl_b32 s5, s83, 11
    s_add_u32 s4, s4, s5
    s_add_u32 s5, s58, 1
    s_and_b32 s5, s5, 3
    s_lshl_b32 s5, s5, 9
    s_add_u32 s5, s5, s4
    s_add_u32 s6, s5, 65536
    buffer_load_dwordx4 v[16:19], v250, s[24:27], s5 offen sc1
    buffer_load_dwordx4 v[20:23], v250, s[24:27], s6 offen sc1
    s_add_u32 s5, s58, 2
    s_and_b32 s5, s5, 3
    s_lshl_b32 s5, s5, 9
    s_add_u32 s5, s5, s4
    s_add_u32 s6, s5, 65536
    buffer_load_dwordx4 v[24:27], v250, s[24:27], s5 offen sc1
    buffer_load_dwordx4 v[28:31], v250, s[24:27], s6 offen sc1
    s_add_u32 s5, s58, 3
    s_and_b32 s5, s5, 3
    s_lshl_b32 s5, s5, 9
    s_add_u32 s5, s5, s4
    s_add_u32 s6, s5, 65536
    buffer_load_dwordx4 v[32:35], v250, s[24:27], s5 offen sc1
    buffer_load_dwordx4 v[36:39], v250, s[24:27], s6 offen sc1
    s_add_u32 s5, s58, 4
    s_and_b32 s5, s5, 3
    s_lshl_b32 s5, s5, 9
    s_add_u32 s5, s5, s4
    s_add_u32 s6, s5, 65536
    buffer_load_dwordx4 v[40:43], v250, s[24:27], s5 offen sc1
    buffer_load_dwordx4 v[44:47], v250, s[24:27], s6 offen sc1
    s_lshl_b32 s4, s83, 2
    s_add_u32 s4, s4, s58
    s_lshl_b32 s4, s4, 7
    s_add_u32 s4, s4, 14942208
    v_and_b32 v246, 31, v1
    v_lshlrev_b32 v246, 2, v246
    buffer_load_dword v246, v246, s[24:27], s4 offen sc1
    s_mov_b32 s91, 1
L_eh16:
    s_waitcnt lgkmcnt(6)
    v_mfma_f32_32x32x16_bf16 v[128:143], v[176:179], v[120:123], v[128:143]
    s_waitcnt lgkmcnt(4)
    v_mfma_f32_32x32x16_bf16 v[144:159], v[180:183], v[120:123], v[144:159]
    s_waitcnt lgkmcnt(2)
    v_mfma_f32_32x32x16_bf16 v[128:143], v[184:187], v[124:127], v[128:143]
    s_waitcnt lgkmcnt(0)
    v_mfma_f32_32x32x16_bf16 v[144:159], v[188:191], v[124:127], v[144:159]
L_tail:
    s_waitcnt lgkmcnt(0)
    s_barrier
    s_cmp_ge_u32 s58, 4
    s_cbranch_scc1 L_dphase
    s_setprio 1
    s_cmp_eq_u32 s91, 0
    s_cbranch_scc1 L_aspin17
L_ago18:
    v_and_b32 v114, 31, v1
    s_lshl_b32 s63, s83, 2
    s_add_u32 s63, s63, s58
    v_max_f32 v128, 0, v128
    v_max_f32 v129, 0, v129
    v_max_f32 v130, 0, v130
    v_max_f32 v131, 0, v131
    v_max_f32 v132, 0, v132
    v_max_f32 v133, 0, v133
    v_max_f32 v134, 0, v134
    v_max_f32 v135, 0, v135
    v_max_f32 v136, 0, v136
    v_max_f32 v137, 0, v137
    v_max_f32 v138, 0, v138
    v_max_f32 v139, 0, v139
    v_max_f32 v140, 0, v140
    v_max_f32 v141, 0, v141
    v_max_f32 v142, 0, v142
    v_max_f32 v143, 0, v143
    v_mul_f32 v128, v128, v144
    v_mul_f32 v129, v129, v145
    v_mul_f32 v130, v130, v146
    v_mul_f32 v131, v131, v147
    v_mul_f32 v132, v132, v148
    v_mul_f32 v133, v133, v149
    v_mul_f32 v134, v134, v150
    v_mul_f32 v135, v135, v151
    v_mul_f32 v136, v136, v152
    v_mul_f32 v137, v137, v153
    v_mul_f32 v138, v138, v154
    v_mul_f32 v139, v139, v155
    v_mul_f32 v140, v140, v156
    v_mul_f32 v141, v141, v157
    v_mul_f32 v142, v142, v158
    v_mul_f32 v143, v143, v159
    v_cvt_pk_bf16_f32 v192, v128, v129
    v_cvt_pk_bf16_f32 v193, v130, v131
    v_cvt_pk_bf16_f32 v194, v132, v133
    v_cvt_pk_bf16_f32 v195, v134, v135
    buffer_store_dwordx4 v[192:195], v11, s[24:27], s53 offen sc1
    v_cvt_pk_bf16_f32 v196, v136, v137
    v_cvt_pk_bf16_f32 v197, v138, v139
    v_cvt_pk_bf16_f32 v198, v140, v141
    v_cvt_pk_bf16_f32 v199, v142, v143
    buffer_store_dwordx4 v[196:199], v11, s[24:27], s53 offen offset:1024 sc1
    v_mov_b32 v112, v222
    v_mov_b32 v113, v223
    s_mul_i32 s94, s63, 147456
    s_lshl_b32 s61, s82, 11
    s_add_u32 s94, s94, s61
    s_add_u32 s94, s94, 5619712
    s_lshl_b32 s95, s63, 4
    s_add_u32 s95, s95, s82
    s_lshl_b32 s95, s95, 3
    s_add_u32 s95, s95, 15065088
    v_mov_b32 v104, 0
    v_mov_b32 v105, 0
    v_mov_b32 v106, 0
    v_mov_b32 v107, 0
    v_mov_b32 v108, 0
    v_mov_b32 v109, 0
    v_mov_b32 v110, 0
    v_mov_b32 v111, 0
    buffer_load_dwordx4 v[64:67], v240, s[44:47], s84 offen sc1
    buffer_load_dwordx4 v[68:71], v248, s[44:47], s84 offen sc1
    buffer_load_dwordx4 v[72:75], v241, s[44:47], s86 offen sc1
    buffer_load_dwordx4 v[76:79], v249, s[44:47], s86 offen sc1
    s_add_u32 s84, s84, 512
    s_and_b32 s84, s84, 8191
    s_mul_i32 s86, s84, 57
    v_mov_b32 v128, 0
    v_mov_b32 v129, 0
    v_mov_b32 v130, 0
    v_mov_b32 v131, 0
    v_mov_b32 v132, 0
    v_mov_b32 v133, 0
    v_mov_b32 v134, 0
    v_mov_b32 v135, 0
    v_mov_b32 v136, 0
    v_mov_b32 v137, 0
    v_mov_b32 v138, 0
    v_mov_b32 v139, 0
    v_mov_b32 v140, 0
    v_mov_b32 v141, 0
    v_mov_b32 v142, 0
    v_mov_b32 v143, 0
    v_mov_b32 v144, 0
    v_mov_b32 v145, 0
    v_mov_b32 v146, 0
    v_mov_b32 v147, 0
    v_mov_b32 v148, 0
    v_mov_b32 v149, 0
    v_mov_b32 v150, 0
    v_mov_b32 v151, 0
    v_mov_b32 v152, 0
    v_mov_b32 v153, 0
    v_mov_b32 v154, 0
    v_mov_b32 v155, 0
    v_mov_b32 v156, 0
    v_mov_b32 v157, 0
    v_mov_b32 v158, 0
    v_mov_b32 v159, 0
    v_mov_b32 v160, 0
    v_mov_b32 v161, 0
    v_mov_b32 v162, 0
    v_mov_b32 v163, 0
    v_mov_b32 v164, 0
    v_mov_b32 v165, 0
    v_mov_b32 v166, 0
    v_mov_b32 v167, 0
    v_mov_b32 v168, 0
    v_mov_b32 v169, 0
    v_mov_b32 v170, 0
    v_mov_b32 v171, 0
    v_mov_b32 v172, 0
    v_mov_b32 v173, 0
    v_mov_b32 v174, 0
    v_mov_b32 v175, 0
    v_mov_b32 v176, 0
    v_mov_b32 v177, 0
    v_mov_b32 v178, 0
    v_mov_b32 v179, 0
    v_mov_b32 v180, 0
    v_mov_b32 v181, 0
    v_mov_b32 v182, 0
    v_mov_b32 v183, 0
    v_mov_b32 v184, 0
    v_mov_b32 v185, 0
    v_mov_b32 v186, 0
    v_mov_b32 v187, 0
    v_mov_b32 v188, 0
    v_mov_b32 v189, 0
    v_mov_b32 v190, 0
    v_mov_b32 v191, 0
    v_mov_b32 v232, 0
    v_mov_b32 v233, 0
    v_mov_b32 v234, 0
    v_mov_b32 v235, 0
    v_mov_b32 v236, 0
    v_mov_b32 v237, 0
    v_mov_b32 v238, 0
    v_mov_b32 v239, 0
    buffer_load_dwordx4 v[80:83], v240, s[44:47], s84 offen sc1
    buffer_load_dwordx4 v[84:87], v248, s[44:47], s84 offen sc1
    buffer_load_dwordx4 v[88:91], v241, s[44:47], s86 offen sc1
    buffer_load_dwordx4 v[92:95], v249, s[44:47], s86 offen sc1
    s_add_u32 s84, s84, 512
    s_and_b32 s84, s84, 8191
    s_mul_i32 s86, s84, 57
    s_add_u32 s61, s58, 1
    s_and_b32 s61, s61, 3
    s_mul_i32 s61, s61, 12288
    s_add_u32 s61, s61, 106496
    v_add_u32 v123, s61, v11
    s_add_u32 s61, s58, 2
    s_and_b32 s61, s61, 3
    s_mul_i32 s61, s61, 12288
    s_add_u32 s61, s61, 110592
    v_add_u32 v124, s61, v11
    s_add_u32 s61, s58, 3
    s_and_b32 s61, s61, 3
    s_mul_i32 s61, s61, 12288
    s_add_u32 s61, s61, 114688
    v_add_u32 v125, s61, v11
    s_mul_i32 s61, s58, 12288
    s_add_u32 s61, s61, 106496
    v_add_u32 v126, s61, v11
    v_mov_b32 v127, s3
    s_mov_b32 s88, 4
    s_waitcnt vmcnt(10)
    v_and_b32 v16, v16, v244
    v_and_b32 v17, v17, v244
    v_and_b32 v22, v22, v245
    v_and_b32 v23, v23, v245
    v_and_b32 v24, v24, v244
    v_and_b32 v25, v25, v244
    v_and_b32 v30, v30, v245
    v_and_b32 v31, v31, v245
    v_and_b32 v32, v32, v244
    v_and_b32 v33, v33, v244
    v_and_b32 v38, v38, v245
    v_and_b32 v39, v39, v245
    v_and_b32 v40, v40, v244
    v_and_b32 v41, v41, v244
    v_and_b32 v46, v46, v245
    v_and_b32 v47, v47, v245
    v_mfma_f32_32x32x16_bf16 v[192:207], v[48:51], v[16:19], 0
    v_mfma_f32_32x32x16_bf16 v[192:207], v[52:55], v[20:23], v[192:207]
    s_nop 7
.p2align 3
L_c_loop:
    v_mfma_f32_32x32x16_bf16 v[176:191], v[104:107], v[232:235], v[176:191]
    s_nop 2
    v_exp_f32 v192, v192
    v_exp_f32 v193, v193
    v_exp_f32 v194, v194
    v_mfma_f32_32x32x16_bf16 v[176:191], v[108:111], v[236:239], v[176:191]
    v_exp_f32 v195, v195
    v_exp_f32 v196, v196
    v_exp_f32 v197, v197
    v_mfma_f32_32x32x16_bf16 v[208:223], v[48:51], v[24:27], 0
    v_exp_f32 v198, v198
    v_exp_f32 v199, v199
    v_cvt_pk_bf16_f32 v224, v192, v193
    v_cvt_pk_bf16_f32 v225, v194, v195
    v_mfma_f32_32x32x16_bf16 v[208:223], v[52:55], v[28:31], v[208:223]
    v_exp_f32 v200, v200
    v_exp_f32 v201, v201
    v_cvt_pk_bf16_f32 v226, v196, v197
    v_exp_f32 v202, v202
    v_exp_f32 v203, v203
    v_cvt_pk_bf16_f32 v227, v198, v199
    v_exp_f32 v204, v204
    v_exp_f32 v205, v205
    v_cvt_pk_bf16_f32 v228, v200, v201
    v_exp_f32 v206, v206
    v_exp_f32 v207, v207
    v_cvt_pk_bf16_f32 v229, v202, v203
    v_cvt_pk_bf16_f32 v230, v204, v205
    v_cvt_pk_bf16_f32 v231, v206, v207
    v_mfma_f32_32x32x16_bf16 v[128:143], v[56:59], v[224:227], v[128:143]
    buffer_load_dwordx4 v[96:99], v240, s[44:47], s84 offen sc1
    v_exp_f32 v208, v208
    v_exp_f32 v209, v209
    v_exp_f32 v210, v210
    v_mfma_f32_32x32x16_bf16 v[128:143], v[60:63], v[228:231], v[128:143]
    buffer_load_dwordx4 v[100:103], v248, s[44:47], s84 offen sc1
    v_exp_f32 v211, v211
    v_exp_f32 v212, v212
    v_exp_f32 v213, v213
    v_mfma_f32_32x32x16_bf16 v[192:207], v[48:51], v[32:35], 0
    buffer_load_dwordx4 v[104:107], v241, s[44:47], s86 offen sc1
    v_exp_f32 v214, v214
    v_exp_f32 v215, v215
    v_cvt_pk_bf16_f32 v232, v208, v209
    v_cvt_pk_bf16_f32 v233, v210, v211
    v_mfma_f32_32x32x16_bf16 v[192:207], v[52:55], v[36:39], v[192:207]
    buffer_load_dwordx4 v[108:111], v249, s[44:47], s86 offen sc1
    v_exp_f32 v216, v216
    v_exp_f32 v217, v217
    v_cvt_pk_bf16_f32 v234, v212, v213
    v_exp_f32 v218, v218
    v_exp_f32 v219, v219
    v_cvt_pk_bf16_f32 v235, v214, v215
    v_exp_f32 v220, v220
    v_exp_f32 v221, v221
    v_cvt_pk_bf16_f32 v236, v216, v217
    v_exp_f32 v222, v222
    v_exp_f32 v223, v223
    v_cvt_pk_bf16_f32 v237, v218, v219
    v_cvt_pk_bf16_f32 v238, v220, v221
    v_cvt_pk_bf16_f32 v239, v222, v223
    v_mfma_f32_32x32x16_bf16 v[144:159], v[56:59], v[232:235], v[144:159]
    s_add_u32 s84, s84, 512
    v_exp_f32 v192, v192
    v_exp_f32 v193, v193
    v_exp_f32 v194, v194
    v_mfma_f32_32x32x16_bf16 v[144:159], v[60:63], v[236:239], v[144:159]
    s_and_b32 s84, s84, 8191
    v_exp_f32 v195, v195
    v_exp_f32 v196, v196
    v_exp_f32 v197, v197
    v_mfma_f32_32x32x16_bf16 v[208:223], v[48:51], v[40:43], 0
    s_mul_i32 s86, s84, 57
    v_exp_f32 v198, v198
    v_exp_f32 v199, v199
    v_cvt_pk_bf16_f32 v224, v192, v193
    v_cvt_pk_bf16_f32 v225, v194, v195
    v_mfma_f32_32x32x16_bf16 v[208:223], v[52:55], v[44:47], v[208:223]
    v_exp_f32 v200, v200
    v_exp_f32 v201, v201
    v_cvt_pk_bf16_f32 v226, v196, v197
    v_exp_f32 v202, v202
    v_exp_f32 v203, v203
    v_cvt_pk_bf16_f32 v227, v198, v199
    v_exp_f32 v204, v204
    v_exp_f32 v205, v205
    v_cvt_pk_bf16_f32 v228, v200, v201
    v_exp_f32 v206, v206
    v_exp_f32 v207, v207
    v_cvt_pk_bf16_f32 v229, v202, v203
    v_cvt_pk_bf16_f32 v230, v204, v205
    v_cvt_pk_bf16_f32 v231, v206, v207
    v_mfma_f32_32x32x16_bf16 v[160:175], v[56:59], v[224:227], v[160:175]
    v_exp_f32 v208, v208
    v_exp_f32 v209, v209
    v_exp_f32 v210, v210
    v_mfma_f32_32x32x16_bf16 v[160:175], v[60:63], v[228:231], v[160:175]
    s_waitcnt vmcnt(8)
    s_cmp_lg_u32 s88, 4
    s_cbranch_scc1 L_pub20
    s_mov_b64 exec, 1
    buffer_store_dwordx2 v[112:113], v14, s[24:27], s54 offen sc1
    s_mov_b64 exec, -1
L_pub20:
    v_exp_f32 v211, v211
    v_exp_f32 v212, v212
    v_exp_f32 v213, v213
    v_mfma_f32_32x32x16_bf16 v[192:207], v[64:67], v[16:19], 0
    v_exp_f32 v214, v214
    v_exp_f32 v215, v215
    v_cvt_pk_bf16_f32 v232, v208, v209
    v_cvt_pk_bf16_f32 v233, v210, v211
    v_mfma_f32_32x32x16_bf16 v[192:207], v[68:71], v[20:23], v[192:207]
    v_exp_f32 v216, v216
    v_exp_f32 v217, v217
    v_cvt_pk_bf16_f32 v234, v212, v213
    v_exp_f32 v218, v218
    v_exp_f32 v219, v219
    v_cvt_pk_bf16_f32 v235, v214, v215
    v_exp_f32 v220, v220
    v_exp_f32 v221, v221
    v_cvt_pk_bf16_f32 v236, v216, v217
    v_exp_f32 v222, v222
    v_exp_f32 v223, v223
    v_cvt_pk_bf16_f32 v237, v218, v219
    v_cvt_pk_bf16_f32 v238, v220, v221
    v_cvt_pk_bf16_f32 v239, v222, v223
    v_mfma_f32_32x32x16_bf16 v[176:191], v[56:59], v[232:235], v[176:191]
    s_cmp_eq_u32 s88, 1
    v_exp_f32 v192, v192
    v_exp_f32 v193, v193
    v_exp_f32 v194, v194
    v_mfma_f32_32x32x16_bf16 v[176:191], v[60:63], v[236:239], v[176:191]
    s_cselect_b32 s46, 0, s46
    v_exp_f32 v195, v195
    v_exp_f32 v196, v196
    v_exp_f32 v197, v197
    v_mfma_f32_32x32x16_bf16 v[208:223], v[64:67], v[24:27], 0
    v_exp_f32 v198, v198
    v_exp_f32 v199, v199
    v_cvt_pk_bf16_f32 v224, v192, v193
    v_cvt_pk_bf16_f32 v225, v194, v195
    v_mfma_f32_32x32x16_bf16 v[208:223], v[68:71], v[28:31], v[208:223]
    v_exp_f32 v200, v200
    v_exp_f32 v201, v201
    v_cvt_pk_bf16_f32 v226, v196, v197
    v_exp_f32 v202, v202
    v_exp_f32 v203, v203
    v_cvt_pk_bf16_f32 v227, v198, v199
    v_exp_f32 v204, v204
    v_exp_f32 v205, v205
    v_cvt_pk_bf16_f32 v228, v200, v201
    v_exp_f32 v206, v206
    v_exp_f32 v207, v207
    v_cvt_pk_bf16_f32 v229, v202, v203
    v_cvt_pk_bf16_f32 v230, v204, v205
    v_cvt_pk_bf16_f32 v231, v206, v207
    v_mfma_f32_32x32x16_bf16 v[128:143], v[72:75], v[224:227], v[128:143]
    buffer_load_dwordx4 v[48:51], v240, s[44:47], s84 offen sc1
    v_exp_f32 v208, v208
    v_exp_f32 v209, v209
    v_exp_f32 v210, v210
    v_mfma_f32_32x32x16_bf16 v[128:143], v[76:79], v[228:231], v[128:143]
    buffer_load_dwordx4 v[52:55], v248, s[44:47], s84 offen sc1
    s_cmp_lg_u32 s88, 1
    s_cbranch_scc1 L_go21
    ds_write_b32 v127, v127 offset:4
L_go21:
    v_exp_f32 v211, v211
    v_exp_f32 v212, v212
    v_exp_f32 v213, v213
    v_mfma_f32_32x32x16_bf16 v[192:207], v[64:67], v[32:35], 0
    buffer_load_dwordx4 v[56:59], v241, s[44:47], s86 offen sc1
    v_exp_f32 v214, v214
    v_exp_f32 v215, v215
    v_cvt_pk_bf16_f32 v232, v208, v209
    v_cvt_pk_bf16_f32 v233, v210, v211
    v_mfma_f32_32x32x16_bf16 v[192:207], v[68:71], v[36:39], v[192:207]
    buffer_load_dwordx4 v[60:63], v249, s[44:47], s86 offen sc1
    v_exp_f32 v216, v216
    v_exp_f32 v217, v217
    v_cvt_pk_bf16_f32 v234, v212, v213
    v_exp_f32 v218, v218
    v_exp_f32 v219, v219
    v_cvt_pk_bf16_f32 v235, v214, v215
    v_exp_f32 v220, v220
    v_exp_f32 v221, v221
    v_cvt_pk_bf16_f32 v236, v216, v217
    v_exp_f32 v222, v222
    v_exp_f32 v223, v223
    v_cvt_pk_bf16_f32 v237, v218, v219
    v_cvt_pk_bf16_f32 v238, v220, v221
    v_cvt_pk_bf16_f32 v239, v222, v223
    v_mfma_f32_32x32x16_bf16 v[144:159], v[72:75], v[232:235], v[144:159]
    s_add_u32 s84, s84, 512
    v_exp_f32 v192, v192
    v_exp_f32 v193, v193
    v_exp_f32 v194, v194
    v_mfma_f32_32x32x16_bf16 v[144:159], v[76:79], v[236:239], v[144:159]
    s_and_b32 s84, s84, 8191
    v_exp_f32 v195, v195
    v_exp_f32 v196, v196
    v_exp_f32 v197, v197
    v_mfma_f32_32x32x16_bf16 v[208:223], v[64:67], v[40:43], 0
    s_mul_i32 s86, s84, 57
    v_exp_f32 v198, v198
    v_exp_f32 v199, v199
    v_cvt_pk_bf16_f32 v224, v192, v193
    v_cvt_pk_bf16_f32 v225, v194, v195
    v_mfma_f32_32x32x16_bf16 v[208:223], v[68:71], v[44:47], v[208:223]
    v_exp_f32 v200, v200
    v_exp_f32 v201, v201
    v_cvt_pk_bf16_f32 v226, v196, v197
    v_exp_f32 v202, v202
    v_exp_f32 v203, v203
    v_cvt_pk_bf16_f32 v227, v198, v199
    v_exp_f32 v204, v204
    v_exp_f32 v205, v205
    v_cvt_pk_bf16_f32 v228, v200, v201
    v_exp_f32 v206, v206
    v_exp_f32 v207, v207
    v_cvt_pk_bf16_f32 v229, v202, v203
    v_cvt_pk_bf16_f32 v230, v204, v205
    v_cvt_pk_bf16_f32 v231, v206, v207
    v_mfma_f32_32x32x16_bf16 v[160:175], v[72:75], v[224:227], v[160:175]
    v_exp_f32 v208, v208
    v_exp_f32 v209, v209
    v_exp_f32 v210, v210
    v_mfma_f32_32x32x16_bf16 v[160:175], v[76:79], v[228:231], v[160:175]
    s_waitcnt vmcnt(8)
    v_exp_f32 v211, v211
    v_exp_f32 v212, v212
    v_exp_f32 v213, v213
    v_mfma_f32_32x32x16_bf16 v[192:207], v[80:83], v[16:19], 0
    v_exp_f32 v214, v214
    v_exp_f32 v215, v215
    v_cvt_pk_bf16_f32 v232, v208, v209
    v_cvt_pk_bf16_f32 v233, v210, v211
    v_mfma_f32_32x32x16_bf16 v[192:207], v[84:87], v[20:23], v[192:207]
    v_exp_f32 v216, v216
    v_exp_f32 v217, v217
    v_cvt_pk_bf16_f32 v234, v212, v213
    v_exp_f32 v218, v218
    v_exp_f32 v219, v219
    v_cvt_pk_bf16_f32 v235, v214, v215
    v_exp_f32 v220, v220
    v_exp_f32 v221, v221
    v_cvt_pk_bf16_f32 v236, v216, v217
    v_exp_f32 v222, v222
    v_exp_f32 v223, v223
    v_cvt_pk_bf16_f32 v237, v218, v219
    v_cvt_pk_bf16_f32 v238, v220, v221
    v_cvt_pk_bf16_f32 v239, v222, v223
    v_mfma_f32_32x32x16_bf16 v[176:191], v[72:75], v[232:235], v[176:191]
    v_exp_f32 v192, v192
    v_exp_f32 v193, v193
    v_exp_f32 v194, v194
    v_mfma_f32_32x32x16_bf16 v[176:191], v[76:79], v[236:239], v[176:191]
    v_exp_f32 v195, v195
    v_exp_f32 v196, v196
    v_exp_f32 v197, v197
    v_mfma_f32_32x32x16_bf16 v[208:223], v[80:83], v[24:27], 0
    v_exp_f32 v198, v198
    v_exp_f32 v199, v199
    v_cvt_pk_bf16_f32 v224, v192, v193
    v_cvt_pk_bf16_f32 v225, v194, v195
    v_mfma_f32_32x32x16_bf16 v[208:223], v[84:87], v[28:31], v[208:223]
    v_exp_f32 v200, v200
    v_exp_f32 v201, v201
    v_cvt_pk_bf16_f32 v226, v196, v197
    v_exp_f32 v202, v202
    v_exp_f32 v203, v203
    v_cvt_pk_bf16_f32 v227, v198, v199
    v_exp_f32 v204, v204
    v_exp_f32 v205, v205
    v_cvt_pk_bf16_f32 v228, v200, v201
    v_exp_f32 v206, v206
    v_exp_f32 v207, v207
    v_cvt_pk_bf16_f32 v229, v202, v203
    v_cvt_pk_bf16_f32 v230, v204, v205
    v_cvt_pk_bf16_f32 v231, v206, v207
    v_mfma_f32_32x32x16_bf16 v[128:143], v[88:91], v[224:227], v[128:143]
    buffer_load_dwordx4 v[64:67], v240, s[44:47], s84 offen sc1
    v_exp_f32 v208, v208
    v_exp_f32 v209, v209
    v_exp_f32 v210, v210
    v_mfma_f32_32x32x16_bf16 v[128:143], v[92:95], v[228:231], v[128:143]
    buffer_load_dwordx4 v[68:71], v248, s[44:47], s84 offen sc1
    v_exp_f32 v211, v211
    v_exp_f32 v212, v212
    v_exp_f32 v213, v213
    v_mfma_f32_32x32x16_bf16 v[192:207], v[80:83], v[32:35], 0
    buffer_load_dwordx4 v[72:75], v241, s[44:47], s86 offen sc1
    v_exp_f32 v214, v214
    v_exp_f32 v215, v215
    v_cvt_pk_bf16_f32 v232, v208, v209
    v_cvt_pk_bf16_f32 v233, v210, v211
    v_mfma_f32_32x32x16_bf16 v[192:207], v[84:87], v[36:39], v[192:207]
    buffer_load_dwordx4 v[76:79], v249, s[44:47], s86 offen sc1
    v_exp_f32 v216, v216
    v_exp_f32 v217, v217
    v_cvt_pk_bf16_f32 v234, v212, v213
    v_exp_f32 v218, v218
    v_exp_f32 v219, v219
    v_cvt_pk_bf16_f32 v235, v214, v215
    v_exp_f32 v220, v220
    v_exp_f32 v221, v221
    v_cvt_pk_bf16_f32 v236, v216, v217
    v_exp_f32 v222, v222
    v_exp_f32 v223, v223
    v_cvt_pk_bf16_f32 v237, v218, v219
    v_cvt_pk_bf16_f32 v238, v220, v221
    v_cvt_pk_bf16_f32 v239, v222, v223
    v_mfma_f32_32x32x16_bf16 v[144:159], v[88:91], v[232:235], v[144:159]
    s_add_u32 s84, s84, 512
    v_exp_f32 v192, v192
    v_exp_f32 v193, v193
    v_exp_f32 v194, v194
    v_mfma_f32_32x32x16_bf16 v[144:159], v[92:95], v[236:239], v[144:159]
    s_and_b32 s84, s84, 8191
    v_exp_f32 v195, v195
    v_exp_f32 v196, v196
    v_exp_f32 v197, v197
    v_mfma_f32_32x32x16_bf16 v[208:223], v[80:83], v[40:43], 0
    s_mul_i32 s86, s84, 57
    v_exp_f32 v198, v198
    v_exp_f32 v199, v199
    v_cvt_pk_bf16_f32 v224, v192, v193
    v_cvt_pk_bf16_f32 v225, v194, v195
    v_mfma_f32_32x32x16_bf16 v[208:223], v[84:87], v[44:47], v[208:223]
    v_exp_f32 v200, v200
    v_exp_f32 v201, v201
    v_cvt_pk_bf16_f32 v226, v196, v197
    v_exp_f32 v202, v202
    v_exp_f32 v203, v203
    v_cvt_pk_bf16_f32 v227, v198, v199
    v_exp_f32 v204, v204
    v_exp_f32 v205, v205
    v_cvt_pk_bf16_f32 v228, v200, v201
    v_exp_f32 v206, v206
    v_exp_f32 v207, v207
    v_cvt_pk_bf16_f32 v229, v202, v203
    v_cvt_pk_bf16_f32 v230, v204, v205
    v_cvt_pk_bf16_f32 v231, v206, v207
    v_mfma_f32_32x32x16_bf16 v[160:175], v[88:91], v[224:227], v[160:175]
    v_exp_f32 v208, v208
    v_exp_f32 v209, v209
    v_exp_f32 v210, v210
    v_mfma_f32_32x32x16_bf16 v[160:175], v[92:95], v[228:231], v[160:175]
    s_waitcnt vmcnt(8)
    v_exp_f32 v211, v211
    v_exp_f32 v212, v212
    v_exp_f32 v213, v213
    v_mfma_f32_32x32x16_bf16 v[192:207], v[96:99], v[16:19], 0
    v_exp_f32 v214, v214
    v_exp_f32 v215, v215
    v_cvt_pk_bf16_f32 v232, v208, v209
    v_cvt_pk_bf16_f32 v233, v210, v211
    v_mfma_f32_32x32x16_bf16 v[192:207], v[100:103], v[20:23], v[192:207]
    v_exp_f32 v216, v216
    v_exp_f32 v217, v217
    v_cvt_pk_bf16_f32 v234, v212, v213
    v_exp_f32 v218, v218
    v_exp_f32 v219, v219
    v_cvt_pk_bf16_f32 v235, v214, v215
    v_exp_f32 v220, v220
    v_exp_f32 v221, v221
    v_cvt_pk_bf16_f32 v236, v216, v217
    v_exp_f32 v222, v222
    v_exp_f32 v223, v223
    v_cvt_pk_bf16_f32 v237, v218, v219
    v_cvt_pk_bf16_f32 v238, v220, v221
    v_cvt_pk_bf16_f32 v239, v222, v223
    v_mfma_f32_32x32x16_bf16 v[176:191], v[88:91], v[232:235], v[176:191]
    v_exp_f32 v192, v192
    v_exp_f32 v193, v193
    v_exp_f32 v194, v194
    v_mfma_f32_32x32x16_bf16 v[176:191], v[92:95], v[236:239], v[176:191]
    v_exp_f32 v195, v195
    v_exp_f32 v196, v196
    v_exp_f32 v197, v197
    v_mfma_f32_32x32x16_bf16 v[208:223], v[96:99], v[24:27], 0
    v_exp_f32 v198, v198
    v_exp_f32 v199, v199
    v_cvt_pk_bf16_f32 v224, v192, v193
    v_cvt_pk_bf16_f32 v225, v194, v195
    v_mfma_f32_32x32x16_bf16 v[208:223], v[100:103], v[28:31], v[208:223]
    v_exp_f32 v200, v200
    v_exp_f32 v201, v201
    v_cvt_pk_bf16_f32 v226, v196, v197
    v_exp_f32 v202, v202
    v_exp_f32 v203, v203
    v_cvt_pk_bf16_f32 v227, v198, v199
    v_exp_f32 v204, v204
    v_exp_f32 v205, v205
    v_cvt_pk_bf16_f32 v228, v200, v201
    v_exp_f32 v206, v206
    v_exp_f32 v207, v207
    v_cvt_pk_bf16_f32 v229, v202, v203
    v_cvt_pk_bf16_f32 v230, v204, v205
    v_cvt_pk_bf16_f32 v231, v206, v207
    v_mfma_f32_32x32x16_bf16 v[128:143], v[104:107], v[224:227], v[128:143]
    buffer_load_dwordx4 v[80:83], v240, s[44:47], s84 offen sc1
    v_exp_f32 v208, v208
    v_exp_f32 v209, v209
    v_exp_f32 v210, v210
    v_mfma_f32_32x32x16_bf16 v[128:143], v[108:111], v[228:231], v[128:143]
    buffer_load_dwordx4 v[84:87], v248, s[44:47], s84 offen sc1
    v_exp_f32 v211, v211
    v_exp_f32 v212, v212
    v_exp_f32 v213, v213
    v_mfma_f32_32x32x16_bf16 v[192:207], v[96:99], v[32:35], 0
    buffer_load_dwordx4 v[88:91], v241, s[44:47], s86 offen sc1
    v_exp_f32 v214, v214
    v_exp_f32 v215, v215
    v_cvt_pk_bf16_f32 v232, v208, v209
    v_cvt_pk_bf16_f32 v233, v210, v211
    v_mfma_f32_32x32x16_bf16 v[192:207], v[100:103], v[36:39], v[192:207]
    buffer_load_dwordx4 v[92:95], v249, s[44:47], s86 offen sc1
    v_exp_f32 v216, v216
    v_exp_f32 v217, v217
    v_cvt_pk_bf16_f32 v234, v212, v213
    v_exp_f32 v218, v218
    v_exp_f32 v219, v219
    v_cvt_pk_bf16_f32 v235, v214, v215
    v_exp_f32 v220, v220
    v_exp_f32 v221, v221
    v_cvt_pk_bf16_f32 v236, v216, v217
    v_exp_f32 v222, v222
    v_exp_f32 v223, v223
    v_cvt_pk_bf16_f32 v237, v218, v219
    v_cvt_pk_bf16_f32 v238, v220, v221
    v_cvt_pk_bf16_f32 v239, v222, v223
    v_mfma_f32_32x32x16_bf16 v[144:159], v[104:107], v[232:235], v[144:159]
    s_add_u32 s84, s84, 512
    v_exp_f32 v192, v192
    v_exp_f32 v193, v193
    v_exp_f32 v194, v194
    v_mfma_f32_32x32x16_bf16 v[144:159], v[108:111], v[236:239], v[144:159]
    s_and_b32 s84, s84, 8191
    v_exp_f32 v195, v195
    v_exp_f32 v196, v196
    v_exp_f32 v197, v197
    v_mfma_f32_32x32x16_bf16 v[208:223], v[96:99], v[40:43], 0
    s_mul_i32 s86, s84, 57
    v_exp_f32 v198, v198
    v_exp_f32 v199, v199
    v_cvt_pk_bf16_f32 v224, v192, v193
    v_cvt_pk_bf16_f32 v225, v194, v195
    v_mfma_f32_32x32x16_bf16 v[208:223], v[100:103], v[44:47], v[208:223]
    v_exp_f32 v200, v200
    v_exp_f32 v201, v201
    v_cvt_pk_bf16_f32 v226, v196, v197
    v_exp_f32 v202, v202
    v_exp_f32 v203, v203
    v_cvt_pk_bf16_f32 v227, v198, v199
    v_exp_f32 v204, v204
    v_exp_f32 v205, v205
    v_cvt_pk_bf16_f32 v228, v200, v201
    v_exp_f32 v206, v206
    v_exp_f32 v207, v207
    v_cvt_pk_bf16_f32 v229, v202, v203
    v_cvt_pk_bf16_f32 v230, v204, v205
    v_cvt_pk_bf16_f32 v231, v206, v207
    v_mfma_f32_32x32x16_bf16 v[160:175], v[104:107], v[224:227], v[160:175]
    v_exp_f32 v208, v208
    v_exp_f32 v209, v209
    v_exp_f32 v210, v210
    v_mfma_f32_32x32x16_bf16 v[160:175], v[108:111], v[228:231], v[160:175]
    s_waitcnt vmcnt(8)
    v_exp_f32 v211, v211
    v_exp_f32 v212, v212
    v_exp_f32 v213, v213
    v_mfma_f32_32x32x16_bf16 v[192:207], v[48:51], v[16:19], 0
    s_sub_u32 s88, s88, 1
    v_exp_f32 v214, v214
    v_exp_f32 v215, v215
    v_cvt_pk_bf16_f32 v232, v208, v209
    v_cvt_pk_bf16_f32 v233, v210, v211
    v_mfma_f32_32x32x16_bf16 v[192:207], v[52:55], v[20:23], v[192:207]
    s_cmp_lg_u32 s88, 0
    v_exp_f32 v216, v216
    v_exp_f32 v217, v217
    v_cvt_pk_bf16_f32 v234, v212, v213
    v_exp_f32 v218, v218
    v_exp_f32 v219, v219
    v_cvt_pk_bf16_f32 v235, v214, v215
    v_exp_f32 v220, v220
    v_exp_f32 v221, v221
    v_cvt_pk_bf16_f32 v236, v216, v217
    v_exp_f32 v222, v222
    v_exp_f32 v223, v223
    v_cvt_pk_bf16_f32 v237, v218, v219
    v_cvt_pk_bf16_f32 v238, v220, v221
    v_cvt_pk_bf16_f32 v239, v222, v223
    s_cbranch_scc1 L_c_loop
    v_mfma_f32_32x32x16_bf16 v[176:191], v[104:107], v[232:235], v[176:191]
    ds_write_b128 v123, v[128:131] offset:0
    ds_write_b128 v123, v[132:135] offset:1024
    ds_write_b128 v123, v[136:139] offset:2048
    ds_write_b128 v123, v[140:143] offset:3072
    v_mfma_f32_32x32x16_bf16 v[176:191], v[108:111], v[236:239], v[176:191]
    ds_write_b128 v124, v[144:147] offset:0
    ds_write_b128 v124, v[148:151] offset:1024
    ds_write_b128 v124, v[152:155] offset:2048
    ds_write_b128 v124, v[156:159] offset:3072
    ds_write_b128 v125, v[160:163] offset:0
    ds_write_b128 v125, v[164:167] offset:1024
    ds_write_b128 v125, v[168:171] offset:2048
    ds_write_b128 v125, v[172:175] offset:3072
    v_mov_b32 v118, 1
    s_waitcnt lgkmcnt(0)
    s_mov_b64 exec, 1
    ds_add_u32 v127, v118
    s_mov_b64 exec, -1
    s_mov_b32 s52, 0x100000
L_xs22:
    ds_read_b32 v118, v127
    s_waitcnt lgkmcnt(0)
    v_readfirstlane_b32 s61, v118
    s_nop 0
    s_cmp_ge_u32 s61, 4
    s_cbranch_scc1 L_xd23
    s_sub_u32 s52, s52, 1
    s_cmp_lg_u32 s52, 0
    s_cbranch_scc1 L_xs22
L_xd23:
    ds_read_b128 v[128:131], v126 offset:0
    ds_read_b128 v[132:135], v126 offset:1024
    ds_read_b128 v[136:139], v126 offset:2048
    ds_read_b128 v[140:143], v126 offset:3072
    ds_read_b128 v[144:147], v126 offset:4096
    ds_read_b128 v[148:151], v126 offset:5120
    ds_read_b128 v[152:155], v126 offset:6144
    ds_read_b128 v[156:159], v126 offset:7168
    ds_read_b128 v[160:163], v126 offset:8192
    ds_read_b128 v[164:167], v126 offset:9216
    ds_read_b128 v[168:171], v126 offset:10240
    ds_read_b128 v[172:175], v126 offset:11264
    s_waitcnt lgkmcnt(8)
    v_add_f32 v128, v128, v176
    v_add_f32 v129, v129, v177
    v_add_f32 v130, v130, v178
    v_add_f32 v131, v131, v179
    v_add_f32 v132, v132, v180
    v_add_f32 v133, v133, v181
    v_add_f32 v134, v134, v182
    v_add_f32 v135, v135, v183
    v_add_f32 v136, v136, v184
    v_add_f32 v137, v137, v185
    v_add_f32 v138, v138, v186
    v_add_f32 v139, v139, v187
    v_add_f32 v140, v140, v188
    v_add_f32 v141, v141, v189
    v_add_f32 v142, v142, v190
    v_add_f32 v143, v143, v191
    s_waitcnt lgkmcnt(4)
    v_add_f32 v128, v128, v144
    v_add_f32 v129, v129, v145
    v_add_f32 v130, v130, v146
    v_add_f32 v131, v131, v147
    v_add_f32 v132, v132, v148
    v_add_f32 v133, v133, v149
    v_add_f32 v134, v134, v150
    v_add_f32 v135, v135, v151
    v_add_f32 v136, v136, v152
    v_add_f32 v137, v137, v153
    v_add_f32 v138, v138, v154
    v_add_f32 v139, v139, v155
    v_add_f32 v140, v140, v156
    v_add_f32 v141, v141, v157
    v_add_f32 v142, v142, v158
    v_add_f32 v143, v143, v159
    s_waitcnt lgkmcnt(0)
    v_add_f32 v128, v128, v160
    v_add_f32 v129, v129, v161
    v_add_f32 v130, v130, v162
    v_add_f32 v131, v131, v163
    v_add_f32 v132, v132, v164
    v_add_f32 v133, v133, v165
    v_add_f32 v134, v134, v166
    v_add_f32 v135, v135, v167
    v_add_f32 v136, v136, v168
    v_add_f32 v137, v137, v169
    v_add_f32 v138, v138, v170
    v_add_f32 v139, v139, v171
    v_add_f32 v140, v140, v172
    v_add_f32 v141, v141, v173
    v_add_f32 v142, v142, v174
    v_add_f32 v143, v143, v175
    v_mov_b32 v117, v140
    v_mov_b32 v118, v140
    s_mov_b32 s88, 0
    s_nop 0
    v_permlane32_swap_b32 v117, v118
L_fb_done:
    v_rcp_f32 v117, v118
    s_nop 0
    v_mul_f32 v117, v117, v246
    v_mul_f32 v144, v128, v117
    v_mul_f32 v145, v129, v117
    v_mul_f32 v146, v130, v117
    v_mul_f32 v147, v131, v117
    v_cvt_pk_bf16_f32 v224, v144, v145
    v_mul_f32 v148, v132, v117
    v_mul_f32 v149, v133, v117
    v_cvt_pk_bf16_f32 v225, v146, v147
    v_mul_f32 v150, v134, v117
    v_mul_f32 v151, v135, v117
    v_cvt_pk_bf16_f32 v226, v148, v149
    v_mul_f32 v152, v136, v117
    v_mul_f32 v153, v137, v117
    v_cvt_pk_bf16_f32 v227, v150, v151
    buffer_store_dwordx4 v[224:227], v11, s[24:27], s94 offen sc1
    v_mul_f32 v154, v138, v117
    v_mul_f32 v155, v139, v117
    v_cvt_pk_bf16_f32 v228, v152, v153
    v_mul_f32 v156, v140, v117
    v_mul_f32 v157, v141, v117
    v_cvt_pk_bf16_f32 v229, v154, v155
    v_mul_f32 v158, v142, v117
    v_mul_f32 v159, v143, v117
    v_cvt_pk_bf16_f32 v230, v156, v157
    v_cvt_pk_bf16_f32 v231, v158, v159
    s_mov_b32 exec_lo, 0
    v_mov_b32 v230, 0
    v_mov_b32 v231, 0
    s_mov_b32 exec_lo, -1
    buffer_store_dwordx4 v[228:231], v11, s[24:27], s94 offen offset:1024 sc1
    v_pk_mul_f32 v[120:121], v[128:129], 0 op_sel_hi:[1,0]
    v_pk_mul_f32 v[122:123], v[130:131], 0 op_sel_hi:[1,0]
    v_pk_fma_f32 v[120:121], v[132:133], 0, v[120:121] op_sel_hi:[1,0,1]
    v_pk_fma_f32 v[122:123], v[134:135], 0, v[122:123] op_sel_hi:[1,0,1]
    v_pk_fma_f32 v[120:121], v[136:137], 0, v[120:121] op_sel_hi:[1,0,1]
    v_pk_fma_f32 v[122:123], v[138:139], 0, v[122:123] op_sel_hi:[1,0,1]
    v_pk_fma_f32 v[120:121], v[140:141], 0, v[120:121] op_sel_hi:[1,0,1]
    v_pk_fma_f32 v[122:123], v[142:143], 0, v[122:123] op_sel_hi:[1,0,1]
    v_cmp_nle_f32 vcc, 0x30800000, v118
    v_cmp_nge_f32 s[4:5], s87, v118
    v_pk_add_f32 v[120:121], v[120:121], v[122:123]
    s_or_b64 vcc, vcc, s[4:5]
    v_cmp_u_f32 s[6:7], v120, v121
    s_nop 0
    s_or_b64 vcc, vcc, s[6:7]
    s_cmp_lg_u32 s88, 0
    s_cselect_b64 vcc, 0, vcc
    s_cbranch_vccnz L_fallback
    s_waitcnt vmcnt(0)
    s_mov_b64 exec, 1
    buffer_store_dwordx2 v[112:113], v14, s[24:27], s95 offen sc1
    s_endpgm
L_fallback:
    v_mov_b32 v119, 0xff800000
    s_add_u32 s4, s89, 56
    s_lshl_b32 s4, s4, 15
    s_add_u32 s5, s4, 65536
    s_mov_b32 s88, 64
L_fb1:
    buffer_load_dwordx4 v[48:51], v250, s[24:27], s4 offen sc1
    buffer_load_dwordx4 v[52:55], v250, s[24:27], s5 offen sc1
    s_add_u32 s4, s4, 512
    s_add_u32 s5, s5, 512
    s_waitcnt vmcnt(0)
    v_mfma_f32_32x32x16_bf16 v[192:207], v[48:51], v[40:43], 0
    v_mfma_f32_32x32x16_bf16 v[192:207], v[52:55], v[44:47], v[192:207]
    s_nop 11
    v_max3_f32 v119, v119, v192, v193
    v_max3_f32 v119, v119, v194, v195
    v_max3_f32 v119, v119, v196, v197
    v_max3_f32 v119, v119, v198, v199
    v_max3_f32 v119, v119, v200, v201
    v_max3_f32 v119, v119, v202, v203
    v_max3_f32 v119, v119, v204, v205
    v_max3_f32 v119, v119, v206, v207
    s_sub_u32 s88, s88, 1
    s_cmp_lg_u32 s88, 0
    s_cbranch_scc1 L_fb1
    v_mov_b32 v120, v119
    s_nop 1
    v_permlane32_swap_b32 v119, v120
    v_max_f32 v119, v119, v120
    v_mov_b32 v128, 0
    v_mov_b32 v129, 0
    v_mov_b32 v130, 0
    v_mov_b32 v131, 0
    v_mov_b32 v132, 0
    v_mov_b32 v133, 0
    v_mov_b32 v134, 0
    v_mov_b32 v135, 0
    v_mov_b32 v136, 0
    v_mov_b32 v137, 0
    v_mov_b32 v138, 0
    v_mov_b32 v139, 0
    v_mov_b32 v140, 0
    v_mov_b32 v141, 0
    v_mov_b32 v142, 0
    v_mov_b32 v143, 0
    s_add_u32 s4, s89, 56
    s_lshl_b32 s4, s4, 15
    s_add_u32 s5, s4, 65536
    s_mov_b32 s88, 64
    s_mul_i32 s6, s58, 466944
    v_subrev_u32 v122, s6, v241
    v_subrev_u32 v123, s6, v249
    s_mov_b32 s6, 0
L_fb2:
    buffer_load_dwordx4 v[48:51], v250, s[24:27], s4 offen sc1
    buffer_load_dwordx4 v[52:55], v250, s[24:27], s5 offen sc1
    s_add_u32 s4, s4, 512
    s_add_u32 s5, s5, 512
    buffer_load_dwordx4 v[56:59], v122, s[24:27], s6 offen sc1
    buffer_load_dwordx4 v[60:63], v123, s[24:27], s6 offen sc1
    s_add_u32 s6, s6, 29184
    s_waitcnt vmcnt(0)
    v_mfma_f32_32x32x16_bf16 v[192:207], v[48:51], v[40:43], 0
    v_mfma_f32_32x32x16_bf16 v[192:207], v[52:55], v[44:47], v[192:207]
    s_nop 11
    v_sub_f32 v192, v192, v119
    v_sub_f32 v193, v193, v119
    v_sub_f32 v194, v194, v119
    v_sub_f32 v195, v195, v119
    v_sub_f32 v196, v196, v119
    v_sub_f32 v197, v197, v119
    v_sub_f32 v198, v198, v119
    v_sub_f32 v199, v199, v119
    v_sub_f32 v200, v200, v119
    v_sub_f32 v201, v201, v119
    v_sub_f32 v202, v202, v119
    v_sub_f32 v203, v203, v119
    v_sub_f32 v204, v204, v119
    v_sub_f32 v205, v205, v119
    v_sub_f32 v206, v206, v119
    v_sub_f32 v207, v207, v119
    v_exp_f32 v192, v192
    v_exp_f32 v193, v193
    v_exp_f32 v194, v194
    v_exp_f32 v195, v195
    v_exp_f32 v196, v196
    v_exp_f32 v197, v197
    v_exp_f32 v198, v198
    v_exp_f32 v199, v199
    v_exp_f32 v200, v200
    v_exp_f32 v201, v201
    v_exp_f32 v202, v202
    v_exp_f32 v203, v203
    v_exp_f32 v204, v204
    v_exp_f32 v205, v205
    v_exp_f32 v206, v206
    v_exp_f32 v207, v207
    v_cvt_pk_bf16_f32 v224, v192, v193
    v_cvt_pk_bf16_f32 v225, v194, v195
    v_cvt_pk_bf16_f32 v226, v196, v197
    v_cvt_pk_bf16_f32 v227, v198, v199
    v_cvt_pk_bf16_f32 v228, v200, v201
    v_cvt_pk_bf16_f32 v229, v202, v203
    v_cvt_pk_bf16_f32 v230, v204, v205
    v_cvt_pk_bf16_f32 v231, v206, v207
    v_mfma_f32_32x32x16_bf16 v[128:143], v[56:59], v[224:227], v[128:143]
    s_nop 0
    v_mfma_f32_32x32x16_bf16 v[128:143], v[60:63], v[228:231], v[128:143]
    s_nop 7
    s_nop 7
    s_sub_u32 s88, s88, 1
    s_cmp_lg_u32 s88, 0
    s_cbranch_scc1 L_fb2
    v_mov_b32 v117, v140
    v_mov_b32 v118, v140
    s_nop 1
    v_permlane32_swap_b32 v117, v118
    s_mov_b32 s88, 1
    s_nop 1
    s_branch L_fb_done
L_aspin17:
    s_mov_b32 s52, 0x8000
L_spin24:
    s_mov_b32 s60, 15007744
    buffer_load_dwordx2 v[216:217], v242, s[24:27], s60 offen sc1
    buffer_load_dwordx2 v[218:219], v243, s[24:27], s60 offen sc1
    s_waitcnt vmcnt(0)
    s_mov_b64 s[6:7], 0
    v_cmp_ne_u32 vcc, s76, v216
    v_cmp_ne_u32 s[4:5], s77, v217
    s_or_b64 s[6:7], s[6:7], vcc
    s_or_b64 s[6:7], s[6:7], s[4:5]
    v_cmp_ne_u32 vcc, s76, v218
    v_cmp_ne_u32 s[4:5], s77, v219
    s_or_b64 s[6:7], s[6:7], vcc
    s_or_b64 s[6:7], s[6:7], s[4:5]
    s_cmp_eq_u64 s[6:7], 0
    s_cbranch_scc1 L_spind25
    s_sleep 2
    s_sub_u32 s52, s52, 1
    s_cmp_lg_u32 s52, 0
    s_cbranch_scc1 L_spin24
L_spind25:
    buffer_load_dwordx4 v[48:51], v240, s[44:47], s84 offen sc1
    buffer_load_dwordx4 v[52:55], v248, s[44:47], s84 offen sc1
    buffer_load_dwordx4 v[56:59], v241, s[44:47], s86 offen sc1
    buffer_load_dwordx4 v[60:63], v249, s[44:47], s86 offen sc1
    s_add_u32 s84, s84, 512
    s_and_b32 s84, s84, 8191
    s_mul_i32 s86, s84, 57
    s_lshl_b32 s4, s89, 15
    s_lshl_b32 s5, s83, 11
    s_add_u32 s4, s4, s5
    s_add_u32 s5, s58, 1
    s_and_b32 s5, s5, 3
    s_lshl_b32 s5, s5, 9
    s_add_u32 s5, s5, s4
    s_add_u32 s6, s5, 65536
    buffer_load_dwordx4 v[16:19], v250, s[24:27], s5 offen sc1
    buffer_load_dwordx4 v[20:23], v250, s[24:27], s6 offen sc1
    s_add_u32 s5, s58, 2
    s_and_b32 s5, s5, 3
    s_lshl_b32 s5, s5, 9
    s_add_u32 s5, s5, s4
    s_add_u32 s6, s5, 65536
    buffer_load_dwordx4 v[24:27], v250, s[24:27], s5 offen sc1
    buffer_load_dwordx4 v[28:31], v250, s[24:27], s6 offen sc1
    s_add_u32 s5, s58, 3
    s_and_b32 s5, s5, 3
    s_lshl_b32 s5, s5, 9
    s_add_u32 s5, s5, s4
    s_add_u32 s6, s5, 65536
    buffer_load_dwordx4 v[32:35], v250, s[24:27], s5 offen sc1
    buffer_load_dwordx4 v[36:39], v250, s[24:27], s6 offen sc1
    s_add_u32 s5, s58, 4
    s_and_b32 s5, s5, 3
    s_lshl_b32 s5, s5, 9
    s_add_u32 s5, s5, s4
    s_add_u32 s6, s5, 65536
    buffer_load_dwordx4 v[40:43], v250, s[24:27], s5 offen sc1
    buffer_load_dwordx4 v[44:47], v250, s[24:27], s6 offen sc1
    s_lshl_b32 s4, s83, 2
    s_add_u32 s4, s4, s58
    s_lshl_b32 s4, s4, 7
    s_add_u32 s4, s4, 14942208
    v_and_b32 v246, 31, v1
    v_lshlrev_b32 v246, 2, v246
    buffer_load_dword v246, v246, s[24:27], s4 offen sc1
    s_branch L_ago18
L_dphase:
    s_nop 7
    s_nop 7
    v_max_f32 v128, 0, v128
    v_max_f32 v129, 0, v129
    v_max_f32 v130, 0, v130
    v_max_f32 v131, 0, v131
    v_max_f32 v132, 0, v132
    v_max_f32 v133, 0, v133
    v_max_f32 v134, 0, v134
    v_max_f32 v135, 0, v135
    v_max_f32 v136, 0, v136
    v_max_f32 v137, 0, v137
    v_max_f32 v138, 0, v138
    v_max_f32 v139, 0, v139
    v_max_f32 v140, 0, v140
    v_max_f32 v141, 0, v141
    v_max_f32 v142, 0, v142
    v_max_f32 v143, 0, v143
    v_mul_f32 v128, v128, v144
    v_mul_f32 v129, v129, v145
    v_mul_f32 v130, v130, v146
    v_mul_f32 v131, v131, v147
    v_mul_f32 v132, v132, v148
    v_mul_f32 v133, v133, v149
    v_mul_f32 v134, v134, v150
    v_mul_f32 v135, v135, v151
    v_mul_f32 v136, v136, v152
    v_mul_f32 v137, v137, v153
    v_mul_f32 v138, v138, v154
    v_mul_f32 v139, v139, v155
    v_mul_f32 v140, v140, v156
    v_mul_f32 v141, v141, v157
    v_mul_f32 v142, v142, v158
    v_mul_f32 v143, v143, v159
    v_cvt_pk_bf16_f32 v192, v128, v129
    v_cvt_pk_bf16_f32 v193, v130, v131
    v_cvt_pk_bf16_f32 v194, v132, v133
    v_cvt_pk_bf16_f32 v195, v134, v135
    buffer_store_dwordx4 v[192:195], v11, s[24:27], s53 offen sc1
    v_cvt_pk_bf16_f32 v196, v136, v137
    v_cvt_pk_bf16_f32 v197, v138, v139
    v_cvt_pk_bf16_f32 v198, v140, v141
    v_cvt_pk_bf16_f32 v199, v142, v143
    buffer_store_dwordx4 v[196:199], v11, s[24:27], s53 offen offset:1024 sc1
    s_cmp_ge_u32 s2, 224
    s_cbranch_scc1 L_dfin26
    s_and_b32 s58, s58, 3
    s_mul_i32 s89, s58, 401408
    s_lshl_b32 s60, s83, 7
    s_add_u32 s89, s89, s60
    s_mul_i32 s90, s82, 294912
    s_mul_i32 s60, s58, 28672
    s_add_u32 s90, s90, s60
    s_add_u32 s90, s90, 5505024
    s_waitcnt vmcnt(0)
    s_mov_b64 exec, 1
    buffer_store_dwordx2 v[222:223], v14, s[24:27], s54 offen sc1
    s_mov_b64 exec, -1
    s_bfe_u32 s86, s88, 0x40000
    s_mul_i32 s86, s86, 57344
    s_add_u32 s86, s86, s89
    s_add_u32 m0, s87, 0
    s_add_u32 s60, s86, 0
    buffer_load_dwordx4 v240, s[28:31], s60 offen lds
    s_add_u32 m0, s87, 1024
    s_add_u32 s60, s60, 7168
    buffer_load_dwordx4 v240, s[28:31], s60 offen lds
    s_waitcnt vmcnt(3)
    s_add_u32 m0, s87, 2048
    s_add_u32 s60, s86, 14336
    buffer_load_dwordx4 v240, s[28:31], s60 offen lds
    s_add_u32 m0, s87, 3072
    s_add_u32 s60, s60, 7168
    buffer_load_dwordx4 v240, s[28:31], s60 offen lds
    s_waitcnt vmcnt(3)
    s_add_u32 m0, s87, 4096
    s_add_u32 s60, s86, 28672
    buffer_load_dwordx4 v240, s[28:31], s60 offen lds
    s_add_u32 m0, s87, 5120
    s_add_u32 s60, s60, 7168
    buffer_load_dwordx4 v240, s[28:31], s60 offen lds
    s_waitcnt vmcnt(3)
    s_add_u32 m0, s87, 6144
    s_add_u32 s60, s86, 43008
    buffer_load_dwordx4 v240, s[28:31], s60 offen lds
    s_add_u32 m0, s87, 7168
    s_add_u32 s60, s60, 7168
    buffer_load_dwordx4 v240, s[28:31], s60 offen lds
    s_waitcnt vmcnt(3)
    s_bfe_u32 s86, s88, 0x40004
    s_mul_i32 s86, s86, 57344
    s_add_u32 s86, s86, s89
    s_add_u32 m0, s87, 8192
    s_add_u32 s60, s86, 0
    buffer_load_dwordx4 v240, s[28:31], s60 offen lds
    s_add_u32 m0, s87, 9216
    s_add_u32 s60, s60, 7168
    buffer_load_dwordx4 v240, s[28:31], s60 offen lds
    s_waitcnt vmcnt(3)
    s_add_u32 m0, s87, 10240
    s_add_u32 s60, s86, 14336
    buffer_load_dwordx4 v240, s[28:31], s60 offen lds
    s_add_u32 m0, s87, 11264
    s_add_u32 s60, s60, 7168
    buffer_load_dwordx4 v240, s[28:31], s60 offen lds
    s_waitcnt vmcnt(3)
    s_add_u32 m0, s87, 12288
    s_add_u32 s60, s86, 28672
    buffer_load_dwordx4 v240, s[28:31], s60 offen lds
    s_add_u32 m0, s87, 13312
    s_add_u32 s60, s60, 7168
    buffer_load_dwordx4 v240, s[28:31], s60 offen lds
    s_waitcnt vmcnt(3)
    s_add_u32 m0, s87, 14336
    s_add_u32 s60, s86, 43008
    buffer_load_dwordx4 v240, s[28:31], s60 offen lds
    s_add_u32 m0, s87, 15360
    s_add_u32 s60, s60, 7168
    buffer_load_dwordx4 v240, s[28:31], s60 offen lds
    s_waitcnt vmcnt(3)
    s_bfe_u32 s86, s88, 0x40008
    s_mul_i32 s86, s86, 57344
    s_add_u32 s86, s86, s89
    s_add_u32 m0, s87, 16384
    s_add_u32 s60, s86, 0
    buffer_load_dwordx4 v240, s[28:31], s60 offen lds
    s_add_u32 m0, s87, 17408
    s_add_u32 s60, s60, 7168
    buffer_load_dwordx4 v240, s[28:31], s60 offen lds
    s_waitcnt vmcnt(3)
    s_add_u32 m0, s87, 18432
    s_add_u32 s60, s86, 14336
    buffer_load_dwordx4 v240, s[28:31], s60 offen lds
    s_add_u32 m0, s87, 19456
    s_add_u32 s60, s60, 7168
    buffer_load_dwordx4 v240, s[28:31], s60 offen lds
    s_waitcnt vmcnt(3)
    s_add_u32 m0, s87, 20480
    s_add_u32 s60, s86, 28672
    buffer_load_dwordx4 v240, s[28:31], s60 offen lds
    s_add_u32 m0, s87, 21504
    s_add_u32 s60, s60, 7168
    buffer_load_dwordx4 v240, s[28:31], s60 offen lds
    s_waitcnt vmcnt(3)
    s_add_u32 m0, s87, 22528
    s_add_u32 s60, s86, 43008
    buffer_load_dwordx4 v240, s[28:31], s60 offen lds
    s_add_u32 m0, s87, 23552
    s_add_u32 s60, s60, 7168
    buffer_load_dwordx4 v240, s[28:31], s60 offen lds
    s_waitcnt vmcnt(3)
    s_bfe_u32 s86, s88, 0x4000c
    s_mul_i32 s86, s86, 57344
    s_add_u32 s86, s86, s89
    s_add_u32 m0, s87, 24576
    s_add_u32 s60, s86, 0
    buffer_load_dwordx4 v240, s[28:31], s60 offen lds
    s_add_u32 m0, s87, 25600
    s_add_u32 s60, s60, 7168
    buffer_load_dwordx4 v240, s[28:31], s60 offen lds
    s_waitcnt vmcnt(3)
    s_mov_b32 s52, 0x8000
L_spin27:
    s_mov_b32 s60, 15007744
    buffer_load_dwordx2 v[216:217], v244, s[24:27], s60 offen sc1
    s_waitcnt vmcnt(0)
    s_mov_b64 s[6:7], 0
    v_cmp_ne_u32 vcc, s76, v216
    v_cmp_ne_u32 s[4:5], s77, v217
    s_or_b64 s[6:7], s[6:7], vcc
    s_or_b64 s[6:7], s[6:7], s[4:5]
    s_cmp_eq_u64 s[6:7], 0
    s_cbranch_scc1 L_spind28
    s_sleep 2
    s_sub_u32 s52, s52, 1
    s_cmp_lg_u32 s52, 0
    s_cbranch_scc1 L_spin27
L_spind28:
    buffer_load_dwordx2 v[216:217], v245, s[24:27], s60 offen sc1
    v_and_b32 v209, 31, v1
    v_lshlrev_b32 v210, 2, v209
    s_lshl_b32 s60, s82, 8
    s_add_u32 s60, s60, 14942208
    buffer_load_dword v246, v210, s[24:27], s60 offen sc1
    buffer_load_dword v247, v210, s[24:27], s60 offen offset:128 sc1
    s_bfe_u32 s84, s88, 0x40000
    s_lshl_b32 s84, s84, 12
    s_add_u32 s84, s84, s90
    s_add_u32 s85, s84, 147456
    buffer_load_dwordx4 v[80:83], v11, s[24:27], s84 offen offset:0 sc1
    buffer_load_dwordx4 v[84:87], v11, s[24:27], s85 offen offset:0 sc1
    s_waitcnt vmcnt(3)
    buffer_load_dwordx4 v[88:91], v11, s[24:27], s84 offen offset:1024 sc1
    buffer_load_dwordx4 v[92:95], v11, s[24:27], s85 offen offset:1024 sc1
    s_waitcnt vmcnt(3)
    buffer_load_dwordx4 v[96:99], v11, s[24:27], s84 offen offset:2048 sc1
    buffer_load_dwordx4 v[100:103], v11, s[24:27], s85 offen offset:2048 sc1
    s_waitcnt vmcnt(3)
    buffer_load_dwordx4 v[104:107], v11, s[24:27], s84 offen offset:3072 sc1
    buffer_load_dwordx4 v[108:111], v11, s[24:27], s85 offen offset:3072 sc1
    s_waitcnt vmcnt(3)
    s_bfe_u32 s84, s88, 0x40004
    s_lshl_b32 s84, s84, 12
    s_add_u32 s84, s84, s90
    s_add_u32 s85, s84, 147456
    buffer_load_dwordx4 v[112:115], v11, s[24:27], s84 offen offset:0 sc1
    buffer_load_dwordx4 v[116:119], v11, s[24:27], s85 offen offset:0 sc1
    s_waitcnt vmcnt(3)
    buffer_load_dwordx4 v[120:123], v11, s[24:27], s84 offen offset:1024 sc1
    buffer_load_dwordx4 v[124:127], v11, s[24:27], s85 offen offset:1024 sc1
    s_waitcnt vmcnt(3)
    buffer_load_dwordx4 v[128:131], v11, s[24:27], s84 offen offset:2048 sc1
    buffer_load_dwordx4 v[132:135], v11, s[24:27], s85 offen offset:2048 sc1
    s_waitcnt vmcnt(3)
    buffer_load_dwordx4 v[136:139], v11, s[24:27], s84 offen offset:3072 sc1
    buffer_load_dwordx4 v[140:143], v11, s[24:27], s85 offen offset:3072 sc1
    s_waitcnt vmcnt(3)
    s_bfe_u32 s84, s88, 0x40008
    s_lshl_b32 s84, s84, 12
    s_add_u32 s84, s84, s90
    s_add_u32 s85, s84, 147456
    buffer_load_dwordx4 v[144:147], v11, s[24:27], s84 offen offset:0 sc1
    buffer_load_dwordx4 v[148:151], v11, s[24:27], s85 offen offset:0 sc1
    s_waitcnt vmcnt(3)
    buffer_load_dwordx4 v[152:155], v11, s[24:27], s84 offen offset:1024 sc1
    buffer_load_dwordx4 v[156:159], v11, s[24:27], s85 offen offset:1024 sc1
    s_waitcnt vmcnt(3)
    buffer_load_dwordx4 v[160:163], v11, s[24:27], s84 offen offset:2048 sc1
    buffer_load_dwordx4 v[164:167], v11, s[24:27], s85 offen offset:2048 sc1
    s_waitcnt vmcnt(3)
    buffer_load_dwordx4 v[168:171], v11, s[24:27], s84 offen offset:3072 sc1
    buffer_load_dwordx4 v[172:175], v11, s[24:27], s85 offen offset:3072 sc1
    s_waitcnt vmcnt(3)
    s_bfe_u32 s84, s88, 0x4000c
    s_lshl_b32 s84, s84, 12
    s_add_u32 s84, s84, s90
    s_add_u32 s85, s84, 147456
    buffer_load_dwordx4 v[176:179], v11, s[24:27], s84 offen offset:0 sc1
    buffer_load_dwordx4 v[180:183], v11, s[24:27], s85 offen offset:0 sc1
    s_waitcnt vmcnt(3)
    buffer_load_dwordx4 v[184:187], v11, s[24:27], s84 offen offset:1024 sc1
    buffer_load_dwordx4 v[188:191], v11, s[24:27], s85 offen offset:1024 sc1
    s_waitcnt vmcnt(3)
    buffer_load_dwordx4 v[192:195], v11, s[24:27], s84 offen offset:2048 sc1
    buffer_load_dwordx4 v[196:199], v11, s[24:27], s85 offen offset:2048 sc1
    s_waitcnt vmcnt(3)
    buffer_load_dwordx4 v[200:203], v11, s[24:27], s84 offen offset:3072 sc1
    buffer_load_dwordx4 v[204:207], v11, s[24:27], s85 offen offset:3072 sc1
    s_waitcnt vmcnt(3)
    s_waitcnt vmcnt(59)
    ds_read_b64_tr_b16 v[224:225], v242 offset:0
    ds_read_b64_tr_b16 v[226:227], v242 offset:1024
    ds_read_b64_tr_b16 v[228:229], v243 offset:0
    ds_read_b64_tr_b16 v[230:231], v243 offset:1024
    s_waitcnt vmcnt(57)
    ds_read_b64_tr_b16 v[232:233], v242 offset:2048
    ds_read_b64_tr_b16 v[234:235], v242 offset:3072
    ds_read_b64_tr_b16 v[236:237], v243 offset:2048
    ds_read_b64_tr_b16 v[238:239], v243 offset:3072
    s_waitcnt vmcnt(30)
    s_waitcnt lgkmcnt(6)
    v_mfma_f32_32x32x16_bf16 v[16:31], v[224:227], v[80:83], 0
    v_mfma_f32_32x32x16_bf16 v[32:47], v[224:227], v[84:87], 0
    s_waitcnt lgkmcnt(4)
    v_mfma_f32_32x32x16_bf16 v[48:63], v[228:231], v[80:83], 0
    v_mfma_f32_32x32x16_bf16 v[64:79], v[228:231], v[84:87], 0
    s_waitcnt vmcnt(55)
    ds_read_b64_tr_b16 v[224:225], v242 offset:4096
    ds_read_b64_tr_b16 v[226:227], v242 offset:5120
    ds_read_b64_tr_b16 v[228:229], v243 offset:4096
    ds_read_b64_tr_b16 v[230:231], v243 offset:5120
    s_waitcnt vmcnt(28)
    s_waitcnt lgkmcnt(6)
    v_mfma_f32_32x32x16_bf16 v[16:31], v[232:235], v[88:91], v[16:31]
    s_add_u32 m0, s87, 0
    s_add_u32 s60, s86, 14336
    buffer_load_dwordx4 v240, s[28:31], s60 offen lds
    v_mfma_f32_32x32x16_bf16 v[32:47], v[232:235], v[92:95], v[32:47]
    s_add_u32 m0, s87, 1024
    s_add_u32 s60, s60, 7168
    buffer_load_dwordx4 v240, s[28:31], s60 offen lds
    s_waitcnt lgkmcnt(4)
    v_mfma_f32_32x32x16_bf16 v[48:63], v[236:239], v[88:91], v[48:63]
    s_waitcnt vmcnt(3)
    s_bfe_u32 s84, s88, 0x40010
    s_lshl_b32 s84, s84, 12
    s_add_u32 s84, s84, s90
    s_add_u32 s85, s84, 147456
    buffer_load_dwordx4 v[80:83], v11, s[24:27], s84 offen offset:0 sc1
    v_mfma_f32_32x32x16_bf16 v[64:79], v[236:239], v[92:95], v[64:79]
    buffer_load_dwordx4 v[84:87], v11, s[24:27], s85 offen offset:0 sc1
    s_waitcnt vmcnt(3)
    s_waitcnt vmcnt(57)
    ds_read_b64_tr_b16 v[232:233], v242 offset:6144
    ds_read_b64_tr_b16 v[234:235], v242 offset:7168
    ds_read_b64_tr_b16 v[236:237], v243 offset:6144
    ds_read_b64_tr_b16 v[238:239], v243 offset:7168
    s_waitcnt vmcnt(30)
    s_waitcnt lgkmcnt(6)
    v_mfma_f32_32x32x16_bf16 v[16:31], v[224:227], v[96:99], v[16:31]
    s_add_u32 m0, s87, 2048
    s_add_u32 s60, s86, 28672
    buffer_load_dwordx4 v240, s[28:31], s60 offen lds
    v_mfma_f32_32x32x16_bf16 v[32:47], v[224:227], v[100:103], v[32:47]
    s_add_u32 m0, s87, 3072
    s_add_u32 s60, s60, 7168
    buffer_load_dwordx4 v240, s[28:31], s60 offen lds
    s_waitcnt lgkmcnt(4)
    v_mfma_f32_32x32x16_bf16 v[48:63], v[228:231], v[96:99], v[48:63]
    s_waitcnt vmcnt(3)
    buffer_load_dwordx4 v[88:91], v11, s[24:27], s84 offen offset:1024 sc1
    v_mfma_f32_32x32x16_bf16 v[64:79], v[228:231], v[100:103], v[64:79]
    buffer_load_dwordx4 v[92:95], v11, s[24:27], s85 offen offset:1024 sc1
    s_waitcnt vmcnt(3)
    s_waitcnt vmcnt(59)
    ds_read_b64_tr_b16 v[224:225], v242 offset:8192
    ds_read_b64_tr_b16 v[226:227], v242 offset:9216
    ds_read_b64_tr_b16 v[228:229], v243 offset:8192
    ds_read_b64_tr_b16 v[230:231], v243 offset:9216
    s_waitcnt vmcnt(32)
    s_waitcnt lgkmcnt(6)
    v_mfma_f32_32x32x16_bf16 v[16:31], v[232:235], v[104:107], v[16:31]
    s_add_u32 m0, s87, 4096
    s_add_u32 s60, s86, 43008
    buffer_load_dwordx4 v240, s[28:31], s60 offen lds
    v_mfma_f32_32x32x16_bf16 v[32:47], v[232:235], v[108:111], v[32:47]
    s_add_u32 m0, s87, 5120
    s_add_u32 s60, s60, 7168
    buffer_load_dwordx4 v240, s[28:31], s60 offen lds
    s_waitcnt lgkmcnt(4)
    v_mfma_f32_32x32x16_bf16 v[48:63], v[236:239], v[104:107], v[48:63]
    s_waitcnt vmcnt(3)
    buffer_load_dwordx4 v[96:99], v11, s[24:27], s84 offen offset:2048 sc1
    v_mfma_f32_32x32x16_bf16 v[64:79], v[236:239], v[108:111], v[64:79]
    buffer_load_dwordx4 v[100:103], v11, s[24:27], s85 offen offset:2048 sc1
    s_waitcnt vmcnt(3)
    v_mov_b32 v211, s3
    s_mov_b32 s52, 0x40000
L_dg29:
    ds_read_b32 v212, v211 offset:4
    s_waitcnt lgkmcnt(0)
    v_readfirstlane_b32 s60, v212
    s_nop 0
    s_cmp_lg_u32 s60, 0
    s_cbranch_scc1 L_dg30
    s_sleep 4
    s_sub_u32 s52, s52, 1
    s_cmp_lg_u32 s52, 0
    s_cbranch_scc1 L_dg29
L_dg30:
    s_waitcnt vmcnt(61)
    ds_read_b64_tr_b16 v[232:233], v242 offset:10240
    ds_read_b64_tr_b16 v[234:235], v242 offset:11264
    ds_read_b64_tr_b16 v[236:237], v243 offset:10240
    ds_read_b64_tr_b16 v[238:239], v243 offset:11264
    s_waitcnt vmcnt(34)
    s_waitcnt lgkmcnt(6)
    v_mfma_f32_32x32x16_bf16 v[16:31], v[224:227], v[112:115], v[16:31]
    s_bfe_u32 s86, s88, 0x40010
    s_mul_i32 s86, s86, 57344
    s_add_u32 s86, s86, s89
    s_add_u32 m0, s87, 6144
    s_add_u32 s60, s86, 0
    buffer_load_dwordx4 v240, s[28:31], s60 offen lds
    v_mfma_f32_32x32x16_bf16 v[32:47], v[224:227], v[116:119], v[32:47]
    s_add_u32 m0, s87, 7168
    s_add_u32 s60, s60, 7168
    buffer_load_dwordx4 v240, s[28:31], s60 offen lds
    s_waitcnt lgkmcnt(4)
    v_mfma_f32_32x32x16_bf16 v[48:63], v[228:231], v[112:115], v[48:63]
    buffer_load_dwordx4 v[104:107], v11, s[24:27], s84 offen offset:3072 sc1
    v_mfma_f32_32x32x16_bf16 v[64:79], v[228:231], v[116:119], v[64:79]
    buffer_load_dwordx4 v[108:111], v11, s[24:27], s85 offen offset:3072 sc1
    s_waitcnt vmcnt(63)
    ds_read_b64_tr_b16 v[224:225], v242 offset:12288
    ds_read_b64_tr_b16 v[226:227], v242 offset:13312
    ds_read_b64_tr_b16 v[228:229], v243 offset:12288
    ds_read_b64_tr_b16 v[230:231], v243 offset:13312
    s_waitcnt vmcnt(36)
    s_waitcnt lgkmcnt(6)
    v_mfma_f32_32x32x16_bf16 v[16:31], v[232:235], v[120:123], v[16:31]
    s_add_u32 m0, s87, 8192
    s_add_u32 s60, s86, 14336
    buffer_load_dwordx4 v240, s[28:31], s60 offen lds
    v_mfma_f32_32x32x16_bf16 v[32:47], v[232:235], v[124:127], v[32:47]
    s_add_u32 m0, s87, 9216
    s_add_u32 s60, s60, 7168
    buffer_load_dwordx4 v240, s[28:31], s60 offen lds
    s_waitcnt lgkmcnt(4)
    v_mfma_f32_32x32x16_bf16 v[48:63], v[236:239], v[120:123], v[48:63]
    s_bfe_u32 s84, s88, 0x40014
    s_lshl_b32 s84, s84, 12
    s_add_u32 s84, s84, s90
    s_add_u32 s85, s84, 147456
    buffer_load_dwordx4 v[112:115], v11, s[24:27], s84 offen offset:0 sc1
    v_mfma_f32_32x32x16_bf16 v[64:79], v[236:239], v[124:127], v[64:79]
    buffer_load_dwordx4 v[116:119], v11, s[24:27], s85 offen offset:0 sc1
    s_waitcnt vmcnt(63)
    ds_read_b64_tr_b16 v[232:233], v242 offset:14336
    ds_read_b64_tr_b16 v[234:235], v242 offset:15360
    ds_read_b64_tr_b16 v[236:237], v243 offset:14336
    ds_read_b64_tr_b16 v[238:239], v243 offset:15360
    s_waitcnt vmcnt(38)
    s_waitcnt lgkmcnt(6)
    v_mfma_f32_32x32x16_bf16 v[16:31], v[224:227], v[128:131], v[16:31]
    s_add_u32 m0, s87, 10240
    s_add_u32 s60, s86, 28672
    buffer_load_dwordx4 v240, s[28:31], s60 offen lds
    v_mfma_f32_32x32x16_bf16 v[32:47], v[224:227], v[132:135], v[32:47]
    s_add_u32 m0, s87, 11264
    s_add_u32 s60, s60, 7168
    buffer_load_dwordx4 v240, s[28:31], s60 offen lds
    s_waitcnt lgkmcnt(4)
    v_mfma_f32_32x32x16_bf16 v[48:63], v[228:231], v[128:131], v[48:63]
    buffer_load_dwordx4 v[120:123], v11, s[24:27], s84 offen offset:1024 sc1
    v_mfma_f32_32x32x16_bf16 v[64:79], v[228:231], v[132:135], v[64:79]
    buffer_load_dwordx4 v[124:127], v11, s[24:27], s85 offen offset:1024 sc1
    s_waitcnt vmcnt(63)
    ds_read_b64_tr_b16 v[224:225], v242 offset:16384
    ds_read_b64_tr_b16 v[226:227], v242 offset:17408
    ds_read_b64_tr_b16 v[228:229], v243 offset:16384
    ds_read_b64_tr_b16 v[230:231], v243 offset:17408
    s_waitcnt vmcnt(40)
    s_waitcnt lgkmcnt(6)
    v_mfma_f32_32x32x16_bf16 v[16:31], v[232:235], v[136:139], v[16:31]
    s_add_u32 m0, s87, 12288
    s_add_u32 s60, s86, 43008
    buffer_load_dwordx4 v240, s[28:31], s60 offen lds
    v_mfma_f32_32x32x16_bf16 v[32:47], v[232:235], v[140:143], v[32:47]
    s_add_u32 m0, s87, 13312
    s_add_u32 s60, s60, 7168
    buffer_load_dwordx4 v240, s[28:31], s60 offen lds
    s_waitcnt lgkmcnt(4)
    v_mfma_f32_32x32x16_bf16 v[48:63], v[236:239], v[136:139], v[48:63]
    buffer_load_dwordx4 v[128:131], v11, s[24:27], s84 offen offset:2048 sc1
    v_mfma_f32_32x32x16_bf16 v[64:79], v[236:239], v[140:143], v[64:79]
    buffer_load_dwordx4 v[132:135], v11, s[24:27], s85 offen offset:2048 sc1
    s_waitcnt vmcnt(63)
    ds_read_b64_tr_b16 v[232:233], v242 offset:18432
    ds_read_b64_tr_b16 v[234:235], v242 offset:19456
    ds_read_b64_tr_b16 v[236:237], v243 offset:18432
    ds_read_b64_tr_b16 v[238:239], v243 offset:19456
    s_waitcnt vmcnt(42)
    s_waitcnt lgkmcnt(6)
    v_mfma_f32_32x32x16_bf16 v[16:31], v[224:227], v[144:147], v[16:31]
    s_bfe_u32 s86, s88, 0x40014
    s_mul_i32 s86, s86, 57344
    s_add_u32 s86, s86, s89
    s_add_u32 m0, s87, 14336
    s_add_u32 s60, s86, 0
    buffer_load_dwordx4 v240, s[28:31], s60 offen lds
    v_mfma_f32_32x32x16_bf16 v[32:47], v[224:227], v[148:151], v[32:47]
    s_add_u32 m0, s87, 15360
    s_add_u32 s60, s60, 7168
    buffer_load_dwordx4 v240, s[28:31], s60 offen lds
    s_waitcnt lgkmcnt(4)
    v_mfma_f32_32x32x16_bf16 v[48:63], v[228:231], v[144:147], v[48:63]
    buffer_load_dwordx4 v[136:139], v11, s[24:27], s84 offen offset:3072 sc1
    v_mfma_f32_32x32x16_bf16 v[64:79], v[228:231], v[148:151], v[64:79]
    buffer_load_dwordx4 v[140:143], v11, s[24:27], s85 offen offset:3072 sc1
    s_waitcnt vmcnt(63)
    ds_read_b64_tr_b16 v[224:225], v242 offset:20480
    ds_read_b64_tr_b16 v[226:227], v242 offset:21504
    ds_read_b64_tr_b16 v[228:229], v243 offset:20480
    ds_read_b64_tr_b16 v[230:231], v243 offset:21504
    s_waitcnt vmcnt(44)
    s_waitcnt lgkmcnt(6)
    v_mfma_f32_32x32x16_bf16 v[16:31], v[232:235], v[152:155], v[16:31]
    s_add_u32 m0, s87, 16384
    s_add_u32 s60, s86, 14336
    buffer_load_dwordx4 v240, s[28:31], s60 offen lds
    v_mfma_f32_32x32x16_bf16 v[32:47], v[232:235], v[156:159], v[32:47]
    s_add_u32 m0, s87, 17408
    s_add_u32 s60, s60, 7168
    buffer_load_dwordx4 v240, s[28:31], s60 offen lds
    s_waitcnt lgkmcnt(4)
    v_mfma_f32_32x32x16_bf16 v[48:63], v[236:239], v[152:155], v[48:63]
    s_bfe_u32 s84, s88, 0x40018
    s_lshl_b32 s84, s84, 12
    s_add_u32 s84, s84, s90
    s_add_u32 s85, s84, 147456
    buffer_load_dwordx4 v[144:147], v11, s[24:27], s84 offen offset:0 sc1
    v_mfma_f32_32x32x16_bf16 v[64:79], v[236:239], v[156:159], v[64:79]
    buffer_load_dwordx4 v[148:151], v11, s[24:27], s85 offen offset:0 sc1
    s_waitcnt vmcnt(63)
    ds_read_b64_tr_b16 v[232:233], v242 offset:22528
    ds_read_b64_tr_b16 v[234:235], v242 offset:23552
    ds_read_b64_tr_b16 v[236:237], v243 offset:22528
    ds_read_b64_tr_b16 v[238:239], v243 offset:23552
    s_waitcnt vmcnt(46)
    s_waitcnt lgkmcnt(6)
    v_mfma_f32_32x32x16_bf16 v[16:31], v[224:227], v[160:163], v[16:31]
    s_add_u32 m0, s87, 18432
    s_add_u32 s60, s86, 28672
    buffer_load_dwordx4 v240, s[28:31], s60 offen lds
    v_mfma_f32_32x32x16_bf16 v[32:47], v[224:227], v[164:167], v[32:47]
    s_add_u32 m0, s87, 19456
    s_add_u32 s60, s60, 7168
    buffer_load_dwordx4 v240, s[28:31], s60 offen lds
    s_waitcnt lgkmcnt(4)
    v_mfma_f32_32x32x16_bf16 v[48:63], v[228:231], v[160:163], v[48:63]
    buffer_load_dwordx4 v[152:155], v11, s[24:27], s84 offen offset:1024 sc1
    v_mfma_f32_32x32x16_bf16 v[64:79], v[228:231], v[164:167], v[64:79]
    buffer_load_dwordx4 v[156:159], v11, s[24:27], s85 offen offset:1024 sc1
    s_waitcnt vmcnt(63)
    ds_read_b64_tr_b16 v[224:225], v242 offset:24576
    ds_read_b64_tr_b16 v[226:227], v242 offset:25600
    ds_read_b64_tr_b16 v[228:229], v243 offset:24576
    ds_read_b64_tr_b16 v[230:231], v243 offset:25600
    s_waitcnt vmcnt(48)
    s_waitcnt lgkmcnt(6)
    v_mfma_f32_32x32x16_bf16 v[16:31], v[232:235], v[168:171], v[16:31]
    s_add_u32 m0, s87, 20480
    s_add_u32 s60, s86, 43008
    buffer_load_dwordx4 v240, s[28:31], s60 offen lds
    v_mfma_f32_32x32x16_bf16 v[32:47], v[232:235], v[172:175], v[32:47]
    s_add_u32 m0, s87, 21504
    s_add_u32 s60, s60, 7168
    buffer_load_dwordx4 v240, s[28:31], s60 offen lds
    s_waitcnt lgkmcnt(4)
    v_mfma_f32_32x32x16_bf16 v[48:63], v[236:239], v[168:171], v[48:63]
    buffer_load_dwordx4 v[160:163], v11, s[24:27], s84 offen offset:2048 sc1
    v_mfma_f32_32x32x16_bf16 v[64:79], v[236:239], v[172:175], v[64:79]
    buffer_load_dwordx4 v[164:167], v11, s[24:27], s85 offen offset:2048 sc1
    s_waitcnt vmcnt(42)
    ds_read_b64_tr_b16 v[232:233], v242 offset:0
    ds_read_b64_tr_b16 v[234:235], v242 offset:1024
    ds_read_b64_tr_b16 v[236:237], v243 offset:0
    ds_read_b64_tr_b16 v[238:239], v243 offset:1024
    s_waitcnt vmcnt(50)
    s_waitcnt lgkmcnt(6)
    v_mfma_f32_32x32x16_bf16 v[16:31], v[224:227], v[176:179], v[16:31]
    s_bfe_u32 s86, s88, 0x40018
    s_mul_i32 s86, s86, 57344
    s_add_u32 s86, s86, s89
    s_add_u32 m0, s87, 22528
    s_add_u32 s60, s86, 0
    buffer_load_dwordx4 v240, s[28:31], s60 offen lds
    v_mfma_f32_32x32x16_bf16 v[32:47], v[224:227], v[180:183], v[32:47]
    s_add_u32 m0, s87, 23552
    s_add_u32 s60, s60, 7168
    buffer_load_dwordx4 v240, s[28:31], s60 offen lds
    s_waitcnt lgkmcnt(4)
    v_mfma_f32_32x32x16_bf16 v[48:63], v[228:231], v[176:179], v[48:63]
    buffer_load_dwordx4 v[168:171], v11, s[24:27], s84 offen offset:3072 sc1
    v_mfma_f32_32x32x16_bf16 v[64:79], v[228:231], v[180:183], v[64:79]
    buffer_load_dwordx4 v[172:175], v11, s[24:27], s85 offen offset:3072 sc1
    s_waitcnt vmcnt(42)
    ds_read_b64_tr_b16 v[224:225], v242 offset:2048
    ds_read_b64_tr_b16 v[226:227], v242 offset:3072
    ds_read_b64_tr_b16 v[228:229], v243 offset:2048
    ds_read_b64_tr_b16 v[230:231], v243 offset:3072
    s_waitcnt vmcnt(52)
    s_waitcnt lgkmcnt(6)
    v_mfma_f32_32x32x16_bf16 v[16:31], v[232:235], v[184:187], v[16:31]
    s_add_u32 m0, s87, 24576
    s_add_u32 s60, s86, 14336
    buffer_load_dwordx4 v240, s[28:31], s60 offen lds
    v_mfma_f32_32x32x16_bf16 v[32:47], v[232:235], v[188:191], v[32:47]
    s_add_u32 m0, s87, 25600
    s_add_u32 s60, s60, 7168
    buffer_load_dwordx4 v240, s[28:31], s60 offen lds
    s_waitcnt lgkmcnt(4)
    v_mfma_f32_32x32x16_bf16 v[48:63], v[236:239], v[184:187], v[48:63]
    v_mfma_f32_32x32x16_bf16 v[64:79], v[236:239], v[188:191], v[64:79]
    s_waitcnt vmcnt(40)
    ds_read_b64_tr_b16 v[232:233], v242 offset:4096
    ds_read_b64_tr_b16 v[234:235], v242 offset:5120
    ds_read_b64_tr_b16 v[236:237], v243 offset:4096
    ds_read_b64_tr_b16 v[238:239], v243 offset:5120
    s_waitcnt vmcnt(52)
    s_waitcnt lgkmcnt(6)
    v_mfma_f32_32x32x16_bf16 v[16:31], v[224:227], v[192:195], v[16:31]
    s_add_u32 m0, s87, 0
    s_add_u32 s60, s86, 28672
    buffer_load_dwordx4 v240, s[28:31], s60 offen lds
    v_mfma_f32_32x32x16_bf16 v[32:47], v[224:227], v[196:199], v[32:47]
    s_add_u32 m0, s87, 1024
    s_add_u32 s60, s60, 7168
    buffer_load_dwordx4 v240, s[28:31], s60 offen lds
    s_waitcnt lgkmcnt(4)
    v_mfma_f32_32x32x16_bf16 v[48:63], v[228:231], v[192:195], v[48:63]
    v_mfma_f32_32x32x16_bf16 v[64:79], v[228:231], v[196:199], v[64:79]
    s_waitcnt vmcnt(38)
    ds_read_b64_tr_b16 v[224:225], v242 offset:6144
    ds_read_b64_tr_b16 v[226:227], v242 offset:7168
    ds_read_b64_tr_b16 v[228:229], v243 offset:6144
    ds_read_b64_tr_b16 v[230:231], v243 offset:7168
    s_waitcnt vmcnt(52)
    s_waitcnt lgkmcnt(6)
    v_mfma_f32_32x32x16_bf16 v[16:31], v[232:235], v[200:203], v[16:31]
    s_add_u32 m0, s87, 2048
    s_add_u32 s60, s86, 43008
    buffer_load_dwordx4 v240, s[28:31], s60 offen lds
    v_mfma_f32_32x32x16_bf16 v[32:47], v[232:235], v[204:207], v[32:47]
    s_add_u32 m0, s87, 3072
    s_add_u32 s60, s60, 7168
    buffer_load_dwordx4 v240, s[28:31], s60 offen lds
    s_waitcnt lgkmcnt(4)
    v_mfma_f32_32x32x16_bf16 v[48:63], v[236:239], v[200:203], v[48:63]
    v_mfma_f32_32x32x16_bf16 v[64:79], v[236:239], v[204:207], v[64:79]
    s_waitcnt vmcnt(36)
    ds_read_b64_tr_b16 v[232:233], v242 offset:8192
    ds_read_b64_tr_b16 v[234:235], v242 offset:9216
    ds_read_b64_tr_b16 v[236:237], v243 offset:8192
    ds_read_b64_tr_b16 v[238:239], v243 offset:9216
    s_waitcnt vmcnt(50)
    s_waitcnt lgkmcnt(6)
    v_mfma_f32_32x32x16_bf16 v[16:31], v[224:227], v[80:83], v[16:31]
    s_mul_i32 s86, s58, 100352
    s_lshl_b32 s60, s83, 7
    s_add_u32 s86, s86, s60
    s_add_u32 m0, s87, 4096
    s_add_u32 s60, s86, 0
    buffer_load_dwordx4 v240, s[32:35], s60 offen lds
    v_mfma_f32_32x32x16_bf16 v[32:47], v[224:227], v[84:87], v[32:47]
    s_add_u32 m0, s87, 5120
    s_add_u32 s60, s60, 7168
    buffer_load_dwordx4 v240, s[32:35], s60 offen lds
    s_waitcnt lgkmcnt(4)
    v_mfma_f32_32x32x16_bf16 v[48:63], v[228:231], v[80:83], v[48:63]
    v_mfma_f32_32x32x16_bf16 v[64:79], v[228:231], v[84:87], v[64:79]
    s_waitcnt vmcnt(34)
    ds_read_b64_tr_b16 v[224:225], v242 offset:10240
    ds_read_b64_tr_b16 v[226:227], v242 offset:11264
    ds_read_b64_tr_b16 v[228:229], v243 offset:10240
    ds_read_b64_tr_b16 v[230:231], v243 offset:11264
    s_waitcnt vmcnt(48)
    s_waitcnt lgkmcnt(6)
    v_mfma_f32_32x32x16_bf16 v[16:31], v[232:235], v[88:91], v[16:31]
    s_add_u32 m0, s87, 6144
    s_add_u32 s60, s86, 14336
    buffer_load_dwordx4 v240, s[32:35], s60 offen lds
    v_mfma_f32_32x32x16_bf16 v[32:47], v[232:235], v[92:95], v[32:47]
    s_add_u32 m0, s87, 7168
    s_add_u32 s60, s60, 7168
    buffer_load_dwordx4 v240, s[32:35], s60 offen lds
    s_waitcnt lgkmcnt(4)
    v_mfma_f32_32x32x16_bf16 v[48:63], v[236:239], v[88:91], v[48:63]
    v_mfma_f32_32x32x16_bf16 v[64:79], v[236:239], v[92:95], v[64:79]
    s_waitcnt vmcnt(32)
    ds_read_b64_tr_b16 v[232:233], v242 offset:12288
    ds_read_b64_tr_b16 v[234:235], v242 offset:13312
    ds_read_b64_tr_b16 v[236:237], v243 offset:12288
    ds_read_b64_tr_b16 v[238:239], v243 offset:13312
    s_waitcnt vmcnt(46)
    s_waitcnt lgkmcnt(6)
    v_mfma_f32_32x32x16_bf16 v[16:31], v[224:227], v[96:99], v[16:31]
    s_add_u32 m0, s87, 8192
    s_add_u32 s60, s86, 25088
    buffer_load_dwordx4 v240, s[32:35], s60 offen lds
    v_mfma_f32_32x32x16_bf16 v[32:47], v[224:227], v[100:103], v[32:47]
    s_add_u32 m0, s87, 9216
    s_add_u32 s60, s60, 7168
    buffer_load_dwordx4 v240, s[32:35], s60 offen lds
    s_waitcnt lgkmcnt(4)
    v_mfma_f32_32x32x16_bf16 v[48:63], v[228:231], v[96:99], v[48:63]
    v_mfma_f32_32x32x16_bf16 v[64:79], v[228:231], v[100:103], v[64:79]
    s_waitcnt vmcnt(30)
    ds_read_b64_tr_b16 v[224:225], v242 offset:14336
    ds_read_b64_tr_b16 v[226:227], v242 offset:15360
    ds_read_b64_tr_b16 v[228:229], v243 offset:14336
    ds_read_b64_tr_b16 v[230:231], v243 offset:15360
    s_waitcnt vmcnt(44)
    s_waitcnt lgkmcnt(6)
    v_mfma_f32_32x32x16_bf16 v[16:31], v[232:235], v[104:107], v[16:31]
    s_add_u32 m0, s87, 10240
    s_add_u32 s60, s86, 39424
    buffer_load_dwordx4 v240, s[32:35], s60 offen lds
    v_mfma_f32_32x32x16_bf16 v[32:47], v[232:235], v[108:111], v[32:47]
    s_add_u32 m0, s87, 11264
    s_add_u32 s60, s60, 7168
    buffer_load_dwordx4 v240, s[32:35], s60 offen lds
    s_waitcnt lgkmcnt(4)
    v_mfma_f32_32x32x16_bf16 v[48:63], v[236:239], v[104:107], v[48:63]
    v_mfma_f32_32x32x16_bf16 v[64:79], v[236:239], v[108:111], v[64:79]
    s_waitcnt vmcnt(28)
    ds_read_b64_tr_b16 v[232:233], v242 offset:16384
    ds_read_b64_tr_b16 v[234:235], v242 offset:17408
    ds_read_b64_tr_b16 v[236:237], v243 offset:16384
    ds_read_b64_tr_b16 v[238:239], v243 offset:17408
    s_waitcnt vmcnt(42)
    s_waitcnt lgkmcnt(6)
    v_mfma_f32_32x32x16_bf16 v[16:31], v[224:227], v[112:115], v[16:31]
    s_add_u32 m0, s87, 12288
    s_add_u32 s60, s86, 50176
    buffer_load_dwordx4 v240, s[32:35], s60 offen lds
    v_mfma_f32_32x32x16_bf16 v[32:47], v[224:227], v[116:119], v[32:47]
    s_add_u32 m0, s87, 13312
    s_add_u32 s60, s60, 7168
    buffer_load_dwordx4 v240, s[32:35], s60 offen lds
    s_waitcnt lgkmcnt(4)
    v_mfma_f32_32x32x16_bf16 v[48:63], v[228:231], v[112:115], v[48:63]
    v_mfma_f32_32x32x16_bf16 v[64:79], v[228:231], v[116:119], v[64:79]
    s_waitcnt vmcnt(26)
    ds_read_b64_tr_b16 v[224:225], v242 offset:18432
    ds_read_b64_tr_b16 v[226:227], v242 offset:19456
    ds_read_b64_tr_b16 v[228:229], v243 offset:18432
    ds_read_b64_tr_b16 v[230:231], v243 offset:19456
    s_waitcnt vmcnt(40)
    s_waitcnt lgkmcnt(6)
    v_mfma_f32_32x32x16_bf16 v[16:31], v[232:235], v[120:123], v[16:31]
    s_add_u32 m0, s87, 14336
    s_add_u32 s60, s86, 64512
    buffer_load_dwordx4 v240, s[32:35], s60 offen lds
    v_mfma_f32_32x32x16_bf16 v[32:47], v[232:235], v[124:127], v[32:47]
    s_add_u32 m0, s87, 15360
    s_add_u32 s60, s60, 7168
    buffer_load_dwordx4 v240, s[32:35], s60 offen lds
    s_waitcnt lgkmcnt(4)
    v_mfma_f32_32x32x16_bf16 v[48:63], v[236:239], v[120:123], v[48:63]
    v_mfma_f32_32x32x16_bf16 v[64:79], v[236:239], v[124:127], v[64:79]
    s_waitcnt vmcnt(24)
    ds_read_b64_tr_b16 v[232:233], v242 offset:20480
    ds_read_b64_tr_b16 v[234:235], v242 offset:21504
    ds_read_b64_tr_b16 v[236:237], v243 offset:20480
    ds_read_b64_tr_b16 v[238:239], v243 offset:21504
    s_waitcnt vmcnt(38)
    s_waitcnt lgkmcnt(6)
    v_mfma_f32_32x32x16_bf16 v[16:31], v[224:227], v[128:131], v[16:31]
    s_add_u32 m0, s87, 16384
    s_add_u32 s60, s86, 75264
    buffer_load_dwordx4 v240, s[32:35], s60 offen lds
    v_mfma_f32_32x32x16_bf16 v[32:47], v[224:227], v[132:135], v[32:47]
    s_add_u32 m0, s87, 17408
    s_add_u32 s60, s60, 7168
    buffer_load_dwordx4 v240, s[32:35], s60 offen lds
    s_waitcnt lgkmcnt(4)
    v_mfma_f32_32x32x16_bf16 v[48:63], v[228:231], v[128:131], v[48:63]
    v_mfma_f32_32x32x16_bf16 v[64:79], v[228:231], v[132:135], v[64:79]
    s_waitcnt vmcnt(22)
    ds_read_b64_tr_b16 v[224:225], v242 offset:22528
    ds_read_b64_tr_b16 v[226:227], v242 offset:23552
    ds_read_b64_tr_b16 v[228:229], v243 offset:22528
    ds_read_b64_tr_b16 v[230:231], v243 offset:23552
    s_waitcnt vmcnt(36)
    s_waitcnt lgkmcnt(6)
    v_mfma_f32_32x32x16_bf16 v[16:31], v[232:235], v[136:139], v[16:31]
    s_add_u32 m0, s87, 18432
    s_add_u32 s60, s86, 89600
    buffer_load_dwordx4 v240, s[32:35], s60 offen lds
    v_mfma_f32_32x32x16_bf16 v[32:47], v[232:235], v[140:143], v[32:47]
    s_add_u32 m0, s87, 19456
    s_add_u32 s60, s60, 7168
    buffer_load_dwordx4 v240, s[32:35], s60 offen lds
    s_waitcnt lgkmcnt(4)
    v_mfma_f32_32x32x16_bf16 v[48:63], v[236:239], v[136:139], v[48:63]
    v_mfma_f32_32x32x16_bf16 v[64:79], v[236:239], v[140:143], v[64:79]
    s_waitcnt vmcnt(20)
    ds_read_b64_tr_b16 v[232:233], v242 offset:24576
    ds_read_b64_tr_b16 v[234:235], v242 offset:25600
    ds_read_b64_tr_b16 v[236:237], v243 offset:24576
    ds_read_b64_tr_b16 v[238:239], v243 offset:25600
    s_waitcnt vmcnt(34)
    s_waitcnt lgkmcnt(6)
    v_mfma_f32_32x32x16_bf16 v[16:31], v[224:227], v[144:147], v[16:31]
    v_mfma_f32_32x32x16_bf16 v[32:47], v[224:227], v[148:151], v[32:47]
    s_waitcnt lgkmcnt(4)
    v_mfma_f32_32x32x16_bf16 v[48:63], v[228:231], v[144:147], v[48:63]
    v_mfma_f32_32x32x16_bf16 v[64:79], v[228:231], v[148:151], v[64:79]
    s_waitcnt vmcnt(18)
    ds_read_b64_tr_b16 v[224:225], v242 offset:0
    ds_read_b64_tr_b16 v[226:227], v242 offset:1024
    ds_read_b64_tr_b16 v[228:229], v243 offset:0
    ds_read_b64_tr_b16 v[230:231], v243 offset:1024
    s_waitcnt vmcnt(30)
    s_waitcnt lgkmcnt(6)
    v_mfma_f32_32x32x16_bf16 v[16:31], v[232:235], v[152:155], v[16:31]
    v_mfma_f32_32x32x16_bf16 v[32:47], v[232:235], v[156:159], v[32:47]
    s_waitcnt lgkmcnt(4)
    v_mfma_f32_32x32x16_bf16 v[48:63], v[236:239], v[152:155], v[48:63]
    v_mfma_f32_32x32x16_bf16 v[64:79], v[236:239], v[156:159], v[64:79]
    s_waitcnt vmcnt(16)
    ds_read_b64_tr_b16 v[232:233], v242 offset:2048
    ds_read_b64_tr_b16 v[234:235], v242 offset:3072
    ds_read_b64_tr_b16 v[236:237], v243 offset:2048
    ds_read_b64_tr_b16 v[238:239], v243 offset:3072
    s_waitcnt vmcnt(26)
    s_waitcnt lgkmcnt(6)
    v_mfma_f32_32x32x16_bf16 v[16:31], v[224:227], v[160:163], v[16:31]
    v_mfma_f32_32x32x16_bf16 v[32:47], v[224:227], v[164:167], v[32:47]
    s_waitcnt lgkmcnt(4)
    v_mfma_f32_32x32x16_bf16 v[48:63], v[228:231], v[160:163], v[48:63]
    v_mfma_f32_32x32x16_bf16 v[64:79], v[228:231], v[164:167], v[64:79]
    s_waitcnt vmcnt(22)
    s_waitcnt lgkmcnt(2)
    v_mfma_f32_32x32x16_bf16 v[16:31], v[232:235], v[168:171], v[16:31]
    v_mfma_f32_32x32x16_bf16 v[32:47], v[232:235], v[172:175], v[32:47]
    s_waitcnt lgkmcnt(0)
    v_mfma_f32_32x32x16_bf16 v[48:63], v[236:239], v[168:171], v[48:63]
    v_mfma_f32_32x32x16_bf16 v[64:79], v[236:239], v[172:175], v[64:79]
    v_sub_f32 v246, 1.0, v246
    v_sub_f32 v247, 1.0, v247
    s_waitcnt vmcnt(0)
    ds_read_b64_tr_b16 v[112:113], v242 offset:4096
    ds_read_b64_tr_b16 v[114:115], v242 offset:5120
    ds_read_b64_tr_b16 v[116:117], v243 offset:4096
    ds_read_b64_tr_b16 v[118:119], v243 offset:5120
    ds_read_b64_tr_b16 v[120:121], v242 offset:6144
    ds_read_b64_tr_b16 v[122:123], v242 offset:7168
    ds_read_b64_tr_b16 v[124:125], v243 offset:6144
    ds_read_b64_tr_b16 v[126:127], v243 offset:7168
    ds_read_b64_tr_b16 v[128:129], v242 offset:8192
    ds_read_b64_tr_b16 v[130:131], v242 offset:9216
    ds_read_b64_tr_b16 v[132:133], v243 offset:8192
    ds_read_b64_tr_b16 v[134:135], v243 offset:9216
    ds_read_b64_tr_b16 v[136:137], v242 offset:10240
    ds_read_b64_tr_b16 v[138:139], v242 offset:11264
    ds_read_b64_tr_b16 v[140:141], v243 offset:10240
    ds_read_b64_tr_b16 v[142:143], v243 offset:11264
    ds_read_b64_tr_b16 v[144:145], v242 offset:12288
    ds_read_b64_tr_b16 v[146:147], v242 offset:13312
    ds_read_b64_tr_b16 v[148:149], v243 offset:12288
    ds_read_b64_tr_b16 v[150:151], v243 offset:13312
    ds_read_b64_tr_b16 v[152:153], v242 offset:14336
    ds_read_b64_tr_b16 v[154:155], v242 offset:15360
    ds_read_b64_tr_b16 v[156:157], v243 offset:14336
    ds_read_b64_tr_b16 v[158:159], v243 offset:15360
    ds_read_b64_tr_b16 v[160:161], v242 offset:16384
    ds_read_b64_tr_b16 v[162:163], v242 offset:17408
    ds_read_b64_tr_b16 v[164:165], v243 offset:16384
    ds_read_b64_tr_b16 v[166:167], v243 offset:17408
    ds_read_b64_tr_b16 v[168:169], v242 offset:18432
    ds_read_b64_tr_b16 v[170:171], v242 offset:19456
    ds_read_b64_tr_b16 v[172:173], v243 offset:18432
    ds_read_b64_tr_b16 v[174:175], v243 offset:19456
    v_mul_f32 v16, v16, v246
    v_mul_f32 v17, v17, v246
    v_mul_f32 v18, v18, v246
    v_mul_f32 v19, v19, v246
    v_mul_f32 v20, v20, v246
    v_mul_f32 v21, v21, v246
    v_mul_f32 v22, v22, v246
    v_mul_f32 v23, v23, v246
    v_mul_f32 v24, v24, v246
    v_mul_f32 v25, v25, v246
    v_mul_f32 v26, v26, v246
    v_mul_f32 v27, v27, v246
    v_mul_f32 v28, v28, v246
    v_mul_f32 v29, v29, v246
    v_mul_f32 v30, v30, v246
    v_mul_f32 v31, v31, v246
    v_mul_f32 v32, v32, v247
    v_mul_f32 v33, v33, v247
    v_mul_f32 v34, v34, v247
    v_mul_f32 v35, v35, v247
    v_mul_f32 v36, v36, v247
    v_mul_f32 v37, v37, v247
    v_mul_f32 v38, v38, v247
    v_mul_f32 v39, v39, v247
    v_mul_f32 v40, v40, v247
    v_mul_f32 v41, v41, v247
    v_mul_f32 v42, v42, v247
    v_mul_f32 v43, v43, v247
    v_mul_f32 v44, v44, v247
    v_mul_f32 v45, v45, v247
    v_mul_f32 v46, v46, v247
    v_mul_f32 v47, v47, v247
    v_mul_f32 v48, v48, v246
    v_mul_f32 v49, v49, v246
    v_mul_f32 v50, v50, v246
    v_mul_f32 v51, v51, v246
    v_mul_f32 v52, v52, v246
    v_mul_f32 v53, v53, v246
    v_mul_f32 v54, v54, v246
    v_mul_f32 v55, v55, v246
    v_mul_f32 v56, v56, v246
    v_mul_f32 v57, v57, v246
    v_mul_f32 v58, v58, v246
    v_mul_f32 v59, v59, v246
    v_mul_f32 v60, v60, v246
    v_mul_f32 v61, v61, v246
    v_mul_f32 v62, v62, v246
    v_mul_f32 v63, v63, v246
    v_mul_f32 v64, v64, v247
    v_mul_f32 v65, v65, v247
    v_mul_f32 v66, v66, v247
    v_mul_f32 v67, v67, v247
    v_mul_f32 v68, v68, v247
    v_mul_f32 v69, v69, v247
    v_mul_f32 v70, v70, v247
    v_mul_f32 v71, v71, v247
    v_mul_f32 v72, v72, v247
    v_mul_f32 v73, v73, v247
    v_mul_f32 v74, v74, v247
    v_mul_f32 v75, v75, v247
    v_mul_f32 v76, v76, v247
    v_mul_f32 v77, v77, v247
    v_mul_f32 v78, v78, v247
    v_mul_f32 v79, v79, v247
    v_lshrrev_b32 v208, 5, v1
    v_mul_u32_u24 v210, 272, v209
    v_lshl_add_u32 v210, v208, 4, v210
    v_add_u32 v210, s87, v210
    s_mov_b32 s52, 0x8000
L_spin32:
    s_mov_b32 s60, 15007744
    buffer_load_dwordx2 v[216:217], v245, s[24:27], s60 offen sc1
    s_waitcnt vmcnt(0)
    s_mov_b64 s[6:7], 0
    v_cmp_ne_u32 vcc, s76, v216
    v_cmp_ne_u32 s[4:5], s77, v217
    s_or_b64 s[6:7], s[6:7], vcc
    s_or_b64 s[6:7], s[6:7], s[4:5]
    s_cmp_eq_u64 s[6:7], 0
    s_cbranch_scc1 L_spind33
    s_nop 0
    s_sub_u32 s52, s52, 1
    s_cmp_lg_u32 s52, 0
    s_cbranch_scc1 L_spin32
L_spind33:
    s_mul_i32 s4, s82, 294912
    s_mul_i32 s60, s58, 8192
    s_add_u32 s4, s4, s60
    s_add_u32 s4, s4, 5619712
    s_add_u32 s5, s4, 147456
    s_add_u32 s6, s4, 4096
    s_add_u32 s7, s5, 4096
    buffer_load_dwordx4 v[176:179], v11, s[24:27], s4 offen offset:0 sc1
    buffer_load_dwordx4 v[184:187], v11, s[24:27], s4 offen offset:1024 sc1
    buffer_load_dwordx4 v[192:195], v11, s[24:27], s4 offen offset:2048 sc1
    buffer_load_dwordx4 v[200:203], v11, s[24:27], s4 offen offset:3072 sc1
    buffer_load_dwordx4 v[80:83], v11, s[24:27], s6 offen offset:0 sc1
    buffer_load_dwordx4 v[88:91], v11, s[24:27], s6 offen offset:1024 sc1
    buffer_load_dwordx4 v[96:99], v11, s[24:27], s6 offen offset:2048 sc1
    buffer_load_dwordx4 v[104:107], v11, s[24:27], s6 offen offset:3072 sc1
    buffer_load_dwordx4 v[180:183], v11, s[24:27], s5 offen offset:0 sc1
    buffer_load_dwordx4 v[188:191], v11, s[24:27], s5 offen offset:1024 sc1
    buffer_load_dwordx4 v[196:199], v11, s[24:27], s5 offen offset:2048 sc1
    buffer_load_dwordx4 v[204:207], v11, s[24:27], s5 offen offset:3072 sc1
    buffer_load_dwordx4 v[84:87], v11, s[24:27], s7 offen offset:0 sc1
    buffer_load_dwordx4 v[92:95], v11, s[24:27], s7 offen offset:1024 sc1
    buffer_load_dwordx4 v[100:103], v11, s[24:27], s7 offen offset:2048 sc1
    buffer_load_dwordx4 v[108:111], v11, s[24:27], s7 offen offset:3072 sc1
    s_waitcnt lgkmcnt(0)
    s_waitcnt vmcnt(15)
    v_mfma_f32_32x32x16_bf16 v[16:31], v[112:115], v[176:179], v[16:31]
    s_waitcnt vmcnt(14)
    v_mfma_f32_32x32x16_bf16 v[16:31], v[120:123], v[184:187], v[16:31]
    s_waitcnt vmcnt(13)
    v_mfma_f32_32x32x16_bf16 v[16:31], v[128:131], v[192:195], v[16:31]
    s_waitcnt vmcnt(12)
    v_mfma_f32_32x32x16_bf16 v[16:31], v[136:139], v[200:203], v[16:31]
    s_waitcnt vmcnt(11)
    v_mfma_f32_32x32x16_bf16 v[16:31], v[144:147], v[80:83], v[16:31]
    s_waitcnt vmcnt(10)
    v_mfma_f32_32x32x16_bf16 v[16:31], v[152:155], v[88:91], v[16:31]
    s_waitcnt vmcnt(9)
    v_mfma_f32_32x32x16_bf16 v[16:31], v[160:163], v[96:99], v[16:31]
    s_waitcnt vmcnt(8)
    v_mfma_f32_32x32x16_bf16 v[16:31], v[168:171], v[104:107], v[16:31]
    v_mfma_f32_32x32x16_bf16 v[48:63], v[116:119], v[176:179], v[48:63]
    v_mfma_f32_32x32x16_bf16 v[48:63], v[124:127], v[184:187], v[48:63]
    v_mfma_f32_32x32x16_bf16 v[48:63], v[132:135], v[192:195], v[48:63]
    v_mfma_f32_32x32x16_bf16 v[48:63], v[140:143], v[200:203], v[48:63]
    v_mfma_f32_32x32x16_bf16 v[48:63], v[148:151], v[80:83], v[48:63]
    s_nop 7
    ds_write_b128 v210, v[16:19] offset:0
    v_mfma_f32_32x32x16_bf16 v[48:63], v[156:159], v[88:91], v[48:63]
    ds_write_b128 v210, v[20:23] offset:32
    v_mfma_f32_32x32x16_bf16 v[48:63], v[164:167], v[96:99], v[48:63]
    ds_write_b128 v210, v[24:27] offset:64
    v_mfma_f32_32x32x16_bf16 v[48:63], v[172:175], v[104:107], v[48:63]
    ds_write_b128 v210, v[28:31] offset:96
    s_waitcnt vmcnt(7)
    v_mfma_f32_32x32x16_bf16 v[32:47], v[112:115], v[180:183], v[32:47]
    s_waitcnt vmcnt(6)
    v_mfma_f32_32x32x16_bf16 v[32:47], v[120:123], v[188:191], v[32:47]
    s_waitcnt vmcnt(5)
    v_mfma_f32_32x32x16_bf16 v[32:47], v[128:131], v[196:199], v[32:47]
    s_waitcnt vmcnt(4)
    v_mfma_f32_32x32x16_bf16 v[32:47], v[136:139], v[204:207], v[32:47]
    s_waitcnt vmcnt(3)
    v_mfma_f32_32x32x16_bf16 v[32:47], v[144:147], v[84:87], v[32:47]
    s_nop 7
    ds_write_b128 v210, v[48:51] offset:128
    s_waitcnt vmcnt(2)
    v_mfma_f32_32x32x16_bf16 v[32:47], v[152:155], v[92:95], v[32:47]
    ds_write_b128 v210, v[52:55] offset:160
    s_waitcnt vmcnt(1)
    v_mfma_f32_32x32x16_bf16 v[32:47], v[160:163], v[100:103], v[32:47]
    ds_write_b128 v210, v[56:59] offset:192
    s_waitcnt vmcnt(0)
    v_mfma_f32_32x32x16_bf16 v[32:47], v[168:171], v[108:111], v[32:47]
    ds_write_b128 v210, v[60:63] offset:224
    v_mfma_f32_32x32x16_bf16 v[64:79], v[116:119], v[180:183], v[64:79]
    v_mfma_f32_32x32x16_bf16 v[64:79], v[124:127], v[188:191], v[64:79]
    v_mfma_f32_32x32x16_bf16 v[64:79], v[132:135], v[196:199], v[64:79]
    v_mfma_f32_32x32x16_bf16 v[64:79], v[140:143], v[204:207], v[64:79]
    v_mfma_f32_32x32x16_bf16 v[64:79], v[148:151], v[84:87], v[64:79]
    s_nop 7
    ds_write_b128 v210, v[32:35] offset:8704
    v_mfma_f32_32x32x16_bf16 v[64:79], v[156:159], v[92:95], v[64:79]
    ds_write_b128 v210, v[36:39] offset:8736
    v_mfma_f32_32x32x16_bf16 v[64:79], v[164:167], v[100:103], v[64:79]
    ds_write_b128 v210, v[40:43] offset:8768
    v_mfma_f32_32x32x16_bf16 v[64:79], v[172:175], v[108:111], v[64:79]
    ds_write_b128 v210, v[44:47] offset:8800
    s_nop 10
    ds_write_b128 v210, v[64:67] offset:8832
    ds_write_b128 v210, v[68:71] offset:8864
    ds_write_b128 v210, v[72:75] offset:8896
    ds_write_b128 v210, v[76:79] offset:8928
    v_and_b32 v212, 255, v0
    v_lshrrev_b32 v208, 3, v212
    v_and_b32 v209, 7, v0
    v_mul_u32_u24 v213, 272, v208
    v_lshl_add_u32 v213, v209, 5, v213
    v_mul_u32_u24 v211, 896, v208
    v_lshl_add_u32 v211, v209, 4, v211
    s_mul_i32 s60, s82, 57344
    s_lshl_b32 s61, s83, 7
    s_add_u32 s60, s60, s61
    s_add_u32 s61, s60, 28672
    v_add_u32 v214, 53248, v213
    s_waitcnt lgkmcnt(0)
    s_barrier
    ds_read_b128 v[16:19], v213 offset:0
    ds_read_b128 v[20:23], v213 offset:16
    ds_read_b128 v[24:27], v213 offset:26624
    ds_read_b128 v[28:31], v213 offset:26640
    ds_read_b128 v[32:35], v214 offset:0
    ds_read_b128 v[36:39], v214 offset:16
    ds_read_b128 v[40:43], v214 offset:26624
    ds_read_b128 v[44:47], v214 offset:26640
    ds_read_b128 v[48:51], v213 offset:8704
    ds_read_b128 v[52:55], v213 offset:8720
    ds_read_b128 v[56:59], v213 offset:35328
    ds_read_b128 v[60:63], v213 offset:35344
    ds_read_b128 v[64:67], v214 offset:8704
    ds_read_b128 v[68:71], v214 offset:8720
    ds_read_b128 v[72:75], v214 offset:35328
    ds_read_b128 v[76:79], v214 offset:35344
    s_waitcnt lgkmcnt(12)
    v_add_f32 v16, v16, v24
    v_add_f32 v17, v17, v25
    v_add_f32 v18, v18, v26
    v_add_f32 v19, v19, v27
    v_add_f32 v20, v20, v28
    v_add_f32 v21, v21, v29
    v_add_f32 v22, v22, v30
    v_add_f32 v23, v23, v31
    s_waitcnt lgkmcnt(8)
    v_add_f32 v32, v32, v40
    v_add_f32 v33, v33, v41
    v_add_f32 v34, v34, v42
    v_add_f32 v35, v35, v43
    v_add_f32 v36, v36, v44
    v_add_f32 v37, v37, v45
    v_add_f32 v38, v38, v46
    v_add_f32 v39, v39, v47
    v_add_f32 v16, v16, v32
    v_add_f32 v17, v17, v33
    v_add_f32 v18, v18, v34
    v_add_f32 v19, v19, v35
    v_add_f32 v20, v20, v36
    v_add_f32 v21, v21, v37
    v_add_f32 v22, v22, v38
    v_add_f32 v23, v23, v39
    v_cvt_pk_bf16_f32 v24, v16, v17
    v_cvt_pk_bf16_f32 v25, v18, v19
    v_cvt_pk_bf16_f32 v26, v20, v21
    v_cvt_pk_bf16_f32 v27, v22, v23
    buffer_store_dwordx4 v[24:27], v211, s[36:39], s60 offen
    s_waitcnt lgkmcnt(4)
    v_add_f32 v48, v48, v56
    v_add_f32 v49, v49, v57
    v_add_f32 v50, v50, v58
    v_add_f32 v51, v51, v59
    v_add_f32 v52, v52, v60
    v_add_f32 v53, v53, v61
    v_add_f32 v54, v54, v62
    v_add_f32 v55, v55, v63
    s_waitcnt lgkmcnt(0)
    v_add_f32 v64, v64, v72
    v_add_f32 v65, v65, v73
    v_add_f32 v66, v66, v74
    v_add_f32 v67, v67, v75
    v_add_f32 v68, v68, v76
    v_add_f32 v69, v69, v77
    v_add_f32 v70, v70, v78
    v_add_f32 v71, v71, v79
    v_add_f32 v48, v48, v64
    v_add_f32 v49, v49, v65
    v_add_f32 v50, v50, v66
    v_add_f32 v51, v51, v67
    v_add_f32 v52, v52, v68
    v_add_f32 v53, v53, v69
    v_add_f32 v54, v54, v70
    v_add_f32 v55, v55, v71
    v_cvt_pk_bf16_f32 v56, v48, v49
    v_cvt_pk_bf16_f32 v57, v50, v51
    v_cvt_pk_bf16_f32 v58, v52, v53
    v_cvt_pk_bf16_f32 v59, v54, v55
    buffer_store_dwordx4 v[56:59], v211, s[36:39], s61 offen
    s_endpgm
L_dfin26:
    s_waitcnt vmcnt(0)
    s_mov_b64 exec, 1
    buffer_store_dwordx2 v[222:223], v14, s[24:27], s54 offen sc1
    s_mov_b64 exec, -1
    s_endpgm
L_C:
    s_lshl_b32 s7, s57, 1
    s_sub_u32 s7, s7, 11
    s_lshl_b32 s66, s7, 7
    s_lshl_b32 s61, s7, 1
    s_lshl_b32 s70, s61, 9
    s_mul_i32 s60, s63, 29184
    s_add_u32 s70, s70, s60
    s_add_u32 s70, s70, 16762880
    s_lshl_b32 s78, s61, 6
    s_add_u32 s78, s78, s63
    s_lshl_b32 s78, s78, 3
    s_add_u32 s78, s78, 15007744
    s_lshl_b32 s7, s57, 1
    s_sub_u32 s7, s7, 10
    s_lshl_b32 s67, s7, 7
    s_lshl_b32 s61, s7, 1
    s_add_u32 s61, s61, s64
    s_lshl_b32 s71, s61, 9
    s_mul_i32 s60, s63, 29184
    s_add_u32 s71, s71, s60
    s_add_u32 s71, s71, 16762880
    s_lshl_b32 s79, s61, 6
    s_add_u32 s79, s79, s63
    s_lshl_b32 s79, s79, 3
    s_add_u32 s79, s79, 15007744
    s_mov_b32 s68, 1792
    s_sub_u32 s61, s57, 13
    s_lshr_b32 s61, s61, 1
    s_add_u32 s61, s61, 28
    s_lshl_b32 s72, s61, 9
    s_mul_i32 s60, s63, 29184
    s_add_u32 s72, s72, s60
    s_add_u32 s72, s72, 16762880
    s_lshl_b32 s80, s61, 6
    s_add_u32 s80, s80, s63
    s_lshl_b32 s80, s80, 3
    s_add_u32 s80, s80, 15007744
    s_lshl_b32 s60, s63, 9
    s_add_u32 s60, s60, 15032768
    s_cmp_ge_u32 s58, 4
    s_cselect_b32 s80, s60, s80
    s_add_u32 s7, s57, 12
    s_lshl_b32 s69, s7, 7
    s_lshl_b32 s61, s7, 1
    s_add_u32 s61, s61, s64
    s_lshl_b32 s73, s61, 11
    s_mul_i32 s60, s63, 147456
    s_add_u32 s73, s73, s60
    s_add_u32 s73, s73, 5505024
    s_lshl_b32 s81, s63, 6
    s_add_u32 s81, s81, s61
    s_lshl_b32 s81, s81, 3
    s_add_u32 s81, s81, 15032320
    s_mov_b32 s53, s73
    s_mov_b32 s54, s81
    s_cmp_ge_u32 s58, 4
    s_cbranch_scc1 L_g0c34
    s_waitcnt vmcnt(6) lgkmcnt(4)
    s_barrier
    v_add_u32 v212, 0, v208
    v_add_u32 v213, 0, v209
    v_add_u32 v214, 0, v210
    v_add_u32 v215, 0, v211
    ds_read_b128 v[16:19], v212
    ds_read_b128 v[20:23], v213
    ds_read_b128 v[24:27], v214
    ds_read_b128 v[28:31], v215
    s_add_u32 m0, s65, 131072
    s_bfe_u32 s61, s75, 0x40008
    s_mul_i32 s61, s61, 172032
    s_add_u32 s61, s61, s66
    buffer_load_dwordx4 v202, s[12:15], s61 offen lds
    s_add_u32 m0, s65, 132096
    s_add_u32 s61, s61, 21504
    buffer_load_dwordx4 v202, s[12:15], s61 offen lds
    s_add_u32 m0, s55, 32768
    s_bfe_u32 s60, s75, 0x40008
    s_mul_i32 s60, s60, 128
    s_add_u32 s60, s60, s62
    buffer_load_dwordx4 v4, s[8:11], s60 offen lds
    s_add_u32 m0, s55, 33792
    s_nop 0
    buffer_load_dwordx4 v5, s[8:11], s60 offen lds
    s_add_u32 m0, s55, 34816
    s_add_u32 s60, s60, 14336
    buffer_load_dwordx4 v4, s[8:11], s60 offen lds
    s_add_u32 m0, s55, 35840
    s_nop 0
    buffer_load_dwordx4 v5, s[8:11], s60 offen lds
    s_add_u32 m0, s65, 139264
    s_bfe_u32 s61, s75, 0x4000c
    s_mul_i32 s61, s61, 172032
    s_add_u32 s61, s61, s66
    buffer_load_dwordx4 v202, s[12:15], s61 offen lds
    s_add_u32 m0, s65, 140288
    s_add_u32 s61, s61, 21504
    buffer_load_dwordx4 v202, s[12:15], s61 offen lds
    s_add_u32 m0, s55, 49152
    s_bfe_u32 s60, s75, 0x4000c
    s_mul_i32 s60, s60, 128
    s_add_u32 s60, s60, s62
    buffer_load_dwordx4 v4, s[8:11], s60 offen lds
    s_add_u32 m0, s55, 50176
    s_nop 0
    buffer_load_dwordx4 v5, s[8:11], s60 offen lds
    s_add_u32 m0, s55, 51200
    s_add_u32 s60, s60, 14336
    buffer_load_dwordx4 v4, s[8:11], s60 offen lds
    s_add_u32 m0, s55, 52224
    s_nop 0
    buffer_load_dwordx4 v5, s[8:11], s60 offen lds
    s_waitcnt vmcnt(12) lgkmcnt(4)
    s_barrier
    v_add_u32 v212, 16384, v208
    v_add_u32 v213, 16384, v209
    v_add_u32 v214, 16384, v210
    v_add_u32 v215, 16384, v211
    ds_read_b128 v[32:35], v212
    ds_read_b128 v[36:39], v213
    ds_read_b128 v[40:43], v214
    ds_read_b128 v[44:47], v215
    s_add_u32 m0, s65, 147456
    s_bfe_u32 s61, s75, 0x40010
    s_mul_i32 s61, s61, 172032
    s_add_u32 s61, s61, s66
    buffer_load_dwordx4 v202, s[12:15], s61 offen lds
    s_add_u32 m0, s65, 148480
    s_add_u32 s61, s61, 21504
    buffer_load_dwordx4 v202, s[12:15], s61 offen lds
    s_add_u32 m0, s55, 65536
    s_bfe_u32 s60, s75, 0x40010
    s_mul_i32 s60, s60, 128
    s_add_u32 s60, s60, s62
    buffer_load_dwordx4 v4, s[8:11], s60 offen lds
    s_add_u32 m0, s55, 66560
    s_nop 0
    buffer_load_dwordx4 v5, s[8:11], s60 offen lds
    s_add_u32 m0, s55, 67584
    s_add_u32 s60, s60, 14336
    buffer_load_dwordx4 v4, s[8:11], s60 offen lds
    s_add_u32 m0, s55, 68608
    s_nop 0
    buffer_load_dwordx4 v5, s[8:11], s60 offen lds
    s_waitcnt vmcnt(12) lgkmcnt(4)
    s_barrier
    v_add_u32 v212, 32768, v208
    v_add_u32 v213, 32768, v209
    v_add_u32 v214, 32768, v210
    v_add_u32 v215, 32768, v211
    ds_read_b128 v[48:51], v212
    ds_read_b128 v[52:55], v213
    ds_read_b128 v[56:59], v214
    ds_read_b128 v[60:63], v215
    s_add_u32 m0, s65, 155648
    s_bfe_u32 s61, s75, 0x40014
    s_mul_i32 s61, s61, 172032
    s_add_u32 s61, s61, s66
    buffer_load_dwordx4 v202, s[12:15], s61 offen lds
    s_add_u32 m0, s65, 156672
    s_add_u32 s61, s61, 21504
    buffer_load_dwordx4 v202, s[12:15], s61 offen lds
    s_add_u32 m0, s55, 81920
    s_bfe_u32 s60, s75, 0x40014
    s_mul_i32 s60, s60, 128
    s_add_u32 s60, s60, s62
    buffer_load_dwordx4 v4, s[8:11], s60 offen lds
    s_add_u32 m0, s55, 82944
    s_nop 0
    buffer_load_dwordx4 v5, s[8:11], s60 offen lds
    s_add_u32 m0, s55, 83968
    s_add_u32 s60, s60, 14336
    buffer_load_dwordx4 v4, s[8:11], s60 offen lds
    s_add_u32 m0, s55, 84992
    s_nop 0
    buffer_load_dwordx4 v5, s[8:11], s60 offen lds
    s_waitcnt vmcnt(12) lgkmcnt(4)
    s_barrier
    v_add_u32 v212, 49152, v208
    v_add_u32 v213, 49152, v209
    v_add_u32 v214, 49152, v210
    v_add_u32 v215, 49152, v211
    ds_read_b128 v[64:67], v212
    ds_read_b128 v[68:71], v213
    ds_read_b128 v[72:75], v214
    ds_read_b128 v[76:79], v215
    s_add_u32 m0, s65, 114688
    s_bfe_u32 s61, s75, 0x40018
    s_mul_i32 s61, s61, 172032
    s_add_u32 s61, s61, s66
    buffer_load_dwordx4 v202, s[12:15], s61 offen lds
    s_add_u32 m0, s65, 115712
    s_add_u32 s61, s61, 21504
    buffer_load_dwordx4 v202, s[12:15], s61 offen lds
    s_add_u32 m0, s55, 98304
    s_bfe_u32 s60, s75, 0x40018
    s_mul_i32 s60, s60, 128
    s_add_u32 s60, s60, s62
    buffer_load_dwordx4 v4, s[8:11], s60 offen lds
    s_add_u32 m0, s55, 99328
    s_nop 0
    buffer_load_dwordx4 v5, s[8:11], s60 offen lds
    s_add_u32 m0, s55, 100352
    s_add_u32 s60, s60, 14336
    buffer_load_dwordx4 v4, s[8:11], s60 offen lds
    s_add_u32 m0, s55, 101376
    s_nop 0
    buffer_load_dwordx4 v5, s[8:11], s60 offen lds
    s_add_u32 m0, s65, 0
    s_bfe_u32 s60, s75, 0x40000
    s_mul_i32 s60, s60, 172032
    s_add_u32 s60, s60, s67
    buffer_load_dwordx4 v202, s[12:15], s60 offen lds
    s_add_u32 m0, s65, 1024
    s_add_u32 s60, s60, 21504
    buffer_load_dwordx4 v202, s[12:15], s60 offen lds
    s_add_u32 m0, s65, 8192
    s_bfe_u32 s60, s75, 0x40004
    s_mul_i32 s60, s60, 172032
    s_add_u32 s60, s60, s67
    buffer_load_dwordx4 v202, s[12:15], s60 offen lds
    s_add_u32 m0, s65, 9216
    s_add_u32 s60, s60, 21504
    buffer_load_dwordx4 v202, s[12:15], s60 offen lds
    s_waitcnt vmcnt(16) lgkmcnt(4)
    s_barrier
    v_add_u32 v212, 65536, v208
    v_add_u32 v213, 65536, v209
    v_add_u32 v214, 65536, v210
    v_add_u32 v215, 65536, v211
    ds_read_b128 v[80:83], v212
    ds_read_b128 v[84:87], v213
    ds_read_b128 v[88:91], v214
    ds_read_b128 v[92:95], v215
    s_add_u32 m0, s65, 122880
    s_bfe_u32 s60, s75, 0x40008
    s_mul_i32 s60, s60, 172032
    s_add_u32 s60, s60, s67
    buffer_load_dwordx4 v202, s[12:15], s60 offen lds
    s_add_u32 m0, s65, 123904
    s_add_u32 s60, s60, 21504
    buffer_load_dwordx4 v202, s[12:15], s60 offen lds
    s_add_u32 m0, s65, 16384
    s_bfe_u32 s60, s75, 0x4000c
    s_mul_i32 s60, s60, 172032
    s_add_u32 s60, s60, s67
    buffer_load_dwordx4 v202, s[12:15], s60 offen lds
    s_add_u32 m0, s65, 17408
    s_add_u32 s60, s60, 21504
    buffer_load_dwordx4 v202, s[12:15], s60 offen lds
    s_waitcnt vmcnt(14) lgkmcnt(4)
    s_barrier
    v_add_u32 v212, 81920, v208
    v_add_u32 v213, 81920, v209
    v_add_u32 v214, 81920, v210
    v_add_u32 v215, 81920, v211
    ds_read_b128 v[96:99], v212
    ds_read_b128 v[100:103], v213
    ds_read_b128 v[104:107], v214
    ds_read_b128 v[108:111], v215
    s_add_u32 m0, s65, 24576
    s_bfe_u32 s60, s75, 0x40010
    s_mul_i32 s60, s60, 172032
    s_add_u32 s60, s60, s67
    buffer_load_dwordx4 v202, s[12:15], s60 offen lds
    s_add_u32 m0, s65, 25600
    s_add_u32 s60, s60, 21504
    buffer_load_dwordx4 v202, s[12:15], s60 offen lds
    s_add_u32 m0, s65, 131072
    s_bfe_u32 s60, s75, 0x40014
    s_mul_i32 s60, s60, 172032
    s_add_u32 s60, s60, s67
    buffer_load_dwordx4 v202, s[12:15], s60 offen lds
    s_add_u32 m0, s65, 132096
    s_add_u32 s60, s60, 21504
    buffer_load_dwordx4 v202, s[12:15], s60 offen lds
    s_waitcnt vmcnt(12) lgkmcnt(4)
    s_barrier
    v_add_u32 v212, 98304, v208
    v_add_u32 v213, 98304, v209
    v_add_u32 v214, 98304, v210
    v_add_u32 v215, 98304, v211
    ds_read_b128 v[112:115], v212
    ds_read_b128 v[116:119], v213
    ds_read_b128 v[120:123], v214
    ds_read_b128 v[124:127], v215
    s_add_u32 m0, s65, 32768
    s_bfe_u32 s60, s75, 0x40018
    s_mul_i32 s60, s60, 172032
    s_add_u32 s60, s60, s67
    buffer_load_dwordx4 v202, s[12:15], s60 offen lds
    s_add_u32 m0, s65, 33792
    s_add_u32 s60, s60, 21504
    buffer_load_dwordx4 v202, s[12:15], s60 offen lds
    s_branch L_g0j35
L_g0c34:
    s_barrier
    v_add_u32 v212, 0, v208
    v_add_u32 v213, 0, v209
    v_add_u32 v214, 0, v210
    v_add_u32 v215, 0, v211
    ds_read_b128 v[16:19], v212
    ds_read_b128 v[20:23], v213
    ds_read_b128 v[24:27], v214
    ds_read_b128 v[28:31], v215
    ds_read_b64_tr_b16 v[216:217], v204 offset:49152
    ds_read_b64_tr_b16 v[218:219], v204 offset:49664
    ds_read_b64_tr_b16 v[220:221], v7 offset:49152
    ds_read_b64_tr_b16 v[222:223], v7 offset:49664
    ds_read_b64_tr_b16 v[224:225], v204 offset:51200
    ds_read_b64_tr_b16 v[226:227], v204 offset:51712
    ds_read_b64_tr_b16 v[228:229], v7 offset:51200
    ds_read_b64_tr_b16 v[230:231], v7 offset:51712
    ds_read_b64_tr_b16 v[232:233], v204 offset:53248
    ds_read_b64_tr_b16 v[234:235], v204 offset:53760
    ds_read_b64_tr_b16 v[236:237], v7 offset:53248
    ds_read_b64_tr_b16 v[238:239], v7 offset:53760
    ds_read_b64_tr_b16 v[240:241], v204 offset:55296
    ds_read_b64_tr_b16 v[242:243], v204 offset:55808
    ds_read_b64_tr_b16 v[244:245], v7 offset:55296
    ds_read_b64_tr_b16 v[246:247], v7 offset:55808
    s_barrier
    v_add_u32 v212, 16384, v208
    v_add_u32 v213, 16384, v209
    v_add_u32 v214, 16384, v210
    v_add_u32 v215, 16384, v211
    s_waitcnt lgkmcnt(14)
    v_mfma_f32_32x32x16_bf16 v[128:143], v[16:19], v[216:219], 0
    ds_read_b128 v[32:35], v212
    ds_read_b128 v[36:39], v213
    ds_read_b128 v[40:43], v214
    s_waitcnt lgkmcnt(15)
    v_mfma_f32_32x32x16_bf16 v[144:159], v[16:19], v[220:223], 0
    ds_read_b128 v[44:47], v215
    ds_read_b64_tr_b16 v[160:161], v204 offset:57344
    ds_read_b64_tr_b16 v[162:163], v204 offset:57856
    s_waitcnt lgkmcnt(15)
    v_mfma_f32_32x32x16_bf16 v[128:143], v[20:23], v[224:227], v[128:143]
    ds_read_b64_tr_b16 v[164:165], v7 offset:57344
    ds_read_b64_tr_b16 v[166:167], v7 offset:57856
    ds_read_b64_tr_b16 v[168:169], v204 offset:59392
    s_waitcnt lgkmcnt(15)
    v_mfma_f32_32x32x16_bf16 v[144:159], v[20:23], v[228:231], v[144:159]
    ds_read_b64_tr_b16 v[170:171], v204 offset:59904
    ds_read_b64_tr_b16 v[172:173], v7 offset:59392
    ds_read_b64_tr_b16 v[174:175], v7 offset:59904
    s_waitcnt lgkmcnt(15)
    v_mfma_f32_32x32x16_bf16 v[128:143], v[24:27], v[232:235], v[128:143]
    ds_read_b64_tr_b16 v[176:177], v204 offset:61440
    ds_read_b64_tr_b16 v[178:179], v204 offset:61952
    s_waitcnt lgkmcnt(15)
    v_mfma_f32_32x32x16_bf16 v[144:159], v[24:27], v[236:239], v[144:159]
    ds_read_b64_tr_b16 v[180:181], v7 offset:61440
    ds_read_b64_tr_b16 v[182:183], v7 offset:61952
    s_waitcnt lgkmcnt(15)
    v_mfma_f32_32x32x16_bf16 v[128:143], v[28:31], v[240:243], v[128:143]
    ds_read_b64_tr_b16 v[184:185], v204 offset:63488
    ds_read_b64_tr_b16 v[186:187], v204 offset:64000
    s_waitcnt lgkmcnt(15)
    v_mfma_f32_32x32x16_bf16 v[144:159], v[28:31], v[244:247], v[144:159]
    ds_read_b64_tr_b16 v[188:189], v7 offset:63488
    ds_read_b64_tr_b16 v[190:191], v7 offset:64000
    s_barrier
    v_add_u32 v212, 32768, v208
    v_add_u32 v213, 32768, v209
    v_add_u32 v214, 32768, v210
    v_add_u32 v215, 32768, v211
    s_waitcnt lgkmcnt(14)
    v_mfma_f32_32x32x16_bf16 v[128:143], v[32:35], v[160:163], v[128:143]
    ds_read_b128 v[48:51], v212
    ds_read_b128 v[52:55], v213
    ds_read_b128 v[56:59], v214
    s_waitcnt lgkmcnt(15)
    v_mfma_f32_32x32x16_bf16 v[144:159], v[32:35], v[164:167], v[144:159]
    ds_read_b128 v[60:63], v215
    ds_read_b64_tr_b16 v[216:217], v205 offset:0
    ds_read_b64_tr_b16 v[218:219], v205 offset:512
    s_waitcnt lgkmcnt(15)
    v_mfma_f32_32x32x16_bf16 v[128:143], v[36:39], v[168:171], v[128:143]
    ds_read_b64_tr_b16 v[220:221], v8 offset:0
    ds_read_b64_tr_b16 v[222:223], v8 offset:512
    ds_read_b64_tr_b16 v[224:225], v205 offset:2048
    s_waitcnt lgkmcnt(15)
    v_mfma_f32_32x32x16_bf16 v[144:159], v[36:39], v[172:175], v[144:159]
    ds_read_b64_tr_b16 v[226:227], v205 offset:2560
    ds_read_b64_tr_b16 v[228:229], v8 offset:2048
    ds_read_b64_tr_b16 v[230:231], v8 offset:2560
    s_waitcnt lgkmcnt(15)
    v_mfma_f32_32x32x16_bf16 v[128:143], v[40:43], v[176:179], v[128:143]
    ds_read_b64_tr_b16 v[232:233], v205 offset:4096
    ds_read_b64_tr_b16 v[234:235], v205 offset:4608
    s_waitcnt lgkmcnt(15)
    v_mfma_f32_32x32x16_bf16 v[144:159], v[40:43], v[180:183], v[144:159]
    ds_read_b64_tr_b16 v[236:237], v8 offset:4096
    ds_read_b64_tr_b16 v[238:239], v8 offset:4608
    s_waitcnt lgkmcnt(15)
    v_mfma_f32_32x32x16_bf16 v[128:143], v[44:47], v[184:187], v[128:143]
    ds_read_b64_tr_b16 v[240:241], v205 offset:6144
    ds_read_b64_tr_b16 v[242:243], v205 offset:6656
    s_waitcnt lgkmcnt(15)
    v_mfma_f32_32x32x16_bf16 v[144:159], v[44:47], v[188:191], v[144:159]
    ds_read_b64_tr_b16 v[244:245], v8 offset:6144
    ds_read_b64_tr_b16 v[246:247], v8 offset:6656
    s_barrier
    v_add_u32 v212, 49152, v208
    v_add_u32 v213, 49152, v209
    v_add_u32 v214, 49152, v210
    v_add_u32 v215, 49152, v211
    s_waitcnt lgkmcnt(14)
    v_mfma_f32_32x32x16_bf16 v[128:143], v[48:51], v[216:219], v[128:143]
    ds_read_b128 v[64:67], v212
    ds_read_b128 v[68:71], v213
    ds_read_b128 v[72:75], v214
    s_waitcnt lgkmcnt(15)
    v_mfma_f32_32x32x16_bf16 v[144:159], v[48:51], v[220:223], v[144:159]
    ds_read_b128 v[76:79], v215
    ds_read_b64_tr_b16 v[160:161], v205 offset:8192
    ds_read_b64_tr_b16 v[162:163], v205 offset:8704
    s_waitcnt lgkmcnt(15)
    v_mfma_f32_32x32x16_bf16 v[128:143], v[52:55], v[224:227], v[128:143]
    ds_read_b64_tr_b16 v[164:165], v8 offset:8192
    ds_read_b64_tr_b16 v[166:167], v8 offset:8704
    ds_read_b64_tr_b16 v[168:169], v205 offset:10240
    s_waitcnt lgkmcnt(15)
    v_mfma_f32_32x32x16_bf16 v[144:159], v[52:55], v[228:231], v[144:159]
    ds_read_b64_tr_b16 v[170:171], v205 offset:10752
    ds_read_b64_tr_b16 v[172:173], v8 offset:10240
    ds_read_b64_tr_b16 v[174:175], v8 offset:10752
    s_waitcnt lgkmcnt(15)
    v_mfma_f32_32x32x16_bf16 v[128:143], v[56:59], v[232:235], v[128:143]
    ds_read_b64_tr_b16 v[176:177], v205 offset:12288
    ds_read_b64_tr_b16 v[178:179], v205 offset:12800
    s_waitcnt lgkmcnt(15)
    v_mfma_f32_32x32x16_bf16 v[144:159], v[56:59], v[236:239], v[144:159]
    ds_read_b64_tr_b16 v[180:181], v8 offset:12288
    ds_read_b64_tr_b16 v[182:183], v8 offset:12800
    s_waitcnt lgkmcnt(15)
    v_mfma_f32_32x32x16_bf16 v[128:143], v[60:63], v[240:243], v[128:143]
    ds_read_b64_tr_b16 v[184:185], v205 offset:14336
    ds_read_b64_tr_b16 v[186:187], v205 offset:14848
    s_waitcnt lgkmcnt(15)
    v_mfma_f32_32x32x16_bf16 v[144:159], v[60:63], v[244:247], v[144:159]
    ds_read_b64_tr_b16 v[188:189], v8 offset:14336
    ds_read_b64_tr_b16 v[190:191], v8 offset:14848
    s_barrier
    v_add_u32 v212, 65536, v208
    v_add_u32 v213, 65536, v209
    v_add_u32 v214, 65536, v210
    v_add_u32 v215, 65536, v211
    s_waitcnt lgkmcnt(14)
    v_mfma_f32_32x32x16_bf16 v[128:143], v[64:67], v[160:163], v[128:143]
    ds_read_b128 v[80:83], v212
    ds_read_b128 v[84:87], v213
    ds_read_b128 v[88:91], v214
    s_waitcnt lgkmcnt(15)
    v_mfma_f32_32x32x16_bf16 v[144:159], v[64:67], v[164:167], v[144:159]
    ds_read_b128 v[92:95], v215
    ds_read_b64_tr_b16 v[216:217], v205 offset:16384
    ds_read_b64_tr_b16 v[218:219], v205 offset:16896
    s_waitcnt lgkmcnt(15)
    v_mfma_f32_32x32x16_bf16 v[128:143], v[68:71], v[168:171], v[128:143]
    ds_read_b64_tr_b16 v[220:221], v8 offset:16384
    ds_read_b64_tr_b16 v[222:223], v8 offset:16896
    ds_read_b64_tr_b16 v[224:225], v205 offset:18432
    s_waitcnt lgkmcnt(15)
    v_mfma_f32_32x32x16_bf16 v[144:159], v[68:71], v[172:175], v[144:159]
    ds_read_b64_tr_b16 v[226:227], v205 offset:18944
    ds_read_b64_tr_b16 v[228:229], v8 offset:18432
    ds_read_b64_tr_b16 v[230:231], v8 offset:18944
    s_waitcnt lgkmcnt(15)
    v_mfma_f32_32x32x16_bf16 v[128:143], v[72:75], v[176:179], v[128:143]
    ds_read_b64_tr_b16 v[232:233], v205 offset:20480
    ds_read_b64_tr_b16 v[234:235], v205 offset:20992
    s_waitcnt lgkmcnt(15)
    v_mfma_f32_32x32x16_bf16 v[144:159], v[72:75], v[180:183], v[144:159]
    ds_read_b64_tr_b16 v[236:237], v8 offset:20480
    ds_read_b64_tr_b16 v[238:239], v8 offset:20992
    s_waitcnt lgkmcnt(15)
    v_mfma_f32_32x32x16_bf16 v[128:143], v[76:79], v[184:187], v[128:143]
    ds_read_b64_tr_b16 v[240:241], v205 offset:22528
    ds_read_b64_tr_b16 v[242:243], v205 offset:23040
    s_waitcnt lgkmcnt(15)
    v_mfma_f32_32x32x16_bf16 v[144:159], v[76:79], v[188:191], v[144:159]
    ds_read_b64_tr_b16 v[244:245], v8 offset:22528
    ds_read_b64_tr_b16 v[246:247], v8 offset:23040
    s_barrier
    v_add_u32 v212, 81920, v208
    v_add_u32 v213, 81920, v209
    v_add_u32 v214, 81920, v210
    v_add_u32 v215, 81920, v211
    s_waitcnt lgkmcnt(14)
    v_mfma_f32_32x32x16_bf16 v[128:143], v[80:83], v[216:219], v[128:143]
    ds_read_b128 v[96:99], v212
    ds_read_b128 v[100:103], v213
    ds_read_b128 v[104:107], v214
    s_waitcnt lgkmcnt(15)
    v_mfma_f32_32x32x16_bf16 v[144:159], v[80:83], v[220:223], v[144:159]
    ds_read_b128 v[108:111], v215
    ds_read_b64_tr_b16 v[160:161], v205 offset:24576
    ds_read_b64_tr_b16 v[162:163], v205 offset:25088
    s_waitcnt lgkmcnt(15)
    v_mfma_f32_32x32x16_bf16 v[128:143], v[84:87], v[224:227], v[128:143]
    ds_read_b64_tr_b16 v[164:165], v8 offset:24576
    ds_read_b64_tr_b16 v[166:167], v8 offset:25088
    ds_read_b64_tr_b16 v[168:169], v205 offset:26624
    s_waitcnt lgkmcnt(15)
    v_mfma_f32_32x32x16_bf16 v[144:159], v[84:87], v[228:231], v[144:159]
    ds_read_b64_tr_b16 v[170:171], v205 offset:27136
    ds_read_b64_tr_b16 v[172:173], v8 offset:26624
    ds_read_b64_tr_b16 v[174:175], v8 offset:27136
    s_waitcnt lgkmcnt(15)
    v_mfma_f32_32x32x16_bf16 v[128:143], v[88:91], v[232:235], v[128:143]
    ds_read_b64_tr_b16 v[176:177], v205 offset:28672
    ds_read_b64_tr_b16 v[178:179], v205 offset:29184
    s_waitcnt lgkmcnt(15)
    v_mfma_f32_32x32x16_bf16 v[144:159], v[88:91], v[236:239], v[144:159]
    ds_read_b64_tr_b16 v[180:181], v8 offset:28672
    ds_read_b64_tr_b16 v[182:183], v8 offset:29184
    s_waitcnt lgkmcnt(15)
    v_mfma_f32_32x32x16_bf16 v[128:143], v[92:95], v[240:243], v[128:143]
    ds_read_b64_tr_b16 v[184:185], v205 offset:30720
    ds_read_b64_tr_b16 v[186:187], v205 offset:31232
    s_waitcnt lgkmcnt(15)
    v_mfma_f32_32x32x16_bf16 v[144:159], v[92:95], v[244:247], v[144:159]
    ds_read_b64_tr_b16 v[188:189], v8 offset:30720
    ds_read_b64_tr_b16 v[190:191], v8 offset:31232
    s_barrier
    v_add_u32 v212, 98304, v208
    v_add_u32 v213, 98304, v209
    v_add_u32 v214, 98304, v210
    v_add_u32 v215, 98304, v211
    s_waitcnt lgkmcnt(14)
    v_mfma_f32_32x32x16_bf16 v[128:143], v[96:99], v[160:163], v[128:143]
    ds_read_b128 v[112:115], v212
    ds_read_b128 v[116:119], v213
    ds_read_b128 v[120:123], v214
    s_waitcnt lgkmcnt(15)
    v_mfma_f32_32x32x16_bf16 v[144:159], v[96:99], v[164:167], v[144:159]
    ds_read_b128 v[124:127], v215
    ds_read_b64_tr_b16 v[216:217], v204 offset:49152
    ds_read_b64_tr_b16 v[218:219], v204 offset:49664
    s_waitcnt lgkmcnt(15)
    v_mfma_f32_32x32x16_bf16 v[128:143], v[100:103], v[168:171], v[128:143]
    ds_read_b64_tr_b16 v[220:221], v7 offset:49152
    ds_read_b64_tr_b16 v[222:223], v7 offset:49664
    ds_read_b64_tr_b16 v[224:225], v204 offset:51200
    s_waitcnt lgkmcnt(15)
    v_mfma_f32_32x32x16_bf16 v[144:159], v[100:103], v[172:175], v[144:159]
    ds_read_b64_tr_b16 v[226:227], v204 offset:51712
    ds_read_b64_tr_b16 v[228:229], v7 offset:51200
    ds_read_b64_tr_b16 v[230:231], v7 offset:51712
    s_waitcnt lgkmcnt(15)
    v_mfma_f32_32x32x16_bf16 v[128:143], v[104:107], v[176:179], v[128:143]
    ds_read_b64_tr_b16 v[232:233], v204 offset:53248
    ds_read_b64_tr_b16 v[234:235], v204 offset:53760
    s_waitcnt lgkmcnt(15)
    v_mfma_f32_32x32x16_bf16 v[144:159], v[104:107], v[180:183], v[144:159]
    ds_read_b64_tr_b16 v[236:237], v7 offset:53248
    ds_read_b64_tr_b16 v[238:239], v7 offset:53760
    s_waitcnt lgkmcnt(15)
    v_mfma_f32_32x32x16_bf16 v[128:143], v[108:111], v[184:187], v[128:143]
    ds_read_b64_tr_b16 v[240:241], v204 offset:55296
    ds_read_b64_tr_b16 v[242:243], v204 offset:55808
    s_waitcnt lgkmcnt(15)
    v_mfma_f32_32x32x16_bf16 v[144:159], v[108:111], v[188:191], v[144:159]
    ds_read_b64_tr_b16 v[244:245], v7 offset:55296
    ds_read_b64_tr_b16 v[246:247], v7 offset:55808
L_g0j35:
    s_cmp_ge_u32 s58, 4
    s_cbranch_scc1 L_vw36
    s_waitcnt vmcnt(10)
L_vw36:
    s_barrier
    buffer_load_dword v200, v14, s[48:51], 0 offen sc1
    ds_read_b64_tr_b16 v[160:161], v6 offset:0
    ds_read_b64_tr_b16 v[162:163], v6 offset:512
    s_and_b32 s60, s75, 15
    s_lshl_b32 s60, s60, 7
    v_add_u32 v12, s60, v11
    v_subrev_u32 v207, 896, v12
    v_min_u32 v12, v12, v207
    s_add_u32 m0, s59, 40960
    s_nop 0
    buffer_load_dwordx4 v12, s[40:43], 0 offen lds
    ds_read_b64_tr_b16 v[164:165], v6 offset:2048
    ds_read_b64_tr_b16 v[166:167], v6 offset:2560
    ds_read_b64_tr_b16 v[168:169], v6 offset:4096
    ds_read_b64_tr_b16 v[170:171], v6 offset:4608
    ds_read_b64_tr_b16 v[172:173], v6 offset:6144
    ds_read_b64_tr_b16 v[174:175], v6 offset:6656
    s_cmp_ge_u32 s58, 4
    s_cbranch_scc1 L_e038
    v_lshrrev_b32 v204, 5, v1
    v_and_b32 v205, 31, v1
    s_and_b32 s60, s2, 7
    s_lshr_b32 s61, s2, 3
    s_and_b32 s82, s61, 1
    s_lshl_b32 s82, s82, 3
    s_add_u32 s82, s82, s60
    s_lshr_b32 s83, s61, 1
    s_mul_i32 s89, s82, 7
    s_lshr_b32 s89, s89, 1
    v_lshlrev_b32 v240, 4, v205
    v_lshl_add_u32 v240, v204, 15, v240
    s_mul_i32 s60, s82, 448
    v_add_u32 v241, s60, v10
    s_mov_b32 s87, 0x4e800000
    s_add_u32 s4, s89, 56
    s_lshl_b32 s4, s4, 15
    s_lshl_b32 s5, s58, 13
    s_add_u32 s4, s4, s5
    s_mov_b32 s85, s4
    v_add_u32 v248, s4, v240
    v_mov_b32 v250, v240
    v_mov_b32 v240, v248
    v_add_u32 v248, 65536, v248
    v_add_u32 v249, 14336, v241
    v_lshlrev_b32 v206, 4, v205
    v_add_u32 v206, 28224, v206
    v_cmp_gt_u32 vcc, 28, v205
    s_nop 1
    v_cndmask_b32 v241, v206, v241, vcc
    v_cndmask_b32 v249, v206, v249, vcc
    s_mul_i32 s4, s58, 466944
    s_add_u32 s4, s4, 16777216
    v_add_u32 v241, s4, v241
    v_add_u32 v249, s4, v249
    s_lshl_b32 s84, s83, 9
    s_mul_i32 s86, s84, 57
    s_and_b32 s60, s82, 1
    v_cmp_le_u32 vcc, s60, v204
    s_nop 1
    v_cndmask_b32 v244, 0, -1, vcc
    v_cmp_ge_u32 vcc, s60, v204
    s_nop 1
    v_cndmask_b32 v245, 0, -1, vcc
    s_add_u32 s4, s89, 56
    s_lshr_b32 s4, s4, 2
    s_add_u32 s5, s89, 59
    s_lshr_b32 s5, s5, 2
    s_mul_i32 s6, s82, 28
    s_add_u32 s7, s6, 27
    s_lshr_b32 s6, s6, 5
    s_lshr_b32 s7, s7, 5
    s_add_u32 s6, s6, 28
    s_add_u32 s7, s7, 28
    v_mov_b32 v242, s7
    v_mov_b32 v206, s6
    v_cmp_gt_u32 vcc, 48, v1
    s_nop 1
    v_cndmask_b32 v242, v242, v206, vcc
    v_mov_b32 v206, s5
    v_cmp_gt_u32 vcc, 32, v1
    s_nop 1
    v_cndmask_b32 v242, v242, v206, vcc
    v_mov_b32 v206, s4
    v_cmp_gt_u32 vcc, 16, v1
    s_nop 1
    v_cndmask_b32 v242, v242, v206, vcc
    v_and_b32 v206, 15, v1
    v_lshl_add_u32 v242, v242, 6, v206
    s_lshl_b32 s4, s58, 4
    v_add_u32 v242, s4, v242
    v_lshlrev_b32 v242, 3, v242
    s_lshr_b32 s4, s89, 2
    s_add_u32 s5, s89, 3
    s_lshr_b32 s5, s5, 2
    s_lshl_b32 s6, s83, 2
    v_and_b32 v206, 3, v1
    v_add_u32 v206, s6, v206
    v_mov_b32 v243, s5
    v_mov_b32 v12, s4
    v_cmp_gt_u32 vcc, 4, v1
    s_nop 1
    v_cndmask_b32 v243, v243, v12, vcc
    v_lshl_add_u32 v243, v243, 6, v206
    v_lshlrev_b32 v243, 3, v243
    v_lshlrev_b32 v206, 9, v206
    v_add_u32 v206, 25024, v206
    v_cmp_gt_u32 vcc, 8, v1
    s_nop 1
    v_cndmask_b32 v243, v206, v243, vcc
    s_branch L_e037
L_e038:
    s_waitcnt lgkmcnt(15)
    v_mfma_f32_32x32x16_bf16 v[128:143], v[112:115], v[216:219], v[128:143]
    s_waitcnt lgkmcnt(15)
    v_mfma_f32_32x32x16_bf16 v[144:159], v[112:115], v[220:223], v[144:159]
    s_waitcnt lgkmcnt(15)
    v_mfma_f32_32x32x16_bf16 v[128:143], v[116:119], v[224:227], v[128:143]
    s_waitcnt lgkmcnt(15)
    v_mfma_f32_32x32x16_bf16 v[144:159], v[116:119], v[228:231], v[144:159]
    s_waitcnt lgkmcnt(14)
    v_mfma_f32_32x32x16_bf16 v[128:143], v[120:123], v[232:235], v[128:143]
    s_waitcnt lgkmcnt(12)
    v_mfma_f32_32x32x16_bf16 v[144:159], v[120:123], v[236:239], v[144:159]
    s_waitcnt lgkmcnt(10)
    v_mfma_f32_32x32x16_bf16 v[128:143], v[124:127], v[240:243], v[128:143]
    s_waitcnt lgkmcnt(8)
    v_mfma_f32_32x32x16_bf16 v[144:159], v[124:127], v[244:247], v[144:159]
    s_nop 9
    v_cvt_pk_bf16_f32 v192, v128, v129
    v_cvt_pk_bf16_f32 v193, v130, v131
    v_cvt_pk_bf16_f32 v194, v132, v133
    v_cvt_pk_bf16_f32 v195, v134, v135
    buffer_store_dwordx4 v[192:195], v10, s[24:27], s70 offen sc1
    v_cvt_pk_bf16_f32 v196, v136, v137
    v_cvt_pk_bf16_f32 v197, v138, v139
    v_cvt_pk_bf16_f32 v198, v140, v141
    v_cvt_pk_bf16_f32 v199, v142, v143
    s_add_u32 s60, s70, 14336
    buffer_store_dwordx4 v[196:199], v10, s[24:27], s60 offen sc1
    v_cmp_gt_u32 vcc, 4, v1
    v_mov_b32 v12, 0x3f803f80
    v_lshlrev_b32 v207, 2, v1
    s_mul_i32 s60, s63, 29184
    v_cndmask_b32 v12, 0, v12, vcc
    s_add_u32 s60, s60, 16805888
    s_mov_b64 exec, 0xffff
    buffer_store_dword v12, v207, s[24:27], s60 offen sc1
    s_mov_b64 exec, -1
    s_add_u32 s70, s70, 512
    v_cvt_pk_bf16_f32 v192, v144, v145
    v_cvt_pk_bf16_f32 v193, v146, v147
    v_cvt_pk_bf16_f32 v194, v148, v149
    v_cvt_pk_bf16_f32 v195, v150, v151
    buffer_store_dwordx4 v[192:195], v10, s[24:27], s70 offen sc1
    v_cvt_pk_bf16_f32 v196, v152, v153
    v_cvt_pk_bf16_f32 v197, v154, v155
    v_cvt_pk_bf16_f32 v198, v156, v157
    v_cvt_pk_bf16_f32 v199, v158, v159
    s_add_u32 s60, s70, 14336
    buffer_store_dwordx4 v[196:199], v10, s[24:27], s60 offen sc1
    v_cmp_gt_u32 vcc, 4, v1
    v_mov_b32 v12, 0x3f803f80
    v_lshlrev_b32 v207, 2, v1
    s_mul_i32 s60, s63, 29184
    v_cndmask_b32 v12, 0, v12, vcc
    s_add_u32 s60, s60, 16805888
    s_mov_b64 exec, 0xffff
    buffer_store_dword v12, v207, s[24:27], s60 offen sc1
    s_mov_b64 exec, -1
L_e037:
    s_waitcnt lgkmcnt(6)
    v_mfma_f32_32x32x16_bf16 v[128:143], v[16:19], v[160:163], 0
    ds_read_b64_tr_b16 v[176:177], v6 offset:8192
    ds_read_b64_tr_b16 v[178:179], v6 offset:8704
    s_waitcnt lgkmcnt(6)
    v_mfma_f32_32x32x16_bf16 v[128:143], v[20:23], v[164:167], v[128:143]
    ds_read_b64_tr_b16 v[180:181], v6 offset:10240
    ds_read_b64_tr_b16 v[182:183], v6 offset:10752
    s_waitcnt lgkmcnt(6)
    v_mfma_f32_32x32x16_bf16 v[128:143], v[24:27], v[168:171], v[128:143]
    ds_read_b64_tr_b16 v[184:185], v6 offset:12288
    ds_read_b64_tr_b16 v[186:187], v6 offset:12800
    s_waitcnt lgkmcnt(6)
    v_mfma_f32_32x32x16_bf16 v[128:143], v[28:31], v[172:175], v[128:143]
    ds_read_b64_tr_b16 v[188:189], v6 offset:14336
    ds_read_b64_tr_b16 v[190:191], v6 offset:14848
    s_waitcnt lgkmcnt(6)
    v_mfma_f32_32x32x16_bf16 v[128:143], v[32:35], v[176:179], v[128:143]
    s_cmp_ge_u32 s58, 4
    s_cbranch_scc1 L_vw39
    s_waitcnt vmcnt(8)
L_vw39:
    s_barrier
    ds_read_b64_tr_b16 v[160:161], v7 offset:57344
    ds_read_b64_tr_b16 v[162:163], v7 offset:57856
    s_waitcnt lgkmcnt(6)
    v_mfma_f32_32x32x16_bf16 v[128:143], v[36:39], v[180:183], v[128:143]
    ds_read_b64_tr_b16 v[164:165], v7 offset:59392
    ds_read_b64_tr_b16 v[166:167], v7 offset:59904
    s_waitcnt lgkmcnt(6)
    v_mfma_f32_32x32x16_bf16 v[128:143], v[40:43], v[184:187], v[128:143]
    ds_read_b64_tr_b16 v[168:169], v7 offset:61440
    ds_read_b64_tr_b16 v[170:171], v7 offset:61952
    s_waitcnt lgkmcnt(6)
    v_mfma_f32_32x32x16_bf16 v[128:143], v[44:47], v[188:191], v[128:143]
    ds_read_b64_tr_b16 v[172:173], v7 offset:63488
    ds_read_b64_tr_b16 v[174:175], v7 offset:64000
    s_waitcnt lgkmcnt(6)
    v_mfma_f32_32x32x16_bf16 v[128:143], v[48:51], v[160:163], v[128:143]
    ds_read_b64_tr_b16 v[176:177], v6 offset:16384
    ds_read_b64_tr_b16 v[178:179], v6 offset:16896
    s_waitcnt lgkmcnt(6)
    v_mfma_f32_32x32x16_bf16 v[128:143], v[52:55], v[164:167], v[128:143]
    ds_read_b64_tr_b16 v[180:181], v6 offset:18432
    ds_read_b64_tr_b16 v[182:183], v6 offset:18944
    s_waitcnt lgkmcnt(6)
    v_mfma_f32_32x32x16_bf16 v[128:143], v[56:59], v[168:171], v[128:143]
    ds_read_b64_tr_b16 v[184:185], v6 offset:20480
    ds_read_b64_tr_b16 v[186:187], v6 offset:20992
    s_waitcnt lgkmcnt(6)
    v_mfma_f32_32x32x16_bf16 v[128:143], v[60:63], v[172:175], v[128:143]
    ds_read_b64_tr_b16 v[188:189], v6 offset:22528
    ds_read_b64_tr_b16 v[190:191], v6 offset:23040
    s_waitcnt lgkmcnt(6)
    v_mfma_f32_32x32x16_bf16 v[128:143], v[64:67], v[176:179], v[128:143]
    s_cmp_ge_u32 s58, 4
    s_cbranch_scc1 L_vw40
    s_waitcnt vmcnt(4)
L_vw40:
    s_barrier
    ds_read_b64_tr_b16 v[160:161], v6 offset:24576
    ds_read_b64_tr_b16 v[162:163], v6 offset:25088
    s_waitcnt lgkmcnt(6)
    v_mfma_f32_32x32x16_bf16 v[128:143], v[68:71], v[180:183], v[128:143]
    ds_read_b64_tr_b16 v[164:165], v6 offset:26624
    ds_read_b64_tr_b16 v[166:167], v6 offset:27136
    s_waitcnt lgkmcnt(6)
    v_mfma_f32_32x32x16_bf16 v[128:143], v[72:75], v[184:187], v[128:143]
    ds_read_b64_tr_b16 v[168:169], v6 offset:28672
    ds_read_b64_tr_b16 v[170:171], v6 offset:29184
    s_waitcnt lgkmcnt(6)
    v_mfma_f32_32x32x16_bf16 v[128:143], v[76:79], v[188:191], v[128:143]
    ds_read_b64_tr_b16 v[172:173], v6 offset:30720
    ds_read_b64_tr_b16 v[174:175], v6 offset:31232
    s_waitcnt lgkmcnt(6)
    v_mfma_f32_32x32x16_bf16 v[128:143], v[80:83], v[160:163], v[128:143]
    ds_read_b64_tr_b16 v[176:177], v8 offset:0
    ds_read_b64_tr_b16 v[178:179], v8 offset:512
    s_waitcnt lgkmcnt(6)
    v_mfma_f32_32x32x16_bf16 v[128:143], v[84:87], v[164:167], v[128:143]
    ds_read_b64_tr_b16 v[180:181], v8 offset:2048
    ds_read_b64_tr_b16 v[182:183], v8 offset:2560
    s_waitcnt lgkmcnt(6)
    v_mfma_f32_32x32x16_bf16 v[128:143], v[88:91], v[168:171], v[128:143]
    ds_read_b64_tr_b16 v[184:185], v8 offset:4096
    ds_read_b64_tr_b16 v[186:187], v8 offset:4608
    s_waitcnt lgkmcnt(6)
    v_mfma_f32_32x32x16_bf16 v[128:143], v[92:95], v[172:175], v[128:143]
    ds_read_b64_tr_b16 v[188:189], v8 offset:6144
    ds_read_b64_tr_b16 v[190:191], v8 offset:6656
    s_waitcnt lgkmcnt(6)
    v_mfma_f32_32x32x16_bf16 v[128:143], v[96:99], v[176:179], v[128:143]
    s_waitcnt vmcnt(0)
    s_barrier
    s_add_u32 m0, s59, 139264
    s_bfe_u32 s96, s75, 0x40000
    s_mul_i32 s96, s96, 229376
    s_add_u32 s96, s96, s69
    buffer_load_dwordx4 v3, s[16:19], s96 offen lds
    s_add_u32 m0, s59, 49152
    s_nop 0
    buffer_load_dwordx4 v3, s[20:23], s96 offen lds
    v_readfirstlane_b32 s76, v200
    s_nop 0
    s_cmp_lg_u32 s76, 0
    s_cbranch_scc1 L_tagok41
    s_mov_b32 s52, 0x8000
L_tagspin42:
    buffer_load_dword v200, v14, s[48:51], 0 offen sc1
    s_waitcnt vmcnt(0)
    v_readfirstlane_b32 s76, v200
    s_nop 0
    s_cmp_lg_u32 s76, 0
    s_cbranch_scc1 L_tagok41
    s_sleep 2
    s_sub_u32 s52, s52, 1
    s_cmp_lg_u32 s52, 0
    s_cbranch_scc1 L_tagspin42
L_tagok41:
    s_xor_b32 s77, s76, 0x5bd1e995
    v_mov_b32 v222, s76
    v_mov_b32 v223, s77
    s_cmp_lt_u32 s58, 4
    s_cbranch_scc1 L_p043
    s_add_u32 s60, s78, 512
    s_mov_b64 exec, 1
    buffer_store_dwordx2 v[222:223], v14, s[24:27], s78 offen sc1
    s_mov_b64 exec, -1
    s_mov_b64 exec, 1
    buffer_store_dwordx2 v[222:223], v14, s[24:27], s60 offen sc1
    s_mov_b64 exec, -1
L_p043:
    s_cmp_lt_u32 s58, 4
    s_cbranch_scc1 L_rdone44
    v_lshrrev_b32 v204, 5, v1
    v_and_b32 v205, 31, v1
    s_and_b32 s60, s2, 7
    s_lshr_b32 s61, s2, 3
    s_mul_i32 s82, s61, 37
    s_lshr_b32 s82, s82, 8
    s_mul_i32 s83, s82, 7
    s_sub_u32 s83, s61, s83
    s_lshl_b32 s60, s60, 2
    s_add_u32 s82, s82, s60
    s_and_b32 s60, s58, 3
    s_mul_i32 s87, s60, 26624
    v_lshrrev_b32 v206, 3, v1
    v_mul_u32_u24 v240, 896, v206
    v_and_b32 v206, 7, v1
    v_bfe_u32 v12, v1, 4, 1
    v_lshlrev_b32 v12, 2, v12
    v_xor_b32 v206, v206, v12
    v_lshl_add_u32 v240, v206, 4, v240
    v_bfe_u32 v206, v1, 2, 2
    v_lshl_add_u32 v12, v204, 2, v206
    v_lshlrev_b32 v242, 7, v12
    v_lshrrev_b32 v206, 1, v206
    v_lshl_add_u32 v242, v206, 6, v242
    v_bfe_u32 v206, v1, 4, 1
    v_lshl_add_u32 v242, v206, 5, v242
    v_and_b32 v206, 3, v1
    v_lshl_add_u32 v242, v206, 3, v242
    v_xor_b32 v243, 64, v242
    v_add_u32 v242, s87, v242
    v_add_u32 v243, s87, v243
    s_and_b32 s4, s82, 3
    s_lshl_b32 s4, s4, 1
    s_add_u32 s6, s4, s83
    s_cmp_ge_u32 s6, 7
    s_cselect_b32 s4, 7, 0
    s_sub_u32 s6, s6, s4
    s_lshl_b32 s6, s6, 2
    s_mov_b32 s4, 0x6543210
    s_mov_b32 s5, 0x654321
    s_lshr_b64 s[4:5], s[4:5], s6
    s_mov_b32 s88, s4
    s_mul_i32 s4, s60, 14
    v_add_u32 v206, s4, v205
    v_cmp_gt_u32 vcc, 14, v205
    s_nop 1
    v_cndmask_b32 v206, 56, v206, vcc
    s_lshl_b32 s5, s82, 1
    v_add_u32 v12, s5, v204
    v_lshl_add_u32 v244, v12, 6, v206
    v_lshlrev_b32 v244, 3, v244
    v_add_u32 v244, 24576, v244
    s_lshl_b32 s4, s60, 2
    v_and_b32 v206, 3, v1
    v_add_u32 v206, s4, v206
    v_lshl_add_u32 v245, v12, 4, v206
    v_lshlrev_b32 v245, 3, v245
    v_add_u32 v245, 57344, v245
L_rdone44:
    ds_read_b64_tr_b16 v[160:161], v6 offset:32768
    ds_read_b64_tr_b16 v[162:163], v6 offset:33280
    s_waitcnt lgkmcnt(6)
    v_mfma_f32_32x32x16_bf16 v[128:143], v[100:103], v[180:183], v[128:143]
    ds_read_b64_tr_b16 v[164:165], v6 offset:34816
    ds_read_b64_tr_b16 v[166:167], v6 offset:35328
    s_waitcnt lgkmcnt(6)
    v_mfma_f32_32x32x16_bf16 v[128:143], v[104:107], v[184:187], v[128:143]
    ds_read_b64_tr_b16 v[168:169], v6 offset:36864
    ds_read_b64_tr_b16 v[170:171], v6 offset:37376
    s_waitcnt lgkmcnt(6)
    v_mfma_f32_32x32x16_bf16 v[128:143], v[108:111], v[188:191], v[128:143]
    ds_read_b64_tr_b16 v[172:173], v6 offset:38912
    ds_read_b64_tr_b16 v[174:175], v6 offset:39424
    s_waitcnt lgkmcnt(6)
    v_mfma_f32_32x32x16_bf16 v[128:143], v[112:115], v[160:163], v[128:143]
    s_waitcnt lgkmcnt(4)
    v_mfma_f32_32x32x16_bf16 v[128:143], v[116:119], v[164:167], v[128:143]
    s_waitcnt lgkmcnt(2)
    v_mfma_f32_32x32x16_bf16 v[128:143], v[120:123], v[168:171], v[128:143]
    s_waitcnt lgkmcnt(0)
    v_mfma_f32_32x32x16_bf16 v[128:143], v[124:127], v[172:175], v[128:143]
    v_lshrrev_b32 v215, 5, v1
    v_lshlrev_b32 v215, 4, v215
    s_add_u32 s60, s59, 40960
    v_add_u32 v215, s60, v215
    s_cmp_ge_u32 s58, 4
    s_cbranch_scc1 L_sh45
    s_waitcnt vmcnt(10)
    s_cmp_ge_u32 s58, 4
    s_cbranch_scc1 L_vw47
    s_waitcnt vmcnt(2)
L_vw47:
    s_barrier
    s_add_u32 m0, s59, 57344
    s_bfe_u32 s96, s75, 0x40004
    s_mul_i32 s96, s96, 229376
    s_add_u32 s96, s96, s69
    buffer_load_dwordx4 v3, s[16:19], s96 offen lds
    s_add_u32 m0, s59, 147456
    s_nop 0
    buffer_load_dwordx4 v3, s[20:23], s96 offen lds
    s_add_u32 m0, s59, 65536
    s_bfe_u32 s96, s75, 0x40008
    s_mul_i32 s96, s96, 229376
    s_add_u32 s96, s96, s69
    buffer_load_dwordx4 v3, s[16:19], s96 offen lds
    s_add_u32 m0, s59, 73728
    s_nop 0
    buffer_load_dwordx4 v3, s[20:23], s96 offen lds
    s_add_u32 m0, s59, 155648
    s_bfe_u32 s96, s75, 0x4000c
    s_mul_i32 s96, s96, 229376
    s_add_u32 s96, s96, s69
    buffer_load_dwordx4 v3, s[16:19], s96 offen lds
    s_add_u32 m0, s59, 81920
    s_nop 0
    buffer_load_dwordx4 v3, s[20:23], s96 offen lds
    v_cvt_pk_bf16_f32 v192, v128, v129
    v_cvt_pk_bf16_f32 v193, v130, v131
    v_cvt_pk_bf16_f32 v194, v132, v133
    v_cvt_pk_bf16_f32 v195, v134, v135
    buffer_store_dwordx4 v[192:195], v10, s[24:27], s71 offen sc1
    v_cvt_pk_bf16_f32 v196, v136, v137
    v_cvt_pk_bf16_f32 v197, v138, v139
    v_cvt_pk_bf16_f32 v198, v140, v141
    v_cvt_pk_bf16_f32 v199, v142, v143
    s_add_u32 s60, s71, 14336
    buffer_store_dwordx4 v[196:199], v10, s[24:27], s60 offen sc1
    v_cmp_gt_u32 vcc, 4, v1
    v_mov_b32 v12, 0x3f803f80
    v_lshlrev_b32 v207, 2, v1
    s_mul_i32 s60, s63, 29184
    v_cndmask_b32 v12, 0, v12, vcc
    s_add_u32 s60, s60, 16805888
    s_mov_b64 exec, 0xffff
    buffer_store_dword v12, v207, s[24:27], s60 offen sc1
    s_mov_b64 exec, -1
    s_branch L_sj46
L_sh45:
    s_waitcnt vmcnt(10)
    s_cmp_ge_u32 s58, 4
    s_cbranch_scc1 L_vw47h
    s_waitcnt vmcnt(2)
L_vw47h:
    s_barrier
    s_add_u32 m0, s59, 57344
    s_bfe_u32 s96, s75, 0x40004
    s_mul_i32 s96, s96, 229376
    s_add_u32 s96, s96, s69
    buffer_load_dwordx4 v3, s[16:19], s96 offen lds
    s_add_u32 m0, s59, 147456
    s_nop 0
    buffer_load_dwordx4 v3, s[20:23], s96 offen lds
    s_add_u32 m0, s59, 65536
    s_bfe_u32 s96, s75, 0x40008
    s_mul_i32 s96, s96, 229376
    s_add_u32 s96, s96, s69
    buffer_load_dwordx4 v3, s[16:19], s96 offen lds
    s_add_u32 m0, s59, 73728
    s_nop 0
    buffer_load_dwordx4 v3, s[20:23], s96 offen lds
    s_add_u32 m0, s59, 155648
    s_bfe_u32 s96, s75, 0x4000c
    s_mul_i32 s96, s96, 229376
    s_add_u32 s96, s96, s69
    buffer_load_dwordx4 v3, s[16:19], s96 offen lds
    s_add_u32 m0, s59, 81920
    s_nop 0
    buffer_load_dwordx4 v3, s[20:23], s96 offen lds
    ds_read_b64 v[176:177], v215 offset:0
    ds_read_b64 v[178:179], v215 offset:8
    ds_read_b64 v[180:181], v215 offset:32
    ds_read_b64 v[182:183], v215 offset:40
    ds_read_b64 v[184:185], v215 offset:64
    ds_read_b64 v[186:187], v215 offset:72
    ds_read_b64 v[188:189], v215 offset:96
    ds_read_b64 v[190:191], v215 offset:104
    v_cvt_pk_bf16_f32 v192, v128, v129
    v_cvt_pk_bf16_f32 v193, v130, v131
    v_cvt_pk_bf16_f32 v194, v132, v133
    v_cvt_pk_bf16_f32 v195, v134, v135
    buffer_store_dwordx4 v[192:195], v10, s[24:27], s71 offen sc1
    v_cvt_pk_bf16_f32 v196, v136, v137
    v_cvt_pk_bf16_f32 v197, v138, v139
    v_cvt_pk_bf16_f32 v198, v140, v141
    v_cvt_pk_bf16_f32 v199, v142, v143
    s_add_u32 s60, s71, 14336
    buffer_store_dwordx4 v[196:199], v10, s[24:27], s60 offen sc1
    v_cmp_gt_u32 vcc, 4, v1
    v_mov_b32 v12, 0x3f803f80
    v_lshlrev_b32 v207, 2, v1
    s_mul_i32 s60, s63, 29184
    v_cndmask_b32 v12, 0, v12, vcc
    s_add_u32 s60, s60, 16805888
    s_mov_b64 exec, 0xffff
    buffer_store_dword v12, v207, s[24:27], s60 offen sc1
    s_mov_b64 exec, -1
    s_waitcnt lgkmcnt(6)
    v_mfma_f32_32x32x16_bf16 v[128:143], v[176:179], v[16:19], 0
    ds_read_b64 v[160:161], v215 offset:128
    ds_read_b64 v[162:163], v215 offset:136
    s_waitcnt lgkmcnt(6)
    v_mfma_f32_32x32x16_bf16 v[128:143], v[180:183], v[20:23], v[128:143]
    ds_read_b64 v[164:165], v215 offset:160
    ds_read_b64 v[166:167], v215 offset:168
    s_waitcnt lgkmcnt(6)
    v_mfma_f32_32x32x16_bf16 v[128:143], v[184:187], v[24:27], v[128:143]
    ds_read_b64 v[168:169], v215 offset:192
    ds_read_b64 v[170:171], v215 offset:200
    s_waitcnt lgkmcnt(6)
    v_mfma_f32_32x32x16_bf16 v[128:143], v[188:191], v[28:31], v[128:143]
    ds_read_b64 v[172:173], v215 offset:224
    ds_read_b64 v[174:175], v215 offset:232
    s_waitcnt lgkmcnt(6)
    v_mfma_f32_32x32x16_bf16 v[128:143], v[160:163], v[32:35], v[128:143]
    ds_read_b64 v[176:177], v215 offset:256
    ds_read_b64 v[178:179], v215 offset:264
    s_waitcnt lgkmcnt(6)
    v_mfma_f32_32x32x16_bf16 v[128:143], v[164:167], v[36:39], v[128:143]
    ds_read_b64 v[180:181], v215 offset:288
    ds_read_b64 v[182:183], v215 offset:296
    s_waitcnt lgkmcnt(6)
    v_mfma_f32_32x32x16_bf16 v[128:143], v[168:171], v[40:43], v[128:143]
    ds_read_b64 v[184:185], v215 offset:320
    ds_read_b64 v[186:187], v215 offset:328
    s_waitcnt lgkmcnt(6)
    v_mfma_f32_32x32x16_bf16 v[128:143], v[172:175], v[44:47], v[128:143]
    ds_read_b64 v[188:189], v215 offset:352
    ds_read_b64 v[190:191], v215 offset:360
    s_waitcnt lgkmcnt(6)
    v_mfma_f32_32x32x16_bf16 v[128:143], v[176:179], v[48:51], v[128:143]
    ds_read_b64 v[160:161], v215 offset:384
    ds_read_b64 v[162:163], v215 offset:392
    s_waitcnt lgkmcnt(6)
    v_mfma_f32_32x32x16_bf16 v[128:143], v[180:183], v[52:55], v[128:143]
    ds_read_b64 v[164:165], v215 offset:416
    ds_read_b64 v[166:167], v215 offset:424
    s_waitcnt lgkmcnt(6)
    v_mfma_f32_32x32x16_bf16 v[128:143], v[184:187], v[56:59], v[128:143]
    ds_read_b64 v[168:169], v215 offset:448
    ds_read_b64 v[170:171], v215 offset:456
    s_waitcnt lgkmcnt(6)
    v_mfma_f32_32x32x16_bf16 v[128:143], v[188:191], v[60:63], v[128:143]
    ds_read_b64 v[172:173], v215 offset:480
    ds_read_b64 v[174:175], v215 offset:488
    s_waitcnt lgkmcnt(6)
    v_mfma_f32_32x32x16_bf16 v[128:143], v[160:163], v[64:67], v[128:143]
    ds_read_b64 v[176:177], v215 offset:512
    ds_read_b64 v[178:179], v215 offset:520
    s_waitcnt lgkmcnt(6)
    v_mfma_f32_32x32x16_bf16 v[128:143], v[164:167], v[68:71], v[128:143]
    ds_read_b64 v[180:181], v215 offset:544
    ds_read_b64 v[182:183], v215 offset:552
    s_waitcnt lgkmcnt(6)
    v_mfma_f32_32x32x16_bf16 v[128:143], v[168:171], v[72:75], v[128:143]
    ds_read_b64 v[184:185], v215 offset:576
    ds_read_b64 v[186:187], v215 offset:584
    s_waitcnt lgkmcnt(6)
    v_mfma_f32_32x32x16_bf16 v[128:143], v[172:175], v[76:79], v[128:143]
    ds_read_b64 v[188:189], v215 offset:608
    ds_read_b64 v[190:191], v215 offset:616
    s_waitcnt lgkmcnt(6)
    v_mfma_f32_32x32x16_bf16 v[128:143], v[176:179], v[80:83], v[128:143]
    ds_read_b64 v[160:161], v215 offset:640
    ds_read_b64 v[162:163], v215 offset:648
    s_waitcnt lgkmcnt(6)
    v_mfma_f32_32x32x16_bf16 v[128:143], v[180:183], v[84:87], v[128:143]
    ds_read_b64 v[164:165], v215 offset:672
    ds_read_b64 v[166:167], v215 offset:680
    s_waitcnt lgkmcnt(6)
    v_mfma_f32_32x32x16_bf16 v[128:143], v[184:187], v[88:91], v[128:143]
    ds_read_b64 v[168:169], v215 offset:704
    ds_read_b64 v[170:171], v215 offset:712
    s_waitcnt lgkmcnt(6)
    v_mfma_f32_32x32x16_bf16 v[128:143], v[188:191], v[92:95], v[128:143]
    ds_read_b64 v[172:173], v215 offset:736
    ds_read_b64 v[174:175], v215 offset:744
    s_waitcnt lgkmcnt(6)
    v_mfma_f32_32x32x16_bf16 v[128:143], v[160:163], v[96:99], v[128:143]
    ds_read_b64 v[176:177], v215 offset:768
    ds_read_b64 v[178:179], v215 offset:776
    s_waitcnt lgkmcnt(6)
    v_mfma_f32_32x32x16_bf16 v[128:143], v[164:167], v[100:103], v[128:143]
    ds_read_b64 v[180:181], v215 offset:800
    ds_read_b64 v[182:183], v215 offset:808
    s_waitcnt lgkmcnt(6)
    v_mfma_f32_32x32x16_bf16 v[128:143], v[168:171], v[104:107], v[128:143]
    ds_read_b64 v[184:185], v215 offset:832
    ds_read_b64 v[186:187], v215 offset:840
    s_waitcnt lgkmcnt(6)
    v_mfma_f32_32x32x16_bf16 v[128:143], v[172:175], v[108:111], v[128:143]
    ds_read_b64 v[188:189], v215 offset:864
    ds_read_b64 v[190:191], v215 offset:872
    s_waitcnt lgkmcnt(6)
    v_mfma_f32_32x32x16_bf16 v[128:143], v[176:179], v[112:115], v[128:143]
    s_waitcnt lgkmcnt(4)
    v_mfma_f32_32x32x16_bf16 v[128:143], v[180:183], v[116:119], v[128:143]
    s_waitcnt lgkmcnt(2)
    v_mfma_f32_32x32x16_bf16 v[128:143], v[184:187], v[120:123], v[128:143]
    s_waitcnt lgkmcnt(0)
    v_mfma_f32_32x32x16_bf16 v[128:143], v[188:191], v[124:127], v[128:143]
L_sj46:
    s_waitcnt vmcnt(9)
    s_barrier
    s_lshl_b32 s60, s2, 13
    v_lshlrev_b32 v192, 7, v1
    s_cmp_lg_u32 s58, 0
    s_cbranch_scc1 L_pwn49
    buffer_load_dword v203, v192, s[28:31], s60 offen
L_pwn49:
    s_cmp_lg_u32 s58, 1
    s_cbranch_scc1 L_pwn50
    buffer_load_dword v203, v192, s[32:35], s60 offen
L_pwn50:
    ds_read_b64_tr_b16 v[160:161], v8 offset:8192
    ds_read_b64_tr_b16 v[162:163], v8 offset:8704
    s_add_u32 m0, s59, 90112
    s_bfe_u32 s96, s75, 0x40010
    s_mul_i32 s96, s96, 229376
    s_add_u32 s96, s96, s69
    buffer_load_dwordx4 v3, s[16:19], s96 offen lds
    ds_read_b64_tr_b16 v[164:165], v6 offset:49152
    ds_read_b64_tr_b16 v[166:167], v6 offset:49664
    ds_read_b64_tr_b16 v[168:169], v8 offset:10240
    ds_read_b64_tr_b16 v[170:171], v8 offset:10752
    ds_read_b64_tr_b16 v[172:173], v6 offset:51200
    ds_read_b64_tr_b16 v[174:175], v6 offset:51712
    s_cmp_lt_u32 s58, 4
    s_cbranch_scc1 L_sj51
    s_nop 7
    v_mul_f32 v192, 0xbfb8aa3b, v128
    v_exp_f32 v192, v192
    s_nop 0
    v_add_f32 v192, 1.0, v192
    v_rcp_f32 v192, v192
    s_mov_b32 s60, 14942208
    s_nop 0
    buffer_store_dword v192, v13, s[24:27], s60 offen sc1
L_sj51:
    s_waitcnt lgkmcnt(6)
    v_mfma_f32_32x32x16_bf16 v[128:143], v[160:163], v[16:19], 0
    ds_read_b64_tr_b16 v[176:177], v8 offset:12288
    ds_read_b64_tr_b16 v[178:179], v8 offset:12800
    s_waitcnt lgkmcnt(6)
    v_mfma_f32_32x32x16_bf16 v[144:159], v[164:167], v[16:19], 0
    s_add_u32 m0, s59, 114688
    s_nop 0
    buffer_load_dwordx4 v3, s[20:23], s96 offen lds
    ds_read_b64_tr_b16 v[180:181], v6 offset:53248
    ds_read_b64_tr_b16 v[182:183], v6 offset:53760
    s_waitcnt lgkmcnt(6)
    v_mfma_f32_32x32x16_bf16 v[128:143], v[168:171], v[20:23], v[128:143]
    ds_read_b64_tr_b16 v[184:185], v8 offset:14336
    ds_read_b64_tr_b16 v[186:187], v8 offset:14848
    s_waitcnt lgkmcnt(6)
    v_mfma_f32_32x32x16_bf16 v[144:159], v[172:175], v[20:23], v[144:159]
    ds_read_b64_tr_b16 v[188:189], v6 offset:55296
    ds_read_b64_tr_b16 v[190:191], v6 offset:55808
    s_waitcnt lgkmcnt(6)
    v_mfma_f32_32x32x16_bf16 v[128:143], v[176:179], v[24:27], v[128:143]
    s_waitcnt vmcnt(9)
    s_barrier
    ds_read_b64_tr_b16 v[160:161], v6 offset:57344
    ds_read_b64_tr_b16 v[162:163], v6 offset:57856
    s_waitcnt lgkmcnt(6)
    v_mfma_f32_32x32x16_bf16 v[144:159], v[180:183], v[24:27], v[144:159]
    s_add_u32 m0, s59, 98304
    s_bfe_u32 s96, s75, 0x40014
    s_mul_i32 s96, s96, 229376
    s_add_u32 s96, s96, s69
    buffer_load_dwordx4 v3, s[16:19], s96 offen lds
    ds_read_b64_tr_b16 v[164:165], v8 offset:16384
    ds_read_b64_tr_b16 v[166:167], v8 offset:16896
    s_waitcnt lgkmcnt(6)
    v_mfma_f32_32x32x16_bf16 v[128:143], v[184:187], v[28:31], v[128:143]
    ds_read_b64_tr_b16 v[168:169], v6 offset:59392
    ds_read_b64_tr_b16 v[170:171], v6 offset:59904
    s_waitcnt lgkmcnt(6)
    v_mfma_f32_32x32x16_bf16 v[144:159], v[188:191], v[28:31], v[144:159]
    ds_read_b64_tr_b16 v[172:173], v8 offset:18432
    ds_read_b64_tr_b16 v[174:175], v8 offset:18944
    s_waitcnt lgkmcnt(6)
    v_mfma_f32_32x32x16_bf16 v[128:143], v[160:163], v[32:35], v[128:143]
    ds_read_b64_tr_b16 v[176:177], v6 offset:61440
    ds_read_b64_tr_b16 v[178:179], v6 offset:61952
    s_waitcnt lgkmcnt(6)
    v_mfma_f32_32x32x16_bf16 v[144:159], v[164:167], v[32:35], v[144:159]
    s_add_u32 m0, s59, 106496
    s_nop 0
    buffer_load_dwordx4 v3, s[20:23], s96 offen lds
    ds_read_b64_tr_b16 v[180:181], v8 offset:20480
    ds_read_b64_tr_b16 v[182:183], v8 offset:20992
    s_waitcnt lgkmcnt(6)
    v_mfma_f32_32x32x16_bf16 v[128:143], v[168:171], v[36:39], v[128:143]
    ds_read_b64_tr_b16 v[184:185], v6 offset:63488
    ds_read_b64_tr_b16 v[186:187], v6 offset:64000
    s_waitcnt lgkmcnt(6)
    v_mfma_f32_32x32x16_bf16 v[144:159], v[172:175], v[36:39], v[144:159]
    ds_read_b64_tr_b16 v[188:189], v8 offset:22528
    ds_read_b64_tr_b16 v[190:191], v8 offset:23040
    s_waitcnt lgkmcnt(6)
    v_mfma_f32_32x32x16_bf16 v[128:143], v[176:179], v[40:43], v[128:143]
    s_waitcnt vmcnt(3)
    s_barrier
    s_mov_b64 exec, 1
    buffer_store_dwordx2 v[222:223], v14, s[24:27], s79 offen sc1
    s_mov_b64 exec, -1
    s_cmp_lt_u32 s58, 4
    s_cbranch_scc1 L_p052
    s_mov_b64 exec, 1
    buffer_store_dwordx2 v[222:223], v14, s[24:27], s80 offen sc1
    s_mov_b64 exec, -1
L_p052:
    ds_read_b64_tr_b16 v[160:161], v7 offset:0
    ds_read_b64_tr_b16 v[162:163], v7 offset:512
    s_waitcnt lgkmcnt(6)
    v_mfma_f32_32x32x16_bf16 v[144:159], v[180:183], v[40:43], v[144:159]
    s_add_u32 m0, s59, 0
    s_bfe_u32 s96, s75, 0x40018
    s_mul_i32 s96, s96, 229376
    s_add_u32 s96, s96, s69
    buffer_load_dwordx4 v3, s[16:19], s96 offen lds
    ds_read_b64_tr_b16 v[164:165], v7 offset:8192
    ds_read_b64_tr_b16 v[166:167], v7 offset:8704
    s_waitcnt lgkmcnt(6)
    v_mfma_f32_32x32x16_bf16 v[128:143], v[184:187], v[44:47], v[128:143]
    ds_read_b64_tr_b16 v[168:169], v7 offset:2048
    ds_read_b64_tr_b16 v[170:171], v7 offset:2560
    s_waitcnt lgkmcnt(6)
    v_mfma_f32_32x32x16_bf16 v[144:159], v[188:191], v[44:47], v[144:159]
    ds_read_b64_tr_b16 v[172:173], v7 offset:10240
    ds_read_b64_tr_b16 v[174:175], v7 offset:10752
    s_waitcnt lgkmcnt(6)
    v_mfma_f32_32x32x16_bf16 v[128:143], v[160:163], v[48:51], v[128:143]
    ds_read_b64_tr_b16 v[176:177], v7 offset:4096
    ds_read_b64_tr_b16 v[178:179], v7 offset:4608
    s_waitcnt lgkmcnt(6)
    v_mfma_f32_32x32x16_bf16 v[144:159], v[164:167], v[48:51], v[144:159]
    s_add_u32 m0, s59, 8192
    s_nop 0
    buffer_load_dwordx4 v3, s[20:23], s96 offen lds
    ds_read_b64_tr_b16 v[180:181], v7 offset:12288
    ds_read_b64_tr_b16 v[182:183], v7 offset:12800
    s_waitcnt lgkmcnt(6)
    v_mfma_f32_32x32x16_bf16 v[128:143], v[168:171], v[52:55], v[128:143]
    ds_read_b64_tr_b16 v[184:185], v7 offset:6144
    ds_read_b64_tr_b16 v[186:187], v7 offset:6656
    s_waitcnt lgkmcnt(6)
    v_mfma_f32_32x32x16_bf16 v[144:159], v[172:175], v[52:55], v[144:159]
    ds_read_b64_tr_b16 v[188:189], v7 offset:14336
    ds_read_b64_tr_b16 v[190:191], v7 offset:14848
    s_waitcnt lgkmcnt(6)
    v_mfma_f32_32x32x16_bf16 v[128:143], v[176:179], v[56:59], v[128:143]
    s_waitcnt vmcnt(10)
    s_barrier
    ds_read_b64_tr_b16 v[160:161], v8 offset:24576
    ds_read_b64_tr_b16 v[162:163], v8 offset:25088
    s_waitcnt lgkmcnt(6)
    v_mfma_f32_32x32x16_bf16 v[144:159], v[180:183], v[56:59], v[144:159]
    ds_read_b64_tr_b16 v[164:165], v7 offset:16384
    ds_read_b64_tr_b16 v[166:167], v7 offset:16896
    s_waitcnt lgkmcnt(6)
    v_mfma_f32_32x32x16_bf16 v[128:143], v[184:187], v[60:63], v[128:143]
    ds_read_b64_tr_b16 v[168:169], v8 offset:26624
    ds_read_b64_tr_b16 v[170:171], v8 offset:27136
    s_waitcnt lgkmcnt(6)
    v_mfma_f32_32x32x16_bf16 v[144:159], v[188:191], v[60:63], v[144:159]
    ds_read_b64_tr_b16 v[172:173], v7 offset:18432
    ds_read_b64_tr_b16 v[174:175], v7 offset:18944
    s_waitcnt lgkmcnt(6)
    v_mfma_f32_32x32x16_bf16 v[128:143], v[160:163], v[64:67], v[128:143]
    ds_read_b64_tr_b16 v[176:177], v8 offset:28672
    ds_read_b64_tr_b16 v[178:179], v8 offset:29184
    s_waitcnt lgkmcnt(6)
    v_mfma_f32_32x32x16_bf16 v[144:159], v[164:167], v[64:67], v[144:159]
    ds_read_b64_tr_b16 v[180:181], v7 offset:20480
    ds_read_b64_tr_b16 v[182:183], v7 offset:20992
    s_waitcnt lgkmcnt(6)
    v_mfma_f32_32x32x16_bf16 v[128:143], v[168:171], v[68:71], v[128:143]
    ds_read_b64_tr_b16 v[184:185], v8 offset:30720
    ds_read_b64_tr_b16 v[186:187], v8 offset:31232
    s_waitcnt lgkmcnt(6)
    v_mfma_f32_32x32x16_bf16 v[144:159], v[172:175], v[68:71], v[144:159]
    ds_read_b64_tr_b16 v[188:189], v7 offset:22528
    ds_read_b64_tr_b16 v[190:191], v7 offset:23040
    s_waitcnt lgkmcnt(6)
    v_mfma_f32_32x32x16_bf16 v[128:143], v[176:179], v[72:75], v[128:143]
    s_waitcnt vmcnt(5)
    s_barrier
    ds_read_b64_tr_b16 v[160:161], v7 offset:24576
    ds_read_b64_tr_b16 v[162:163], v7 offset:25088
    s_waitcnt lgkmcnt(6)
    v_mfma_f32_32x32x16_bf16 v[144:159], v[180:183], v[72:75], v[144:159]
    ds_read_b64_tr_b16 v[164:165], v7 offset:49152
    ds_read_b64_tr_b16 v[166:167], v7 offset:49664
    s_waitcnt lgkmcnt(6)
    v_mfma_f32_32x32x16_bf16 v[128:143], v[184:187], v[76:79], v[128:143]
    ds_read_b64_tr_b16 v[168:169], v7 offset:26624
    ds_read_b64_tr_b16 v[170:171], v7 offset:27136
    s_waitcnt lgkmcnt(6)
    v_mfma_f32_32x32x16_bf16 v[144:159], v[188:191], v[76:79], v[144:159]
    ds_read_b64_tr_b16 v[172:173], v7 offset:51200
    ds_read_b64_tr_b16 v[174:175], v7 offset:51712
    s_waitcnt lgkmcnt(6)
    v_mfma_f32_32x32x16_bf16 v[128:143], v[160:163], v[80:83], v[128:143]
    ds_read_b64_tr_b16 v[176:177], v7 offset:28672
    ds_read_b64_tr_b16 v[178:179], v7 offset:29184
    s_waitcnt lgkmcnt(6)
    v_mfma_f32_32x32x16_bf16 v[144:159], v[164:167], v[80:83], v[144:159]
    ds_read_b64_tr_b16 v[180:181], v7 offset:53248
    ds_read_b64_tr_b16 v[182:183], v7 offset:53760
    s_waitcnt lgkmcnt(6)
    v_mfma_f32_32x32x16_bf16 v[128:143], v[168:171], v[84:87], v[128:143]
    ds_read_b64_tr_b16 v[184:185], v7 offset:30720
    ds_read_b64_tr_b16 v[186:187], v7 offset:31232
    s_waitcnt lgkmcnt(6)
    v_mfma_f32_32x32x16_bf16 v[144:159], v[172:175], v[84:87], v[144:159]
    ds_read_b64_tr_b16 v[188:189], v7 offset:55296
    ds_read_b64_tr_b16 v[190:191], v7 offset:55808
    s_waitcnt lgkmcnt(6)
    v_mfma_f32_32x32x16_bf16 v[128:143], v[176:179], v[88:91], v[128:143]
    s_waitcnt vmcnt(3)
    s_barrier
    s_mov_b32 s60, 15007744
    buffer_load_dwordx2 v[216:217], v242, s[24:27], s60 offen sc1
    buffer_load_dwordx2 v[218:219], v243, s[24:27], s60 offen sc1
    ds_read_b64_tr_b16 v[160:161], v7 offset:32768
    ds_read_b64_tr_b16 v[162:163], v7 offset:33280
    s_waitcnt lgkmcnt(6)
    v_mfma_f32_32x32x16_bf16 v[144:159], v[180:183], v[88:91], v[144:159]
    ds_read_b64_tr_b16 v[164:165], v7 offset:40960
    ds_read_b64_tr_b16 v[166:167], v7 offset:41472
    s_waitcnt lgkmcnt(6)
    v_mfma_f32_32x32x16_bf16 v[128:143], v[184:187], v[92:95], v[128:143]
    ds_read_b64_tr_b16 v[168:169], v7 offset:34816
    ds_read_b64_tr_b16 v[170:171], v7 offset:35328
    s_waitcnt lgkmcnt(6)
    v_mfma_f32_32x32x16_bf16 v[144:159], v[188:191], v[92:95], v[144:159]
    ds_read_b64_tr_b16 v[172:173], v7 offset:43008
    ds_read_b64_tr_b16 v[174:175], v7 offset:43520
    s_waitcnt lgkmcnt(6)
    v_mfma_f32_32x32x16_bf16 v[128:143], v[160:163], v[96:99], v[128:143]
    ds_read_b64_tr_b16 v[176:177], v7 offset:36864
    ds_read_b64_tr_b16 v[178:179], v7 offset:37376
    s_waitcnt lgkmcnt(6)
    v_mfma_f32_32x32x16_bf16 v[144:159], v[164:167], v[96:99], v[144:159]
    ds_read_b64_tr_b16 v[180:181], v7 offset:45056
    ds_read_b64_tr_b16 v[182:183], v7 offset:45568
    s_waitcnt lgkmcnt(6)
    v_mfma_f32_32x32x16_bf16 v[128:143], v[168:171], v[100:103], v[128:143]
    ds_read_b64_tr_b16 v[184:185], v7 offset:38912
    ds_read_b64_tr_b16 v[186:187], v7 offset:39424
    s_waitcnt lgkmcnt(6)
    v_mfma_f32_32x32x16_bf16 v[144:159], v[172:175], v[100:103], v[144:159]
    ds_read_b64_tr_b16 v[188:189], v7 offset:47104
    ds_read_b64_tr_b16 v[190:191], v7 offset:47616
    s_waitcnt lgkmcnt(6)
    v_mfma_f32_32x32x16_bf16 v[128:143], v[176:179], v[104:107], v[128:143]
    s_waitcnt vmcnt(2)
    s_barrier
    s_mov_b32 s3, 159744
    v_mov_b32 v204, s3
    ds_write_b32 v204, v14
    ds_write_b32 v204, v14 offset:4
    ds_read_b64_tr_b16 v[160:161], v6 offset:0
    ds_read_b64_tr_b16 v[162:163], v6 offset:512
    s_waitcnt lgkmcnt(8)
    v_mfma_f32_32x32x16_bf16 v[144:159], v[180:183], v[104:107], v[144:159]
    ds_read_b64_tr_b16 v[164:165], v6 offset:8192
    ds_read_b64_tr_b16 v[166:167], v6 offset:8704
    s_waitcnt lgkmcnt(8)
    v_mfma_f32_32x32x16_bf16 v[128:143], v[184:187], v[108:111], v[128:143]
    ds_read_b64_tr_b16 v[168:169], v6 offset:2048
    ds_read_b64_tr_b16 v[170:171], v6 offset:2560
    s_waitcnt lgkmcnt(8)
    v_mfma_f32_32x32x16_bf16 v[144:159], v[188:191], v[108:111], v[144:159]
    ds_read_b64_tr_b16 v[172:173], v6 offset:10240
    ds_read_b64_tr_b16 v[174:175], v6 offset:10752
    s_waitcnt lgkmcnt(6)
    v_mfma_f32_32x32x16_bf16 v[128:143], v[160:163], v[112:115], v[128:143]
    ds_read_b64_tr_b16 v[176:177], v6 offset:4096
    ds_read_b64_tr_b16 v[178:179], v6 offset:4608
    s_waitcnt lgkmcnt(6)
    v_mfma_f32_32x32x16_bf16 v[144:159], v[164:167], v[112:115], v[144:159]
    ds_read_b64_tr_b16 v[180:181], v6 offset:12288
    ds_read_b64_tr_b16 v[182:183], v6 offset:12800
    s_waitcnt lgkmcnt(6)
    v_mfma_f32_32x32x16_bf16 v[128:143], v[168:171], v[116:119], v[128:143]
    ds_read_b64_tr_b16 v[184:185], v6 offset:6144
    ds_read_b64_tr_b16 v[186:187], v6 offset:6656
    s_waitcnt lgkmcnt(6)
    v_mfma_f32_32x32x16_bf16 v[144:159], v[172:175], v[116:119], v[144:159]
    ds_read_b64_tr_b16 v[188:189], v6 offset:14336
    ds_read_b64_tr_b16 v[190:191], v6 offset:14848
    s_mov_b32 s91, 0
    s_cmp_ge_u32 s58, 4
    s_cbranch_scc1 L_eh53
    s_waitcnt vmcnt(0)
    v_cmp_ne_u32 vcc, s76, v216
    v_cmp_ne_u32 s[4:5], s77, v217
    s_nop 0
    s_or_b64 vcc, vcc, s[4:5]
    s_cbranch_vccnz L_eh53
    v_cmp_ne_u32 vcc, s76, v218
    v_cmp_ne_u32 s[4:5], s77, v219
    s_nop 0
    s_or_b64 vcc, vcc, s[4:5]
    s_cbranch_vccnz L_eh53
    buffer_load_dwordx4 v[48:51], v240, s[44:47], s84 offen sc1
    buffer_load_dwordx4 v[52:55], v248, s[44:47], s84 offen sc1
    buffer_load_dwordx4 v[56:59], v241, s[44:47], s86 offen sc1
    buffer_load_dwordx4 v[60:63], v249, s[44:47], s86 offen sc1
    s_add_u32 s84, s84, 512
    s_and_b32 s84, s84, 8191
    s_mul_i32 s86, s84, 57
    s_lshl_b32 s4, s89, 15
    s_lshl_b32 s5, s83, 11
    s_add_u32 s4, s4, s5
    s_add_u32 s5, s58, 1
    s_and_b32 s5, s5, 3
    s_lshl_b32 s5, s5, 9
    s_add_u32 s5, s5, s4
    s_add_u32 s6, s5, 65536
    buffer_load_dwordx4 v[16:19], v250, s[24:27], s5 offen sc1
    buffer_load_dwordx4 v[20:23], v250, s[24:27], s6 offen sc1
    s_add_u32 s5, s58, 2
    s_and_b32 s5, s5, 3
    s_lshl_b32 s5, s5, 9
    s_add_u32 s5, s5, s4
    s_add_u32 s6, s5, 65536
    buffer_load_dwordx4 v[24:27], v250, s[24:27], s5 offen sc1
    buffer_load_dwordx4 v[28:31], v250, s[24:27], s6 offen sc1
    s_add_u32 s5, s58, 3
    s_and_b32 s5, s5, 3
    s_lshl_b32 s5, s5, 9
    s_add_u32 s5, s5, s4
    s_add_u32 s6, s5, 65536
    buffer_load_dwordx4 v[32:35], v250, s[24:27], s5 offen sc1
    buffer_load_dwordx4 v[36:39], v250, s[24:27], s6 offen sc1
    s_add_u32 s5, s58, 4
    s_and_b32 s5, s5, 3
    s_lshl_b32 s5, s5, 9
    s_add_u32 s5, s5, s4
    s_add_u32 s6, s5, 65536
    buffer_load_dwordx4 v[40:43], v250, s[24:27], s5 offen sc1
    buffer_load_dwordx4 v[44:47], v250, s[24:27], s6 offen sc1
    s_lshl_b32 s4, s83, 2
    s_add_u32 s4, s4, s58
    s_lshl_b32 s4, s4, 7
    s_add_u32 s4, s4, 14942208
    v_and_b32 v246, 31, v1
    v_lshlrev_b32 v246, 2, v246
    buffer_load_dword v246, v246, s[24:27], s4 offen sc1
    s_mov_b32 s91, 1
L_eh53:
    s_waitcnt lgkmcnt(6)
    v_mfma_f32_32x32x16_bf16 v[128:143], v[176:179], v[120:123], v[128:143]
    s_waitcnt lgkmcnt(4)
    v_mfma_f32_32x32x16_bf16 v[144:159], v[180:183], v[120:123], v[144:159]
    s_waitcnt lgkmcnt(2)
    v_mfma_f32_32x32x16_bf16 v[128:143], v[184:187], v[124:127], v[128:143]
    s_waitcnt lgkmcnt(0)
    v_mfma_f32_32x32x16_bf16 v[144:159], v[188:191], v[124:127], v[144:159]
    s_branch L_tail
L_D:
    s_lshl_b32 s7, s57, 1
    s_sub_u32 s7, s7, 11
    s_lshl_b32 s66, s7, 7
    s_lshl_b32 s61, s7, 1
    s_lshl_b32 s70, s61, 9
    s_mul_i32 s60, s63, 29184
    s_add_u32 s70, s70, s60
    s_add_u32 s70, s70, 16762880
    s_lshl_b32 s78, s61, 6
    s_add_u32 s78, s78, s63
    s_lshl_b32 s78, s78, 3
    s_add_u32 s78, s78, 15007744
    s_lshl_b32 s7, s57, 1
    s_sub_u32 s7, s7, 10
    s_lshl_b32 s67, s7, 7
    s_lshl_b32 s61, s7, 1
    s_add_u32 s61, s61, s64
    s_lshl_b32 s71, s61, 9
    s_mul_i32 s60, s63, 29184
    s_add_u32 s71, s71, s60
    s_add_u32 s71, s71, 16762880
    s_lshl_b32 s79, s61, 6
    s_add_u32 s79, s79, s63
    s_lshl_b32 s79, s79, 3
    s_add_u32 s79, s79, 15007744
    s_mov_b32 s68, 1792
    s_sub_u32 s61, s57, 13
    s_lshr_b32 s61, s61, 1
    s_add_u32 s61, s61, 28
    s_lshl_b32 s72, s61, 9
    s_mul_i32 s60, s63, 29184
    s_add_u32 s72, s72, s60
    s_add_u32 s72, s72, 16762880
    s_lshl_b32 s80, s61, 6
    s_add_u32 s80, s80, s63
    s_lshl_b32 s80, s80, 3
    s_add_u32 s80, s80, 15007744
    s_lshl_b32 s60, s63, 9
    s_add_u32 s60, s60, 15032768
    s_cmp_ge_u32 s58, 4
    s_cselect_b32 s80, s60, s80
    s_add_u32 s7, s57, 12
    s_lshl_b32 s69, s7, 7
    s_lshl_b32 s61, s7, 1
    s_add_u32 s61, s61, s64
    s_lshl_b32 s73, s61, 11
    s_mul_i32 s60, s63, 147456
    s_add_u32 s73, s73, s60
    s_add_u32 s73, s73, 5505024
    s_lshl_b32 s81, s63, 6
    s_add_u32 s81, s81, s61
    s_lshl_b32 s81, s81, 3
    s_add_u32 s81, s81, 15032320
    s_mov_b32 s53, s73
    s_mov_b32 s54, s81
    s_cmp_ge_u32 s58, 4
    s_cbranch_scc1 L_g0c54
    s_waitcnt vmcnt(6) lgkmcnt(4)
    s_barrier
    v_add_u32 v212, 0, v208
    v_add_u32 v213, 0, v209
    v_add_u32 v214, 0, v210
    v_add_u32 v215, 0, v211
    ds_read_b128 v[16:19], v212
    ds_read_b128 v[20:23], v213
    ds_read_b128 v[24:27], v214
    ds_read_b128 v[28:31], v215
    s_add_u32 m0, s65, 131072
    s_bfe_u32 s61, s75, 0x40008
    s_mul_i32 s61, s61, 172032
    s_add_u32 s61, s61, s66
    buffer_load_dwordx4 v202, s[12:15], s61 offen lds
    s_add_u32 m0, s65, 132096
    s_add_u32 s61, s61, 21504
    buffer_load_dwordx4 v202, s[12:15], s61 offen lds
    s_add_u32 m0, s55, 32768
    s_bfe_u32 s60, s75, 0x40008
    s_mul_i32 s60, s60, 128
    s_add_u32 s60, s60, s62
    buffer_load_dwordx4 v4, s[8:11], s60 offen lds
    s_add_u32 m0, s55, 33792
    s_nop 0
    buffer_load_dwordx4 v5, s[8:11], s60 offen lds
    s_add_u32 m0, s55, 34816
    s_add_u32 s60, s60, 14336
    buffer_load_dwordx4 v4, s[8:11], s60 offen lds
    s_add_u32 m0, s55, 35840
    s_nop 0
    buffer_load_dwordx4 v5, s[8:11], s60 offen lds
    s_add_u32 m0, s65, 139264
    s_bfe_u32 s61, s75, 0x4000c
    s_mul_i32 s61, s61, 172032
    s_add_u32 s61, s61, s66
    buffer_load_dwordx4 v202, s[12:15], s61 offen lds
    s_add_u32 m0, s65, 140288
    s_add_u32 s61, s61, 21504
    buffer_load_dwordx4 v202, s[12:15], s61 offen lds
    s_add_u32 m0, s55, 49152
    s_bfe_u32 s60, s75, 0x4000c
    s_mul_i32 s60, s60, 128
    s_add_u32 s60, s60, s62
    buffer_load_dwordx4 v4, s[8:11], s60 offen lds
    s_add_u32 m0, s55, 50176
    s_nop 0
    buffer_load_dwordx4 v5, s[8:11], s60 offen lds
    s_add_u32 m0, s55, 51200
    s_add_u32 s60, s60, 14336
    buffer_load_dwordx4 v4, s[8:11], s60 offen lds
    s_add_u32 m0, s55, 52224
    s_nop 0
    buffer_load_dwordx4 v5, s[8:11], s60 offen lds
    s_waitcnt vmcnt(12) lgkmcnt(4)
    s_barrier
    v_add_u32 v212, 16384, v208
    v_add_u32 v213, 16384, v209
    v_add_u32 v214, 16384, v210
    v_add_u32 v215, 16384, v211
    ds_read_b128 v[32:35], v212
    ds_read_b128 v[36:39], v213
    ds_read_b128 v[40:43], v214
    ds_read_b128 v[44:47], v215
    s_add_u32 m0, s65, 147456
    s_bfe_u32 s61, s75, 0x40010
    s_mul_i32 s61, s61, 172032
    s_add_u32 s61, s61, s66
    buffer_load_dwordx4 v202, s[12:15], s61 offen lds
    s_add_u32 m0, s65, 148480
    s_add_u32 s61, s61, 21504
    buffer_load_dwordx4 v202, s[12:15], s61 offen lds
    s_add_u32 m0, s55, 65536
    s_bfe_u32 s60, s75, 0x40010
    s_mul_i32 s60, s60, 128
    s_add_u32 s60, s60, s62
    buffer_load_dwordx4 v4, s[8:11], s60 offen lds
    s_add_u32 m0, s55, 66560
    s_nop 0
    buffer_load_dwordx4 v5, s[8:11], s60 offen lds
    s_add_u32 m0, s55, 67584
    s_add_u32 s60, s60, 14336
    buffer_load_dwordx4 v4, s[8:11], s60 offen lds
    s_add_u32 m0, s55, 68608
    s_nop 0
    buffer_load_dwordx4 v5, s[8:11], s60 offen lds
    s_waitcnt vmcnt(12) lgkmcnt(4)
    s_barrier
    v_add_u32 v212, 32768, v208
    v_add_u32 v213, 32768, v209
    v_add_u32 v214, 32768, v210
    v_add_u32 v215, 32768, v211
    ds_read_b128 v[48:51], v212
    ds_read_b128 v[52:55], v213
    ds_read_b128 v[56:59], v214
    ds_read_b128 v[60:63], v215
    s_add_u32 m0, s65, 155648
    s_bfe_u32 s61, s75, 0x40014
    s_mul_i32 s61, s61, 172032
    s_add_u32 s61, s61, s66
    buffer_load_dwordx4 v202, s[12:15], s61 offen lds
    s_add_u32 m0, s65, 156672
    s_add_u32 s61, s61, 21504
    buffer_load_dwordx4 v202, s[12:15], s61 offen lds
    s_add_u32 m0, s55, 81920
    s_bfe_u32 s60, s75, 0x40014
    s_mul_i32 s60, s60, 128
    s_add_u32 s60, s60, s62
    buffer_load_dwordx4 v4, s[8:11], s60 offen lds
    s_add_u32 m0, s55, 82944
    s_nop 0
    buffer_load_dwordx4 v5, s[8:11], s60 offen lds
    s_add_u32 m0, s55, 83968
    s_add_u32 s60, s60, 14336
    buffer_load_dwordx4 v4, s[8:11], s60 offen lds
    s_add_u32 m0, s55, 84992
    s_nop 0
    buffer_load_dwordx4 v5, s[8:11], s60 offen lds
    s_waitcnt vmcnt(12) lgkmcnt(4)
    s_barrier
    v_add_u32 v212, 49152, v208
    v_add_u32 v213, 49152, v209
    v_add_u32 v214, 49152, v210
    v_add_u32 v215, 49152, v211
    ds_read_b128 v[64:67], v212
    ds_read_b128 v[68:71], v213
    ds_read_b128 v[72:75], v214
    ds_read_b128 v[76:79], v215
    s_add_u32 m0, s65, 114688
    s_bfe_u32 s61, s75, 0x40018
    s_mul_i32 s61, s61, 172032
    s_add_u32 s61, s61, s66
    buffer_load_dwordx4 v202, s[12:15], s61 offen lds
    s_add_u32 m0, s65, 115712
    s_add_u32 s61, s61, 21504
    buffer_load_dwordx4 v202, s[12:15], s61 offen lds
    s_add_u32 m0, s55, 98304
    s_bfe_u32 s60, s75, 0x40018
    s_mul_i32 s60, s60, 128
    s_add_u32 s60, s60, s62
    buffer_load_dwordx4 v4, s[8:11], s60 offen lds
    s_add_u32 m0, s55, 99328
    s_nop 0
    buffer_load_dwordx4 v5, s[8:11], s60 offen lds
    s_add_u32 m0, s55, 100352
    s_add_u32 s60, s60, 14336
    buffer_load_dwordx4 v4, s[8:11], s60 offen lds
    s_add_u32 m0, s55, 101376
    s_nop 0
    buffer_load_dwordx4 v5, s[8:11], s60 offen lds
    s_add_u32 m0, s65, 0
    s_bfe_u32 s60, s75, 0x40000
    s_mul_i32 s60, s60, 172032
    s_add_u32 s60, s60, s67
    buffer_load_dwordx4 v202, s[12:15], s60 offen lds
    s_add_u32 m0, s65, 1024
    s_add_u32 s60, s60, 21504
    buffer_load_dwordx4 v202, s[12:15], s60 offen lds
    s_add_u32 m0, s65, 8192
    s_bfe_u32 s60, s75, 0x40004
    s_mul_i32 s60, s60, 172032
    s_add_u32 s60, s60, s67
    buffer_load_dwordx4 v202, s[12:15], s60 offen lds
    s_add_u32 m0, s65, 9216
    s_add_u32 s60, s60, 21504
    buffer_load_dwordx4 v202, s[12:15], s60 offen lds
    s_waitcnt vmcnt(16) lgkmcnt(4)
    s_barrier
    v_add_u32 v212, 65536, v208
    v_add_u32 v213, 65536, v209
    v_add_u32 v214, 65536, v210
    v_add_u32 v215, 65536, v211
    ds_read_b128 v[80:83], v212
    ds_read_b128 v[84:87], v213
    ds_read_b128 v[88:91], v214
    ds_read_b128 v[92:95], v215
    s_add_u32 m0, s65, 122880
    s_bfe_u32 s60, s75, 0x40008
    s_mul_i32 s60, s60, 172032
    s_add_u32 s60, s60, s67
    buffer_load_dwordx4 v202, s[12:15], s60 offen lds
    s_add_u32 m0, s65, 123904
    s_add_u32 s60, s60, 21504
    buffer_load_dwordx4 v202, s[12:15], s60 offen lds
    s_add_u32 m0, s65, 16384
    s_bfe_u32 s60, s75, 0x4000c
    s_mul_i32 s60, s60, 172032
    s_add_u32 s60, s60, s67
    buffer_load_dwordx4 v202, s[12:15], s60 offen lds
    s_add_u32 m0, s65, 17408
    s_add_u32 s60, s60, 21504
    buffer_load_dwordx4 v202, s[12:15], s60 offen lds
    s_waitcnt vmcnt(14) lgkmcnt(4)
    s_barrier
    v_add_u32 v212, 81920, v208
    v_add_u32 v213, 81920, v209
    v_add_u32 v214, 81920, v210
    v_add_u32 v215, 81920, v211
    ds_read_b128 v[96:99], v212
    ds_read_b128 v[100:103], v213
    ds_read_b128 v[104:107], v214
    ds_read_b128 v[108:111], v215
    s_add_u32 m0, s65, 24576
    s_bfe_u32 s60, s75, 0x40010
    s_mul_i32 s60, s60, 172032
    s_add_u32 s60, s60, s67
    buffer_load_dwordx4 v202, s[12:15], s60 offen lds
    s_add_u32 m0, s65, 25600
    s_add_u32 s60, s60, 21504
    buffer_load_dwordx4 v202, s[12:15], s60 offen lds
    s_add_u32 m0, s65, 131072
    s_bfe_u32 s60, s75, 0x40014
    s_mul_i32 s60, s60, 172032
    s_add_u32 s60, s60, s67
    buffer_load_dwordx4 v202, s[12:15], s60 offen lds
    s_add_u32 m0, s65, 132096
    s_add_u32 s60, s60, 21504
    buffer_load_dwordx4 v202, s[12:15], s60 offen lds
    s_waitcnt vmcnt(12) lgkmcnt(4)
    s_barrier
    v_add_u32 v212, 98304, v208
    v_add_u32 v213, 98304, v209
    v_add_u32 v214, 98304, v210
    v_add_u32 v215, 98304, v211
    ds_read_b128 v[112:115], v212
    ds_read_b128 v[116:119], v213
    ds_read_b128 v[120:123], v214
    ds_read_b128 v[124:127], v215
    s_add_u32 m0, s65, 32768
    s_bfe_u32 s60, s75, 0x40018
    s_mul_i32 s60, s60, 172032
    s_add_u32 s60, s60, s67
    buffer_load_dwordx4 v202, s[12:15], s60 offen lds
    s_add_u32 m0, s65, 33792
    s_add_u32 s60, s60, 21504
    buffer_load_dwordx4 v202, s[12:15], s60 offen lds
    s_branch L_g0j55
L_g0c54:
    s_barrier
    v_add_u32 v212, 0, v208
    v_add_u32 v213, 0, v209
    v_add_u32 v214, 0, v210
    v_add_u32 v215, 0, v211
    ds_read_b128 v[16:19], v212
    ds_read_b128 v[20:23], v213
    ds_read_b128 v[24:27], v214
    ds_read_b128 v[28:31], v215
    ds_read_b64_tr_b16 v[216:217], v204 offset:49152
    ds_read_b64_tr_b16 v[218:219], v204 offset:49664
    ds_read_b64_tr_b16 v[220:221], v7 offset:49152
    ds_read_b64_tr_b16 v[222:223], v7 offset:49664
    ds_read_b64_tr_b16 v[224:225], v204 offset:51200
    ds_read_b64_tr_b16 v[226:227], v204 offset:51712
    ds_read_b64_tr_b16 v[228:229], v7 offset:51200
    ds_read_b64_tr_b16 v[230:231], v7 offset:51712
    ds_read_b64_tr_b16 v[232:233], v204 offset:53248
    ds_read_b64_tr_b16 v[234:235], v204 offset:53760
    ds_read_b64_tr_b16 v[236:237], v7 offset:53248
    ds_read_b64_tr_b16 v[238:239], v7 offset:53760
    ds_read_b64_tr_b16 v[240:241], v204 offset:55296
    ds_read_b64_tr_b16 v[242:243], v204 offset:55808
    ds_read_b64_tr_b16 v[244:245], v7 offset:55296
    ds_read_b64_tr_b16 v[246:247], v7 offset:55808
    s_barrier
    v_add_u32 v212, 16384, v208
    v_add_u32 v213, 16384, v209
    v_add_u32 v214, 16384, v210
    v_add_u32 v215, 16384, v211
    s_waitcnt lgkmcnt(14)
    v_mfma_f32_32x32x16_bf16 v[128:143], v[16:19], v[216:219], 0
    ds_read_b128 v[32:35], v212
    ds_read_b128 v[36:39], v213
    ds_read_b128 v[40:43], v214
    s_waitcnt lgkmcnt(15)
    v_mfma_f32_32x32x16_bf16 v[144:159], v[16:19], v[220:223], 0
    ds_read_b128 v[44:47], v215
    ds_read_b64_tr_b16 v[160:161], v204 offset:57344
    ds_read_b64_tr_b16 v[162:163], v204 offset:57856
    s_waitcnt lgkmcnt(15)
    v_mfma_f32_32x32x16_bf16 v[128:143], v[20:23], v[224:227], v[128:143]
    ds_read_b64_tr_b16 v[164:165], v7 offset:57344
    ds_read_b64_tr_b16 v[166:167], v7 offset:57856
    ds_read_b64_tr_b16 v[168:169], v204 offset:59392
    s_waitcnt lgkmcnt(15)
    v_mfma_f32_32x32x16_bf16 v[144:159], v[20:23], v[228:231], v[144:159]
    ds_read_b64_tr_b16 v[170:171], v204 offset:59904
    ds_read_b64_tr_b16 v[172:173], v7 offset:59392
    ds_read_b64_tr_b16 v[174:175], v7 offset:59904
    s_waitcnt lgkmcnt(15)
    v_mfma_f32_32x32x16_bf16 v[128:143], v[24:27], v[232:235], v[128:143]
    ds_read_b64_tr_b16 v[176:177], v204 offset:61440
    ds_read_b64_tr_b16 v[178:179], v204 offset:61952
    s_waitcnt lgkmcnt(15)
    v_mfma_f32_32x32x16_bf16 v[144:159], v[24:27], v[236:239], v[144:159]
    ds_read_b64_tr_b16 v[180:181], v7 offset:61440
    ds_read_b64_tr_b16 v[182:183], v7 offset:61952
    s_waitcnt lgkmcnt(15)
    v_mfma_f32_32x32x16_bf16 v[128:143], v[28:31], v[240:243], v[128:143]
    ds_read_b64_tr_b16 v[184:185], v204 offset:63488
    ds_read_b64_tr_b16 v[186:187], v204 offset:64000
    s_waitcnt lgkmcnt(15)
    v_mfma_f32_32x32x16_bf16 v[144:159], v[28:31], v[244:247], v[144:159]
    ds_read_b64_tr_b16 v[188:189], v7 offset:63488
    ds_read_b64_tr_b16 v[190:191], v7 offset:64000
    s_barrier
    v_add_u32 v212, 32768, v208
    v_add_u32 v213, 32768, v209
    v_add_u32 v214, 32768, v210
    v_add_u32 v215, 32768, v211
    s_waitcnt lgkmcnt(14)
    v_mfma_f32_32x32x16_bf16 v[128:143], v[32:35], v[160:163], v[128:143]
    ds_read_b128 v[48:51], v212
    ds_read_b128 v[52:55], v213
    ds_read_b128 v[56:59], v214
    s_waitcnt lgkmcnt(15)
    v_mfma_f32_32x32x16_bf16 v[144:159], v[32:35], v[164:167], v[144:159]
    ds_read_b128 v[60:63], v215
    ds_read_b64_tr_b16 v[216:217], v205 offset:0
    ds_read_b64_tr_b16 v[218:219], v205 offset:512
    s_waitcnt lgkmcnt(15)
    v_mfma_f32_32x32x16_bf16 v[128:143], v[36:39], v[168:171], v[128:143]
    ds_read_b64_tr_b16 v[220:221], v8 offset:0
    ds_read_b64_tr_b16 v[222:223], v8 offset:512
    ds_read_b64_tr_b16 v[224:225], v205 offset:2048
    s_waitcnt lgkmcnt(15)
    v_mfma_f32_32x32x16_bf16 v[144:159], v[36:39], v[172:175], v[144:159]
    ds_read_b64_tr_b16 v[226:227], v205 offset:2560
    ds_read_b64_tr_b16 v[228:229], v8 offset:2048
    ds_read_b64_tr_b16 v[230:231], v8 offset:2560
    s_waitcnt lgkmcnt(15)
    v_mfma_f32_32x32x16_bf16 v[128:143], v[40:43], v[176:179], v[128:143]
    ds_read_b64_tr_b16 v[232:233], v205 offset:4096
    ds_read_b64_tr_b16 v[234:235], v205 offset:4608
    s_waitcnt lgkmcnt(15)
    v_mfma_f32_32x32x16_bf16 v[144:159], v[40:43], v[180:183], v[144:159]
    ds_read_b64_tr_b16 v[236:237], v8 offset:4096
    ds_read_b64_tr_b16 v[238:239], v8 offset:4608
    s_waitcnt lgkmcnt(15)
    v_mfma_f32_32x32x16_bf16 v[128:143], v[44:47], v[184:187], v[128:143]
    ds_read_b64_tr_b16 v[240:241], v205 offset:6144
    ds_read_b64_tr_b16 v[242:243], v205 offset:6656
    s_waitcnt lgkmcnt(15)
    v_mfma_f32_32x32x16_bf16 v[144:159], v[44:47], v[188:191], v[144:159]
    ds_read_b64_tr_b16 v[244:245], v8 offset:6144
    ds_read_b64_tr_b16 v[246:247], v8 offset:6656
    s_barrier
    v_add_u32 v212, 49152, v208
    v_add_u32 v213, 49152, v209
    v_add_u32 v214, 49152, v210
    v_add_u32 v215, 49152, v211
    s_waitcnt lgkmcnt(14)
    v_mfma_f32_32x32x16_bf16 v[128:143], v[48:51], v[216:219], v[128:143]
    ds_read_b128 v[64:67], v212
    ds_read_b128 v[68:71], v213
    ds_read_b128 v[72:75], v214
    s_waitcnt lgkmcnt(15)
    v_mfma_f32_32x32x16_bf16 v[144:159], v[48:51], v[220:223], v[144:159]
    ds_read_b128 v[76:79], v215
    ds_read_b64_tr_b16 v[160:161], v205 offset:8192
    ds_read_b64_tr_b16 v[162:163], v205 offset:8704
    s_waitcnt lgkmcnt(15)
    v_mfma_f32_32x32x16_bf16 v[128:143], v[52:55], v[224:227], v[128:143]
    ds_read_b64_tr_b16 v[164:165], v8 offset:8192
    ds_read_b64_tr_b16 v[166:167], v8 offset:8704
    ds_read_b64_tr_b16 v[168:169], v205 offset:10240
    s_waitcnt lgkmcnt(15)
    v_mfma_f32_32x32x16_bf16 v[144:159], v[52:55], v[228:231], v[144:159]
    ds_read_b64_tr_b16 v[170:171], v205 offset:10752
    ds_read_b64_tr_b16 v[172:173], v8 offset:10240
    ds_read_b64_tr_b16 v[174:175], v8 offset:10752
    s_waitcnt lgkmcnt(15)
    v_mfma_f32_32x32x16_bf16 v[128:143], v[56:59], v[232:235], v[128:143]
    ds_read_b64_tr_b16 v[176:177], v205 offset:12288
    ds_read_b64_tr_b16 v[178:179], v205 offset:12800
    s_waitcnt lgkmcnt(15)
    v_mfma_f32_32x32x16_bf16 v[144:159], v[56:59], v[236:239], v[144:159]
    ds_read_b64_tr_b16 v[180:181], v8 offset:12288
    ds_read_b64_tr_b16 v[182:183], v8 offset:12800
    s_waitcnt lgkmcnt(15)
    v_mfma_f32_32x32x16_bf16 v[128:143], v[60:63], v[240:243], v[128:143]
    ds_read_b64_tr_b16 v[184:185], v205 offset:14336
    ds_read_b64_tr_b16 v[186:187], v205 offset:14848
    s_waitcnt lgkmcnt(15)
    v_mfma_f32_32x32x16_bf16 v[144:159], v[60:63], v[244:247], v[144:159]
    ds_read_b64_tr_b16 v[188:189], v8 offset:14336
    ds_read_b64_tr_b16 v[190:191], v8 offset:14848
    s_barrier
    v_add_u32 v212, 65536, v208
    v_add_u32 v213, 65536, v209
    v_add_u32 v214, 65536, v210
    v_add_u32 v215, 65536, v211
    s_waitcnt lgkmcnt(14)
    v_mfma_f32_32x32x16_bf16 v[128:143], v[64:67], v[160:163], v[128:143]
    ds_read_b128 v[80:83], v212
    ds_read_b128 v[84:87], v213
    ds_read_b128 v[88:91], v214
    s_waitcnt lgkmcnt(15)
    v_mfma_f32_32x32x16_bf16 v[144:159], v[64:67], v[164:167], v[144:159]
    ds_read_b128 v[92:95], v215
    ds_read_b64_tr_b16 v[216:217], v205 offset:16384
    ds_read_b64_tr_b16 v[218:219], v205 offset:16896
    s_waitcnt lgkmcnt(15)
    v_mfma_f32_32x32x16_bf16 v[128:143], v[68:71], v[168:171], v[128:143]
    ds_read_b64_tr_b16 v[220:221], v8 offset:16384
    ds_read_b64_tr_b16 v[222:223], v8 offset:16896
    ds_read_b64_tr_b16 v[224:225], v205 offset:18432
    s_waitcnt lgkmcnt(15)
    v_mfma_f32_32x32x16_bf16 v[144:159], v[68:71], v[172:175], v[144:159]
    ds_read_b64_tr_b16 v[226:227], v205 offset:18944
    ds_read_b64_tr_b16 v[228:229], v8 offset:18432
    ds_read_b64_tr_b16 v[230:231], v8 offset:18944
    s_waitcnt lgkmcnt(15)
    v_mfma_f32_32x32x16_bf16 v[128:143], v[72:75], v[176:179], v[128:143]
    ds_read_b64_tr_b16 v[232:233], v205 offset:20480
    ds_read_b64_tr_b16 v[234:235], v205 offset:20992
    s_waitcnt lgkmcnt(15)
    v_mfma_f32_32x32x16_bf16 v[144:159], v[72:75], v[180:183], v[144:159]
    ds_read_b64_tr_b16 v[236:237], v8 offset:20480
    ds_read_b64_tr_b16 v[238:239], v8 offset:20992
    s_waitcnt lgkmcnt(15)
    v_mfma_f32_32x32x16_bf16 v[128:143], v[76:79], v[184:187], v[128:143]
    ds_read_b64_tr_b16 v[240:241], v205 offset:22528
    ds_read_b64_tr_b16 v[242:243], v205 offset:23040
    s_waitcnt lgkmcnt(15)
    v_mfma_f32_32x32x16_bf16 v[144:159], v[76:79], v[188:191], v[144:159]
    ds_read_b64_tr_b16 v[244:245], v8 offset:22528
    ds_read_b64_tr_b16 v[246:247], v8 offset:23040
    s_barrier
    v_add_u32 v212, 81920, v208
    v_add_u32 v213, 81920, v209
    v_add_u32 v214, 81920, v210
    v_add_u32 v215, 81920, v211
    s_waitcnt lgkmcnt(14)
    v_mfma_f32_32x32x16_bf16 v[128:143], v[80:83], v[216:219], v[128:143]
    ds_read_b128 v[96:99], v212
    ds_read_b128 v[100:103], v213
    ds_read_b128 v[104:107], v214
    s_waitcnt lgkmcnt(15)
    v_mfma_f32_32x32x16_bf16 v[144:159], v[80:83], v[220:223], v[144:159]
    ds_read_b128 v[108:111], v215
    ds_read_b64_tr_b16 v[160:161], v205 offset:24576
    ds_read_b64_tr_b16 v[162:163], v205 offset:25088
    s_waitcnt lgkmcnt(15)
    v_mfma_f32_32x32x16_bf16 v[128:143], v[84:87], v[224:227], v[128:143]
    ds_read_b64_tr_b16 v[164:165], v8 offset:24576
    ds_read_b64_tr_b16 v[166:167], v8 offset:25088
    ds_read_b64_tr_b16 v[168:169], v205 offset:26624
    s_waitcnt lgkmcnt(15)
    v_mfma_f32_32x32x16_bf16 v[144:159], v[84:87], v[228:231], v[144:159]
    ds_read_b64_tr_b16 v[170:171], v205 offset:27136
    ds_read_b64_tr_b16 v[172:173], v8 offset:26624
    ds_read_b64_tr_b16 v[174:175], v8 offset:27136
    s_waitcnt lgkmcnt(15)
    v_mfma_f32_32x32x16_bf16 v[128:143], v[88:91], v[232:235], v[128:143]
    ds_read_b64_tr_b16 v[176:177], v205 offset:28672
    ds_read_b64_tr_b16 v[178:179], v205 offset:29184
    s_waitcnt lgkmcnt(15)
    v_mfma_f32_32x32x16_bf16 v[144:159], v[88:91], v[236:239], v[144:159]
    ds_read_b64_tr_b16 v[180:181], v8 offset:28672
    ds_read_b64_tr_b16 v[182:183], v8 offset:29184
    s_waitcnt lgkmcnt(15)
    v_mfma_f32_32x32x16_bf16 v[128:143], v[92:95], v[240:243], v[128:143]
    ds_read_b64_tr_b16 v[184:185], v205 offset:30720
    ds_read_b64_tr_b16 v[186:187], v205 offset:31232
    s_waitcnt lgkmcnt(15)
    v_mfma_f32_32x32x16_bf16 v[144:159], v[92:95], v[244:247], v[144:159]
    ds_read_b64_tr_b16 v[188:189], v8 offset:30720
    ds_read_b64_tr_b16 v[190:191], v8 offset:31232
    s_barrier
    v_add_u32 v212, 98304, v208
    v_add_u32 v213, 98304, v209
    v_add_u32 v214, 98304, v210
    v_add_u32 v215, 98304, v211
    s_waitcnt lgkmcnt(14)
    v_mfma_f32_32x32x16_bf16 v[128:143], v[96:99], v[160:163], v[128:143]
    ds_read_b128 v[112:115], v212
    ds_read_b128 v[116:119], v213
    ds_read_b128 v[120:123], v214
    s_waitcnt lgkmcnt(15)
    v_mfma_f32_32x32x16_bf16 v[144:159], v[96:99], v[164:167], v[144:159]
    ds_read_b128 v[124:127], v215
    ds_read_b64_tr_b16 v[216:217], v204 offset:49152
    ds_read_b64_tr_b16 v[218:219], v204 offset:49664
    s_waitcnt lgkmcnt(15)
    v_mfma_f32_32x32x16_bf16 v[128:143], v[100:103], v[168:171], v[128:143]
    ds_read_b64_tr_b16 v[220:221], v7 offset:49152
    ds_read_b64_tr_b16 v[222:223], v7 offset:49664
    ds_read_b64_tr_b16 v[224:225], v204 offset:51200
    s_waitcnt lgkmcnt(15)
    v_mfma_f32_32x32x16_bf16 v[144:159], v[100:103], v[172:175], v[144:159]
    ds_read_b64_tr_b16 v[226:227], v204 offset:51712
    ds_read_b64_tr_b16 v[228:229], v7 offset:51200
    ds_read_b64_tr_b16 v[230:231], v7 offset:51712
    s_waitcnt lgkmcnt(15)
    v_mfma_f32_32x32x16_bf16 v[128:143], v[104:107], v[176:179], v[128:143]
    ds_read_b64_tr_b16 v[232:233], v204 offset:53248
    ds_read_b64_tr_b16 v[234:235], v204 offset:53760
    s_waitcnt lgkmcnt(15)
    v_mfma_f32_32x32x16_bf16 v[144:159], v[104:107], v[180:183], v[144:159]
    ds_read_b64_tr_b16 v[236:237], v7 offset:53248
    ds_read_b64_tr_b16 v[238:239], v7 offset:53760
    s_waitcnt lgkmcnt(15)
    v_mfma_f32_32x32x16_bf16 v[128:143], v[108:111], v[184:187], v[128:143]
    ds_read_b64_tr_b16 v[240:241], v204 offset:55296
    ds_read_b64_tr_b16 v[242:243], v204 offset:55808
    s_waitcnt lgkmcnt(15)
    v_mfma_f32_32x32x16_bf16 v[144:159], v[108:111], v[188:191], v[144:159]
    ds_read_b64_tr_b16 v[244:245], v7 offset:55296
    ds_read_b64_tr_b16 v[246:247], v7 offset:55808
L_g0j55:
    s_cmp_ge_u32 s58, 4
    s_cbranch_scc1 L_vw56
    s_waitcnt vmcnt(10)
L_vw56:
    s_barrier
    buffer_load_dword v200, v14, s[48:51], 0 offen sc1
    ds_read_b64_tr_b16 v[160:161], v6 offset:0
    ds_read_b64_tr_b16 v[162:163], v6 offset:512
    s_add_u32 m0, s59, 40960
    s_bfe_u32 s60, s75, 0x40000
    s_mul_i32 s60, s60, 172032
    s_add_u32 s60, s60, s68
    buffer_load_dwordx4 v2, s[12:15], s60 offen lds
    ds_read_b64_tr_b16 v[164:165], v6 offset:2048
    ds_read_b64_tr_b16 v[166:167], v6 offset:2560
    ds_read_b64_tr_b16 v[168:169], v6 offset:4096
    ds_read_b64_tr_b16 v[170:171], v6 offset:4608
    ds_read_b64_tr_b16 v[172:173], v6 offset:6144
    ds_read_b64_tr_b16 v[174:175], v6 offset:6656
    s_cmp_ge_u32 s58, 4
    s_cbranch_scc1 L_e058
    v_lshrrev_b32 v204, 5, v1
    v_and_b32 v205, 31, v1
    s_and_b32 s60, s2, 7
    s_lshr_b32 s61, s2, 3
    s_and_b32 s82, s61, 1
    s_lshl_b32 s82, s82, 3
    s_add_u32 s82, s82, s60
    s_lshr_b32 s83, s61, 1
    s_mul_i32 s89, s82, 7
    s_lshr_b32 s89, s89, 1
    v_lshlrev_b32 v240, 4, v205
    v_lshl_add_u32 v240, v204, 15, v240
    s_mul_i32 s60, s82, 448
    v_add_u32 v241, s60, v10
    s_mov_b32 s87, 0x4e800000
    s_add_u32 s4, s89, 56
    s_lshl_b32 s4, s4, 15
    s_lshl_b32 s5, s58, 13
    s_add_u32 s4, s4, s5
    s_mov_b32 s85, s4
    v_add_u32 v248, s4, v240
    v_mov_b32 v250, v240
    v_mov_b32 v240, v248
    v_add_u32 v248, 65536, v248
    v_add_u32 v249, 14336, v241
    v_lshlrev_b32 v206, 4, v205
    v_add_u32 v206, 28224, v206
    v_cmp_gt_u32 vcc, 28, v205
    s_nop 1
    v_cndmask_b32 v241, v206, v241, vcc
    v_cndmask_b32 v249, v206, v249, vcc
    s_mul_i32 s4, s58, 466944
    s_add_u32 s4, s4, 16777216
    v_add_u32 v241, s4, v241
    v_add_u32 v249, s4, v249
    s_lshl_b32 s84, s83, 9
    s_mul_i32 s86, s84, 57
    s_and_b32 s60, s82, 1
    v_cmp_le_u32 vcc, s60, v204
    s_nop 1
    v_cndmask_b32 v244, 0, -1, vcc
    v_cmp_ge_u32 vcc, s60, v204
    s_nop 1
    v_cndmask_b32 v245, 0, -1, vcc
    s_add_u32 s4, s89, 56
    s_lshr_b32 s4, s4, 2
    s_add_u32 s5, s89, 59
    s_lshr_b32 s5, s5, 2
    s_mul_i32 s6, s82, 28
    s_add_u32 s7, s6, 27
    s_lshr_b32 s6, s6, 5
    s_lshr_b32 s7, s7, 5
    s_add_u32 s6, s6, 28
    s_add_u32 s7, s7, 28
    v_mov_b32 v242, s7
    v_mov_b32 v206, s6
    v_cmp_gt_u32 vcc, 48, v1
    s_nop 1
    v_cndmask_b32 v242, v242, v206, vcc
    v_mov_b32 v206, s5
    v_cmp_gt_u32 vcc, 32, v1
    s_nop 1
    v_cndmask_b32 v242, v242, v206, vcc
    v_mov_b32 v206, s4
    v_cmp_gt_u32 vcc, 16, v1
    s_nop 1
    v_cndmask_b32 v242, v242, v206, vcc
    v_and_b32 v206, 15, v1
    v_lshl_add_u32 v242, v242, 6, v206
    s_lshl_b32 s4, s58, 4
    v_add_u32 v242, s4, v242
    v_lshlrev_b32 v242, 3, v242
    s_lshr_b32 s4, s89, 2
    s_add_u32 s5, s89, 3
    s_lshr_b32 s5, s5, 2
    s_lshl_b32 s6, s83, 2
    v_and_b32 v206, 3, v1
    v_add_u32 v206, s6, v206
    v_mov_b32 v243, s5
    v_mov_b32 v12, s4
    v_cmp_gt_u32 vcc, 4, v1
    s_nop 1
    v_cndmask_b32 v243, v243, v12, vcc
    v_lshl_add_u32 v243, v243, 6, v206
    v_lshlrev_b32 v243, 3, v243
    v_lshlrev_b32 v206, 9, v206
    v_add_u32 v206, 25024, v206
    v_cmp_gt_u32 vcc, 8, v1
    s_nop 1
    v_cndmask_b32 v243, v206, v243, vcc
    s_branch L_e057
L_e058:
    s_waitcnt lgkmcnt(15)
    v_mfma_f32_32x32x16_bf16 v[128:143], v[112:115], v[216:219], v[128:143]
    s_waitcnt lgkmcnt(15)
    v_mfma_f32_32x32x16_bf16 v[144:159], v[112:115], v[220:223], v[144:159]
    s_waitcnt lgkmcnt(15)
    v_mfma_f32_32x32x16_bf16 v[128:143], v[116:119], v[224:227], v[128:143]
    s_waitcnt lgkmcnt(15)
    v_mfma_f32_32x32x16_bf16 v[144:159], v[116:119], v[228:231], v[144:159]
    s_waitcnt lgkmcnt(14)
    v_mfma_f32_32x32x16_bf16 v[128:143], v[120:123], v[232:235], v[128:143]
    s_waitcnt lgkmcnt(12)
    v_mfma_f32_32x32x16_bf16 v[144:159], v[120:123], v[236:239], v[144:159]
    s_waitcnt lgkmcnt(10)
    v_mfma_f32_32x32x16_bf16 v[128:143], v[124:127], v[240:243], v[128:143]
    s_waitcnt lgkmcnt(8)
    v_mfma_f32_32x32x16_bf16 v[144:159], v[124:127], v[244:247], v[144:159]
    s_nop 9
    v_cvt_pk_bf16_f32 v192, v128, v129
    v_cvt_pk_bf16_f32 v193, v130, v131
    v_cvt_pk_bf16_f32 v194, v132, v133
    v_cvt_pk_bf16_f32 v195, v134, v135
    buffer_store_dwordx4 v[192:195], v10, s[24:27], s70 offen sc1
    v_cvt_pk_bf16_f32 v196, v136, v137
    v_cvt_pk_bf16_f32 v197, v138, v139
    v_cvt_pk_bf16_f32 v198, v140, v141
    v_cvt_pk_bf16_f32 v199, v142, v143
    s_add_u32 s60, s70, 14336
    buffer_store_dwordx4 v[196:199], v10, s[24:27], s60 offen sc1
    v_cmp_gt_u32 vcc, 4, v1
    v_mov_b32 v12, 0x3f803f80
    v_lshlrev_b32 v207, 2, v1
    s_mul_i32 s60, s63, 29184
    v_cndmask_b32 v12, 0, v12, vcc
    s_add_u32 s60, s60, 16805888
    s_mov_b64 exec, 0xffff
    buffer_store_dword v12, v207, s[24:27], s60 offen sc1
    s_mov_b64 exec, -1
    s_add_u32 s70, s70, 512
    v_cvt_pk_bf16_f32 v192, v144, v145
    v_cvt_pk_bf16_f32 v193, v146, v147
    v_cvt_pk_bf16_f32 v194, v148, v149
    v_cvt_pk_bf16_f32 v195, v150, v151
    buffer_store_dwordx4 v[192:195], v10, s[24:27], s70 offen sc1
    v_cvt_pk_bf16_f32 v196, v152, v153
    v_cvt_pk_bf16_f32 v197, v154, v155
    v_cvt_pk_bf16_f32 v198, v156, v157
    v_cvt_pk_bf16_f32 v199, v158, v159
    s_add_u32 s60, s70, 14336
    buffer_store_dwordx4 v[196:199], v10, s[24:27], s60 offen sc1
    v_cmp_gt_u32 vcc, 4, v1
    v_mov_b32 v12, 0x3f803f80
    v_lshlrev_b32 v207, 2, v1
    s_mul_i32 s60, s63, 29184
    v_cndmask_b32 v12, 0, v12, vcc
    s_add_u32 s60, s60, 16805888
    s_mov_b64 exec, 0xffff
    buffer_store_dword v12, v207, s[24:27], s60 offen sc1
    s_mov_b64 exec, -1
L_e057:
    s_waitcnt lgkmcnt(6)
    v_mfma_f32_32x32x16_bf16 v[128:143], v[16:19], v[160:163], 0
    ds_read_b64_tr_b16 v[176:177], v6 offset:8192
    ds_read_b64_tr_b16 v[178:179], v6 offset:8704
    s_waitcnt lgkmcnt(6)
    v_mfma_f32_32x32x16_bf16 v[128:143], v[20:23], v[164:167], v[128:143]
    s_add_u32 m0, s59, 139264
    s_bfe_u32 s60, s75, 0x40004
    s_mul_i32 s60, s60, 172032
    s_add_u32 s60, s60, s68
    buffer_load_dwordx4 v2, s[12:15], s60 offen lds
    ds_read_b64_tr_b16 v[180:181], v6 offset:10240
    ds_read_b64_tr_b16 v[182:183], v6 offset:10752
    s_waitcnt lgkmcnt(6)
    v_mfma_f32_32x32x16_bf16 v[128:143], v[24:27], v[168:171], v[128:143]
    ds_read_b64_tr_b16 v[184:185], v6 offset:12288
    ds_read_b64_tr_b16 v[186:187], v6 offset:12800
    s_waitcnt lgkmcnt(6)
    v_mfma_f32_32x32x16_bf16 v[128:143], v[28:31], v[172:175], v[128:143]
    ds_read_b64_tr_b16 v[188:189], v6 offset:14336
    ds_read_b64_tr_b16 v[190:191], v6 offset:14848
    s_waitcnt lgkmcnt(6)
    v_mfma_f32_32x32x16_bf16 v[128:143], v[32:35], v[176:179], v[128:143]
    s_cmp_ge_u32 s58, 4
    s_cbranch_scc1 L_vw59
    s_waitcnt vmcnt(9)
L_vw59:
    s_barrier
    ds_read_b64_tr_b16 v[160:161], v7 offset:57344
    ds_read_b64_tr_b16 v[162:163], v7 offset:57856
    s_waitcnt lgkmcnt(6)
    v_mfma_f32_32x32x16_bf16 v[128:143], v[36:39], v[180:183], v[128:143]
    s_add_u32 m0, s59, 49152
    s_bfe_u32 s60, s75, 0x40008
    s_mul_i32 s60, s60, 172032
    s_add_u32 s60, s60, s68
    buffer_load_dwordx4 v2, s[12:15], s60 offen lds
    ds_read_b64_tr_b16 v[164:165], v7 offset:59392
    ds_read_b64_tr_b16 v[166:167], v7 offset:59904
    s_waitcnt lgkmcnt(6)
    v_mfma_f32_32x32x16_bf16 v[128:143], v[40:43], v[184:187], v[128:143]
    ds_read_b64_tr_b16 v[168:169], v7 offset:61440
    ds_read_b64_tr_b16 v[170:171], v7 offset:61952
    s_waitcnt lgkmcnt(6)
    v_mfma_f32_32x32x16_bf16 v[128:143], v[44:47], v[188:191], v[128:143]
    ds_read_b64_tr_b16 v[172:173], v7 offset:63488
    ds_read_b64_tr_b16 v[174:175], v7 offset:64000
    s_waitcnt lgkmcnt(6)
    v_mfma_f32_32x32x16_bf16 v[128:143], v[48:51], v[160:163], v[128:143]
    ds_read_b64_tr_b16 v[176:177], v6 offset:16384
    ds_read_b64_tr_b16 v[178:179], v6 offset:16896
    s_waitcnt lgkmcnt(6)
    v_mfma_f32_32x32x16_bf16 v[128:143], v[52:55], v[164:167], v[128:143]
    s_add_u32 m0, s59, 57344
    s_bfe_u32 s60, s75, 0x4000c
    s_mul_i32 s60, s60, 172032
    s_add_u32 s60, s60, s68
    buffer_load_dwordx4 v2, s[12:15], s60 offen lds
    ds_read_b64_tr_b16 v[180:181], v6 offset:18432
    ds_read_b64_tr_b16 v[182:183], v6 offset:18944
    s_waitcnt lgkmcnt(6)
    v_mfma_f32_32x32x16_bf16 v[128:143], v[56:59], v[168:171], v[128:143]
    ds_read_b64_tr_b16 v[184:185], v6 offset:20480
    ds_read_b64_tr_b16 v[186:187], v6 offset:20992
    s_waitcnt lgkmcnt(6)
    v_mfma_f32_32x32x16_bf16 v[128:143], v[60:63], v[172:175], v[128:143]
    ds_read_b64_tr_b16 v[188:189], v6 offset:22528
    ds_read_b64_tr_b16 v[190:191], v6 offset:23040
    s_waitcnt lgkmcnt(6)
    v_mfma_f32_32x32x16_bf16 v[128:143], v[64:67], v[176:179], v[128:143]
    s_cmp_ge_u32 s58, 4
    s_cbranch_scc1 L_vw60
    s_waitcnt vmcnt(7)
L_vw60:
    s_barrier
    ds_read_b64_tr_b16 v[160:161], v6 offset:24576
    ds_read_b64_tr_b16 v[162:163], v6 offset:25088
    s_waitcnt lgkmcnt(6)
    v_mfma_f32_32x32x16_bf16 v[128:143], v[68:71], v[180:183], v[128:143]
    s_add_u32 m0, s59, 147456
    s_bfe_u32 s60, s75, 0x40010
    s_mul_i32 s60, s60, 172032
    s_add_u32 s60, s60, s68
    buffer_load_dwordx4 v2, s[12:15], s60 offen lds
    ds_read_b64_tr_b16 v[164:165], v6 offset:26624
    ds_read_b64_tr_b16 v[166:167], v6 offset:27136
    s_waitcnt lgkmcnt(6)
    v_mfma_f32_32x32x16_bf16 v[128:143], v[72:75], v[184:187], v[128:143]
    ds_read_b64_tr_b16 v[168:169], v6 offset:28672
    ds_read_b64_tr_b16 v[170:171], v6 offset:29184
    s_waitcnt lgkmcnt(6)
    v_mfma_f32_32x32x16_bf16 v[128:143], v[76:79], v[188:191], v[128:143]
    ds_read_b64_tr_b16 v[172:173], v6 offset:30720
    ds_read_b64_tr_b16 v[174:175], v6 offset:31232
    s_waitcnt lgkmcnt(6)
    v_mfma_f32_32x32x16_bf16 v[128:143], v[80:83], v[160:163], v[128:143]
    ds_read_b64_tr_b16 v[176:177], v8 offset:0
    ds_read_b64_tr_b16 v[178:179], v8 offset:512
    s_waitcnt lgkmcnt(6)
    v_mfma_f32_32x32x16_bf16 v[128:143], v[84:87], v[164:167], v[128:143]
    s_add_u32 m0, s59, 65536
    s_bfe_u32 s60, s75, 0x40014
    s_mul_i32 s60, s60, 172032
    s_add_u32 s60, s60, s68
    buffer_load_dwordx4 v2, s[12:15], s60 offen lds
    ds_read_b64_tr_b16 v[180:181], v8 offset:2048
    ds_read_b64_tr_b16 v[182:183], v8 offset:2560
    s_waitcnt lgkmcnt(6)
    v_mfma_f32_32x32x16_bf16 v[128:143], v[88:91], v[168:171], v[128:143]
    ds_read_b64_tr_b16 v[184:185], v8 offset:4096
    ds_read_b64_tr_b16 v[186:187], v8 offset:4608
    s_waitcnt lgkmcnt(6)
    v_mfma_f32_32x32x16_bf16 v[128:143], v[92:95], v[172:175], v[128:143]
    ds_read_b64_tr_b16 v[188:189], v8 offset:6144
    ds_read_b64_tr_b16 v[190:191], v8 offset:6656
    s_waitcnt lgkmcnt(6)
    v_mfma_f32_32x32x16_bf16 v[128:143], v[96:99], v[176:179], v[128:143]
    s_waitcnt vmcnt(5)
    s_barrier
    s_add_u32 m0, s59, 73728
    s_bfe_u32 s60, s75, 0x40018
    s_mul_i32 s60, s60, 172032
    s_add_u32 s60, s60, s68
    buffer_load_dwordx4 v2, s[12:15], s60 offen lds
    s_add_u32 m0, s59, 155648
    s_bfe_u32 s96, s75, 0x40000
    s_mul_i32 s96, s96, 229376
    s_add_u32 s96, s96, s69
    buffer_load_dwordx4 v3, s[16:19], s96 offen lds
    s_add_u32 m0, s59, 81920
    s_nop 0
    buffer_load_dwordx4 v3, s[20:23], s96 offen lds
    v_readfirstlane_b32 s76, v200
    s_nop 0
    s_cmp_lg_u32 s76, 0
    s_cbranch_scc1 L_tagok61
    s_mov_b32 s52, 0x8000
L_tagspin62:
    buffer_load_dword v200, v14, s[48:51], 0 offen sc1
    s_waitcnt vmcnt(0)
    v_readfirstlane_b32 s76, v200
    s_nop 0
    s_cmp_lg_u32 s76, 0
    s_cbranch_scc1 L_tagok61
    s_sleep 2
    s_sub_u32 s52, s52, 1
    s_cmp_lg_u32 s52, 0
    s_cbranch_scc1 L_tagspin62
L_tagok61:
    s_xor_b32 s77, s76, 0x5bd1e995
    v_mov_b32 v222, s76
    v_mov_b32 v223, s77
    s_cmp_lt_u32 s58, 4
    s_cbranch_scc1 L_p063
    s_add_u32 s60, s78, 512
    s_mov_b64 exec, 1
    buffer_store_dwordx2 v[222:223], v14, s[24:27], s78 offen sc1
    s_mov_b64 exec, -1
    s_mov_b64 exec, 1
    buffer_store_dwordx2 v[222:223], v14, s[24:27], s60 offen sc1
    s_mov_b64 exec, -1
L_p063:
    s_cmp_lt_u32 s58, 4
    s_cbranch_scc1 L_rdone64
    v_lshrrev_b32 v204, 5, v1
    v_and_b32 v205, 31, v1
    s_and_b32 s60, s2, 7
    s_lshr_b32 s61, s2, 3
    s_mul_i32 s82, s61, 37
    s_lshr_b32 s82, s82, 8
    s_mul_i32 s83, s82, 7
    s_sub_u32 s83, s61, s83
    s_lshl_b32 s60, s60, 2
    s_add_u32 s82, s82, s60
    s_and_b32 s60, s58, 3
    s_mul_i32 s87, s60, 26624
    v_lshrrev_b32 v206, 3, v1
    v_mul_u32_u24 v240, 896, v206
    v_and_b32 v206, 7, v1
    v_bfe_u32 v12, v1, 4, 1
    v_lshlrev_b32 v12, 2, v12
    v_xor_b32 v206, v206, v12
    v_lshl_add_u32 v240, v206, 4, v240
    v_bfe_u32 v206, v1, 2, 2
    v_lshl_add_u32 v12, v204, 2, v206
    v_lshlrev_b32 v242, 7, v12
    v_lshrrev_b32 v206, 1, v206
    v_lshl_add_u32 v242, v206, 6, v242
    v_bfe_u32 v206, v1, 4, 1
    v_lshl_add_u32 v242, v206, 5, v242
    v_and_b32 v206, 3, v1
    v_lshl_add_u32 v242, v206, 3, v242
    v_xor_b32 v243, 64, v242
    v_add_u32 v242, s87, v242
    v_add_u32 v243, s87, v243
    s_and_b32 s4, s82, 3
    s_lshl_b32 s4, s4, 1
    s_add_u32 s6, s4, s83
    s_cmp_ge_u32 s6, 7
    s_cselect_b32 s4, 7, 0
    s_sub_u32 s6, s6, s4
    s_lshl_b32 s6, s6, 2
    s_mov_b32 s4, 0x6543210
    s_mov_b32 s5, 0x654321
    s_lshr_b64 s[4:5], s[4:5], s6
    s_mov_b32 s88, s4
    s_mul_i32 s4, s60, 14
    v_add_u32 v206, s4, v205
    v_cmp_gt_u32 vcc, 14, v205
    s_nop 1
    v_cndmask_b32 v206, 56, v206, vcc
    s_lshl_b32 s5, s82, 1
    v_add_u32 v12, s5, v204
    v_lshl_add_u32 v244, v12, 6, v206
    v_lshlrev_b32 v244, 3, v244
    v_add_u32 v244, 24576, v244
    s_lshl_b32 s4, s60, 2
    v_and_b32 v206, 3, v1
    v_add_u32 v206, s4, v206
    v_lshl_add_u32 v245, v12, 4, v206
    v_lshlrev_b32 v245, 3, v245
    v_add_u32 v245, 57344, v245
L_rdone64:
    ds_read_b64_tr_b16 v[160:161], v6 offset:32768
    ds_read_b64_tr_b16 v[162:163], v6 offset:33280
    s_waitcnt lgkmcnt(6)
    v_mfma_f32_32x32x16_bf16 v[128:143], v[100:103], v[180:183], v[128:143]
    ds_read_b64_tr_b16 v[164:165], v6 offset:34816
    ds_read_b64_tr_b16 v[166:167], v6 offset:35328
    s_waitcnt lgkmcnt(6)
    v_mfma_f32_32x32x16_bf16 v[128:143], v[104:107], v[184:187], v[128:143]
    ds_read_b64_tr_b16 v[168:169], v6 offset:36864
    ds_read_b64_tr_b16 v[170:171], v6 offset:37376
    s_waitcnt lgkmcnt(6)
    v_mfma_f32_32x32x16_bf16 v[128:143], v[108:111], v[188:191], v[128:143]
    ds_read_b64_tr_b16 v[172:173], v6 offset:38912
    ds_read_b64_tr_b16 v[174:175], v6 offset:39424
    s_waitcnt lgkmcnt(6)
    v_mfma_f32_32x32x16_bf16 v[128:143], v[112:115], v[160:163], v[128:143]
    s_waitcnt lgkmcnt(4)
    v_mfma_f32_32x32x16_bf16 v[128:143], v[116:119], v[164:167], v[128:143]
    s_waitcnt lgkmcnt(2)
    v_mfma_f32_32x32x16_bf16 v[128:143], v[120:123], v[168:171], v[128:143]
    s_waitcnt lgkmcnt(0)
    v_mfma_f32_32x32x16_bf16 v[128:143], v[124:127], v[172:175], v[128:143]
    s_sub_u32 s60, s57, 13
    s_lshl_b32 s60, s60, 5
    v_xor_b32 v212, s60, v6
    v_xor_b32 v213, s60, v7
    v_xor_b32 v214, s60, v8
    s_cmp_ge_u32 s58, 4
    s_cbranch_scc1 L_sh65
    s_waitcnt vmcnt(7)
    s_barrier
    s_add_u32 m0, s59, 90112
    s_bfe_u32 s96, s75, 0x40004
    s_mul_i32 s96, s96, 229376
    s_add_u32 s96, s96, s69
    buffer_load_dwordx4 v3, s[16:19], s96 offen lds
    s_add_u32 m0, s59, 114688
    s_nop 0
    buffer_load_dwordx4 v3, s[20:23], s96 offen lds
    ds_read_b64_tr_b16 v[176:177], v212 offset:40960
    ds_read_b64_tr_b16 v[178:179], v212 offset:41472
    ds_read_b64_tr_b16 v[180:181], v212 offset:43008
    ds_read_b64_tr_b16 v[182:183], v212 offset:43520
    ds_read_b64_tr_b16 v[184:185], v212 offset:45056
    ds_read_b64_tr_b16 v[186:187], v212 offset:45568
    ds_read_b64_tr_b16 v[188:189], v212 offset:47104
    ds_read_b64_tr_b16 v[190:191], v212 offset:47616
    v_cvt_pk_bf16_f32 v192, v128, v129
    v_cvt_pk_bf16_f32 v193, v130, v131
    v_cvt_pk_bf16_f32 v194, v132, v133
    v_cvt_pk_bf16_f32 v195, v134, v135
    buffer_store_dwordx4 v[192:195], v10, s[24:27], s71 offen sc1
    v_cvt_pk_bf16_f32 v196, v136, v137
    v_cvt_pk_bf16_f32 v197, v138, v139
    v_cvt_pk_bf16_f32 v198, v140, v141
    v_cvt_pk_bf16_f32 v199, v142, v143
    s_add_u32 s60, s71, 14336
    buffer_store_dwordx4 v[196:199], v10, s[24:27], s60 offen sc1
    v_cmp_gt_u32 vcc, 4, v1
    v_mov_b32 v12, 0x3f803f80
    v_lshlrev_b32 v207, 2, v1
    s_mul_i32 s60, s63, 29184
    v_cndmask_b32 v12, 0, v12, vcc
    s_add_u32 s60, s60, 16805888
    s_mov_b64 exec, 0xffff
    buffer_store_dword v12, v207, s[24:27], s60 offen sc1
    s_mov_b64 exec, -1
    s_waitcnt lgkmcnt(6)
    v_mfma_f32_32x32x16_bf16 v[128:143], v[16:19], v[176:179], 0
    ds_read_b64_tr_b16 v[160:161], v214 offset:8192
    ds_read_b64_tr_b16 v[162:163], v214 offset:8704
    s_waitcnt lgkmcnt(6)
    v_mfma_f32_32x32x16_bf16 v[128:143], v[20:23], v[180:183], v[128:143]
    ds_read_b64_tr_b16 v[164:165], v214 offset:10240
    ds_read_b64_tr_b16 v[166:167], v214 offset:10752
    s_waitcnt lgkmcnt(6)
    v_mfma_f32_32x32x16_bf16 v[128:143], v[24:27], v[184:187], v[128:143]
    ds_read_b64_tr_b16 v[168:169], v214 offset:12288
    ds_read_b64_tr_b16 v[170:171], v214 offset:12800
    s_waitcnt lgkmcnt(6)
    v_mfma_f32_32x32x16_bf16 v[128:143], v[28:31], v[188:191], v[128:143]
    ds_read_b64_tr_b16 v[172:173], v214 offset:14336
    ds_read_b64_tr_b16 v[174:175], v214 offset:14848
    s_waitcnt lgkmcnt(6)
    v_mfma_f32_32x32x16_bf16 v[128:143], v[32:35], v[160:163], v[128:143]
    s_waitcnt vmcnt(10)
    s_barrier
    s_add_u32 m0, s59, 98304
    s_bfe_u32 s96, s75, 0x40008
    s_mul_i32 s96, s96, 229376
    s_add_u32 s96, s96, s69
    buffer_load_dwordx4 v3, s[16:19], s96 offen lds
    s_add_u32 m0, s59, 106496
    s_nop 0
    buffer_load_dwordx4 v3, s[20:23], s96 offen lds
    s_lshl_b32 s60, s2, 13
    v_lshlrev_b32 v192, 7, v1
    s_cmp_lg_u32 s58, 0
    s_cbranch_scc1 L_pwn68
    buffer_load_dword v203, v192, s[28:31], s60 offen
L_pwn68:
    s_cmp_lg_u32 s58, 1
    s_cbranch_scc1 L_pwn69
    buffer_load_dword v203, v192, s[32:35], s60 offen
L_pwn69:
    ds_read_b64_tr_b16 v[176:177], v212 offset:49152
    ds_read_b64_tr_b16 v[178:179], v212 offset:49664
    s_waitcnt lgkmcnt(6)
    v_mfma_f32_32x32x16_bf16 v[128:143], v[36:39], v[164:167], v[128:143]
    ds_read_b64_tr_b16 v[180:181], v212 offset:51200
    ds_read_b64_tr_b16 v[182:183], v212 offset:51712
    s_waitcnt lgkmcnt(6)
    v_mfma_f32_32x32x16_bf16 v[128:143], v[40:43], v[168:171], v[128:143]
    ds_read_b64_tr_b16 v[184:185], v212 offset:53248
    ds_read_b64_tr_b16 v[186:187], v212 offset:53760
    s_waitcnt lgkmcnt(6)
    v_mfma_f32_32x32x16_bf16 v[128:143], v[44:47], v[172:175], v[128:143]
    ds_read_b64_tr_b16 v[188:189], v212 offset:55296
    ds_read_b64_tr_b16 v[190:191], v212 offset:55808
    s_waitcnt lgkmcnt(6)
    v_mfma_f32_32x32x16_bf16 v[128:143], v[48:51], v[176:179], v[128:143]
    ds_read_b64_tr_b16 v[160:161], v212 offset:57344
    ds_read_b64_tr_b16 v[162:163], v212 offset:57856
    s_waitcnt lgkmcnt(6)
    v_mfma_f32_32x32x16_bf16 v[128:143], v[52:55], v[180:183], v[128:143]
    ds_read_b64_tr_b16 v[164:165], v212 offset:59392
    ds_read_b64_tr_b16 v[166:167], v212 offset:59904
    s_waitcnt lgkmcnt(6)
    v_mfma_f32_32x32x16_bf16 v[128:143], v[56:59], v[184:187], v[128:143]
    ds_read_b64_tr_b16 v[168:169], v212 offset:61440
    ds_read_b64_tr_b16 v[170:171], v212 offset:61952
    s_waitcnt lgkmcnt(6)
    v_mfma_f32_32x32x16_bf16 v[128:143], v[60:63], v[188:191], v[128:143]
    ds_read_b64_tr_b16 v[172:173], v212 offset:63488
    ds_read_b64_tr_b16 v[174:175], v212 offset:64000
    s_waitcnt lgkmcnt(6)
    v_mfma_f32_32x32x16_bf16 v[128:143], v[64:67], v[160:163], v[128:143]
    s_waitcnt vmcnt(10)
    s_barrier
    s_add_u32 m0, s59, 0
    s_bfe_u32 s96, s75, 0x4000c
    s_mul_i32 s96, s96, 229376
    s_add_u32 s96, s96, s69
    buffer_load_dwordx4 v3, s[16:19], s96 offen lds
    s_add_u32 m0, s59, 8192
    s_nop 0
    buffer_load_dwordx4 v3, s[20:23], s96 offen lds
    ds_read_b64_tr_b16 v[176:177], v214 offset:16384
    ds_read_b64_tr_b16 v[178:179], v214 offset:16896
    s_waitcnt lgkmcnt(6)
    v_mfma_f32_32x32x16_bf16 v[128:143], v[68:71], v[164:167], v[128:143]
    ds_read_b64_tr_b16 v[180:181], v214 offset:18432
    ds_read_b64_tr_b16 v[182:183], v214 offset:18944
    s_waitcnt lgkmcnt(6)
    v_mfma_f32_32x32x16_bf16 v[128:143], v[72:75], v[168:171], v[128:143]
    ds_read_b64_tr_b16 v[184:185], v214 offset:20480
    ds_read_b64_tr_b16 v[186:187], v214 offset:20992
    s_waitcnt lgkmcnt(6)
    v_mfma_f32_32x32x16_bf16 v[128:143], v[76:79], v[172:175], v[128:143]
    ds_read_b64_tr_b16 v[188:189], v214 offset:22528
    ds_read_b64_tr_b16 v[190:191], v214 offset:23040
    s_waitcnt lgkmcnt(6)
    v_mfma_f32_32x32x16_bf16 v[128:143], v[80:83], v[176:179], v[128:143]
    ds_read_b64_tr_b16 v[160:161], v213 offset:0
    ds_read_b64_tr_b16 v[162:163], v213 offset:512
    s_waitcnt lgkmcnt(6)
    v_mfma_f32_32x32x16_bf16 v[128:143], v[84:87], v[180:183], v[128:143]
    ds_read_b64_tr_b16 v[164:165], v213 offset:2048
    ds_read_b64_tr_b16 v[166:167], v213 offset:2560
    s_waitcnt lgkmcnt(6)
    v_mfma_f32_32x32x16_bf16 v[128:143], v[88:91], v[184:187], v[128:143]
    ds_read_b64_tr_b16 v[168:169], v213 offset:4096
    ds_read_b64_tr_b16 v[170:171], v213 offset:4608
    s_waitcnt lgkmcnt(6)
    v_mfma_f32_32x32x16_bf16 v[128:143], v[92:95], v[188:191], v[128:143]
    ds_read_b64_tr_b16 v[172:173], v213 offset:6144
    ds_read_b64_tr_b16 v[174:175], v213 offset:6656
    s_waitcnt lgkmcnt(6)
    v_mfma_f32_32x32x16_bf16 v[128:143], v[96:99], v[160:163], v[128:143]
    s_waitcnt vmcnt(4)
    s_barrier
    s_add_u32 m0, s59, 122880
    s_bfe_u32 s96, s75, 0x40010
    s_mul_i32 s96, s96, 229376
    s_add_u32 s96, s96, s69
    buffer_load_dwordx4 v3, s[16:19], s96 offen lds
    s_add_u32 m0, s59, 16384
    s_nop 0
    buffer_load_dwordx4 v3, s[20:23], s96 offen lds
    s_mov_b64 exec, 1
    buffer_store_dwordx2 v[222:223], v14, s[24:27], s79 offen sc1
    s_mov_b64 exec, -1
    ds_read_b64_tr_b16 v[176:177], v213 offset:8192
    ds_read_b64_tr_b16 v[178:179], v213 offset:8704
    s_waitcnt lgkmcnt(6)
    v_mfma_f32_32x32x16_bf16 v[128:143], v[100:103], v[164:167], v[128:143]
    ds_read_b64_tr_b16 v[180:181], v213 offset:10240
    ds_read_b64_tr_b16 v[182:183], v213 offset:10752
    s_waitcnt lgkmcnt(6)
    v_mfma_f32_32x32x16_bf16 v[128:143], v[104:107], v[168:171], v[128:143]
    ds_read_b64_tr_b16 v[184:185], v213 offset:12288
    ds_read_b64_tr_b16 v[186:187], v213 offset:12800
    s_waitcnt lgkmcnt(6)
    v_mfma_f32_32x32x16_bf16 v[128:143], v[108:111], v[172:175], v[128:143]
    ds_read_b64_tr_b16 v[188:189], v213 offset:14336
    ds_read_b64_tr_b16 v[190:191], v213 offset:14848
    s_waitcnt lgkmcnt(6)
    v_mfma_f32_32x32x16_bf16 v[128:143], v[112:115], v[176:179], v[128:143]
    s_waitcnt lgkmcnt(4)
    v_mfma_f32_32x32x16_bf16 v[128:143], v[116:119], v[180:183], v[128:143]
    s_waitcnt lgkmcnt(2)
    v_mfma_f32_32x32x16_bf16 v[128:143], v[120:123], v[184:187], v[128:143]
    s_waitcnt lgkmcnt(0)
    v_mfma_f32_32x32x16_bf16 v[128:143], v[124:127], v[188:191], v[128:143]
    s_branch L_sj66
L_sh65:
    s_waitcnt vmcnt(7)
    s_barrier
    s_add_u32 m0, s59, 90112
    s_bfe_u32 s96, s75, 0x40004
    s_mul_i32 s96, s96, 229376
    s_add_u32 s96, s96, s69
    buffer_load_dwordx4 v3, s[16:19], s96 offen lds
    s_add_u32 m0, s59, 114688
    s_nop 0
    buffer_load_dwordx4 v3, s[20:23], s96 offen lds
    s_nop 0
    v_cvt_pk_bf16_f32 v192, v128, v129
    v_cvt_pk_bf16_f32 v193, v130, v131
    v_cvt_pk_bf16_f32 v194, v132, v133
    v_cvt_pk_bf16_f32 v195, v134, v135
    buffer_store_dwordx4 v[192:195], v10, s[24:27], s71 offen sc1
    v_cvt_pk_bf16_f32 v196, v136, v137
    v_cvt_pk_bf16_f32 v197, v138, v139
    v_cvt_pk_bf16_f32 v198, v140, v141
    v_cvt_pk_bf16_f32 v199, v142, v143
    s_add_u32 s60, s71, 14336
    buffer_store_dwordx4 v[196:199], v10, s[24:27], s60 offen sc1
    v_cmp_gt_u32 vcc, 4, v1
    v_mov_b32 v12, 0x3f803f80
    v_lshlrev_b32 v207, 2, v1
    s_mul_i32 s60, s63, 29184
    v_cndmask_b32 v12, 0, v12, vcc
    s_add_u32 s60, s60, 16805888
    s_mov_b64 exec, 0xffff
    buffer_store_dword v12, v207, s[24:27], s60 offen sc1
    s_mov_b64 exec, -1
    s_waitcnt vmcnt(10)
    s_barrier
    s_add_u32 m0, s59, 98304
    s_bfe_u32 s96, s75, 0x40008
    s_mul_i32 s96, s96, 229376
    s_add_u32 s96, s96, s69
    buffer_load_dwordx4 v3, s[16:19], s96 offen lds
    s_add_u32 m0, s59, 106496
    s_nop 0
    buffer_load_dwordx4 v3, s[20:23], s96 offen lds
    s_lshl_b32 s60, s2, 13
    v_lshlrev_b32 v192, 7, v1
    s_cmp_lg_u32 s58, 0
    s_cbranch_scc1 L_pwn68h
    buffer_load_dword v203, v192, s[28:31], s60 offen
L_pwn68h:
    s_cmp_lg_u32 s58, 1
    s_cbranch_scc1 L_pwn69h
    buffer_load_dword v203, v192, s[32:35], s60 offen
L_pwn69h:
    s_waitcnt vmcnt(10)
    s_barrier
    s_add_u32 m0, s59, 0
    s_bfe_u32 s96, s75, 0x4000c
    s_mul_i32 s96, s96, 229376
    s_add_u32 s96, s96, s69
    buffer_load_dwordx4 v3, s[16:19], s96 offen lds
    s_add_u32 m0, s59, 8192
    s_nop 0
    buffer_load_dwordx4 v3, s[20:23], s96 offen lds
    s_waitcnt vmcnt(4)
    s_barrier
    s_add_u32 m0, s59, 122880
    s_bfe_u32 s96, s75, 0x40010
    s_mul_i32 s96, s96, 229376
    s_add_u32 s96, s96, s69
    buffer_load_dwordx4 v3, s[16:19], s96 offen lds
    s_add_u32 m0, s59, 16384
    s_nop 0
    buffer_load_dwordx4 v3, s[20:23], s96 offen lds
    s_mov_b64 exec, 1
    buffer_store_dwordx2 v[222:223], v14, s[24:27], s79 offen sc1
    s_mov_b64 exec, -1
L_sj66:
    s_waitcnt vmcnt(12)
    s_barrier
    ds_read_b64_tr_b16 v[160:161], v8 offset:24576
    ds_read_b64_tr_b16 v[162:163], v8 offset:25088
    ds_read_b64_tr_b16 v[164:165], v7 offset:16384
    ds_read_b64_tr_b16 v[166:167], v7 offset:16896
    ds_read_b64_tr_b16 v[168:169], v8 offset:26624
    ds_read_b64_tr_b16 v[170:171], v8 offset:27136
    ds_read_b64_tr_b16 v[172:173], v7 offset:18432
    ds_read_b64_tr_b16 v[174:175], v7 offset:18944
    s_cmp_ge_u32 s58, 4
    s_cbranch_scc1 L_sj70
    s_nop 7
    v_cvt_pk_bf16_f32 v192, v128, v129
    v_cvt_pk_bf16_f32 v193, v130, v131
    v_cvt_pk_bf16_f32 v194, v132, v133
    v_cvt_pk_bf16_f32 v195, v134, v135
    buffer_store_dwordx4 v[192:195], v10, s[24:27], s72 offen sc1
    v_cvt_pk_bf16_f32 v196, v136, v137
    v_cvt_pk_bf16_f32 v197, v138, v139
    v_cvt_pk_bf16_f32 v198, v140, v141
    v_cvt_pk_bf16_f32 v199, v142, v143
    s_add_u32 s60, s72, 14336
    buffer_store_dwordx4 v[196:199], v10, s[24:27], s60 offen sc1
    v_cmp_gt_u32 vcc, 4, v1
    v_mov_b32 v12, 0x3f803f80
    v_lshlrev_b32 v207, 2, v1
    s_mul_i32 s60, s63, 29184
    v_cndmask_b32 v12, 0, v12, vcc
    s_add_u32 s60, s60, 16805888
    s_mov_b64 exec, 0xffff
    buffer_store_dword v12, v207, s[24:27], s60 offen sc1
    s_mov_b64 exec, -1
L_sj70:
    s_waitcnt lgkmcnt(6)
    v_mfma_f32_32x32x16_bf16 v[128:143], v[160:163], v[16:19], 0
    ds_read_b64_tr_b16 v[176:177], v8 offset:28672
    ds_read_b64_tr_b16 v[178:179], v8 offset:29184
    s_waitcnt lgkmcnt(6)
    v_mfma_f32_32x32x16_bf16 v[144:159], v[164:167], v[16:19], 0
    ds_read_b64_tr_b16 v[180:181], v7 offset:20480
    ds_read_b64_tr_b16 v[182:183], v7 offset:20992
    s_waitcnt lgkmcnt(6)
    v_mfma_f32_32x32x16_bf16 v[128:143], v[168:171], v[20:23], v[128:143]
    ds_read_b64_tr_b16 v[184:185], v8 offset:30720
    ds_read_b64_tr_b16 v[186:187], v8 offset:31232
    s_waitcnt lgkmcnt(6)
    v_mfma_f32_32x32x16_bf16 v[144:159], v[172:175], v[20:23], v[144:159]
    ds_read_b64_tr_b16 v[188:189], v7 offset:22528
    ds_read_b64_tr_b16 v[190:191], v7 offset:23040
    s_waitcnt lgkmcnt(6)
    v_mfma_f32_32x32x16_bf16 v[128:143], v[176:179], v[24:27], v[128:143]
    s_waitcnt vmcnt(13)
    s_cmp_lt_u32 s58, 4
    s_cbranch_scc1 L_vw71
    s_waitcnt vmcnt(10)
L_vw71:
    s_barrier
    ds_read_b64_tr_b16 v[160:161], v7 offset:24576
    ds_read_b64_tr_b16 v[162:163], v7 offset:25088
    s_waitcnt lgkmcnt(6)
    v_mfma_f32_32x32x16_bf16 v[144:159], v[180:183], v[24:27], v[144:159]
    s_add_u32 m0, s59, 24576
    s_bfe_u32 s96, s75, 0x40014
    s_mul_i32 s96, s96, 229376
    s_add_u32 s96, s96, s69
    buffer_load_dwordx4 v3, s[16:19], s96 offen lds
    ds_read_b64_tr_b16 v[164:165], v7 offset:49152
    ds_read_b64_tr_b16 v[166:167], v7 offset:49664
    s_waitcnt lgkmcnt(6)
    v_mfma_f32_32x32x16_bf16 v[128:143], v[184:187], v[28:31], v[128:143]
    ds_read_b64_tr_b16 v[168:169], v7 offset:26624
    ds_read_b64_tr_b16 v[170:171], v7 offset:27136
    s_waitcnt lgkmcnt(6)
    v_mfma_f32_32x32x16_bf16 v[144:159], v[188:191], v[28:31], v[144:159]
    ds_read_b64_tr_b16 v[172:173], v7 offset:51200
    ds_read_b64_tr_b16 v[174:175], v7 offset:51712
    s_waitcnt lgkmcnt(6)
    v_mfma_f32_32x32x16_bf16 v[128:143], v[160:163], v[32:35], v[128:143]
    ds_read_b64_tr_b16 v[176:177], v7 offset:28672
    ds_read_b64_tr_b16 v[178:179], v7 offset:29184
    s_waitcnt lgkmcnt(6)
    v_mfma_f32_32x32x16_bf16 v[144:159], v[164:167], v[32:35], v[144:159]
    s_add_u32 m0, s59, 131072
    s_nop 0
    buffer_load_dwordx4 v3, s[20:23], s96 offen lds
    ds_read_b64_tr_b16 v[180:181], v7 offset:53248
    ds_read_b64_tr_b16 v[182:183], v7 offset:53760
    s_waitcnt lgkmcnt(6)
    v_mfma_f32_32x32x16_bf16 v[128:143], v[168:171], v[36:39], v[128:143]
    ds_read_b64_tr_b16 v[184:185], v7 offset:30720
    ds_read_b64_tr_b16 v[186:187], v7 offset:31232
    s_waitcnt lgkmcnt(6)
    v_mfma_f32_32x32x16_bf16 v[144:159], v[172:175], v[36:39], v[144:159]
    ds_read_b64_tr_b16 v[188:189], v7 offset:55296
    ds_read_b64_tr_b16 v[190:191], v7 offset:55808
    s_waitcnt lgkmcnt(6)
    v_mfma_f32_32x32x16_bf16 v[128:143], v[176:179], v[40:43], v[128:143]
    s_waitcnt vmcnt(7)
    s_cmp_ge_u32 s58, 4
    s_cbranch_scc1 L_vw72
    s_waitcnt vmcnt(2)
L_vw72:
    s_barrier
    s_cmp_ge_u32 s58, 4
    s_cbranch_scc1 L_p073
    s_mov_b64 exec, 1
    buffer_store_dwordx2 v[222:223], v14, s[24:27], s80 offen sc1
    s_mov_b64 exec, -1
L_p073:
    ds_read_b64_tr_b16 v[160:161], v7 offset:32768
    ds_read_b64_tr_b16 v[162:163], v7 offset:33280
    s_waitcnt lgkmcnt(6)
    v_mfma_f32_32x32x16_bf16 v[144:159], v[180:183], v[40:43], v[144:159]
    s_add_u32 m0, s59, 32768
    s_bfe_u32 s96, s75, 0x40018
    s_mul_i32 s96, s96, 229376
    s_add_u32 s96, s96, s69
    buffer_load_dwordx4 v3, s[16:19], s96 offen lds
    ds_read_b64_tr_b16 v[164:165], v7 offset:40960
    ds_read_b64_tr_b16 v[166:167], v7 offset:41472
    s_waitcnt lgkmcnt(6)
    v_mfma_f32_32x32x16_bf16 v[128:143], v[184:187], v[44:47], v[128:143]
    ds_read_b64_tr_b16 v[168:169], v7 offset:34816
    ds_read_b64_tr_b16 v[170:171], v7 offset:35328
    s_waitcnt lgkmcnt(6)
    v_mfma_f32_32x32x16_bf16 v[144:159], v[188:191], v[44:47], v[144:159]
    ds_read_b64_tr_b16 v[172:173], v7 offset:43008
    ds_read_b64_tr_b16 v[174:175], v7 offset:43520
    s_waitcnt lgkmcnt(6)
    v_mfma_f32_32x32x16_bf16 v[128:143], v[160:163], v[48:51], v[128:143]
    ds_read_b64_tr_b16 v[176:177], v7 offset:36864
    ds_read_b64_tr_b16 v[178:179], v7 offset:37376
    s_waitcnt lgkmcnt(6)
    v_mfma_f32_32x32x16_bf16 v[144:159], v[164:167], v[48:51], v[144:159]
    s_add_u32 m0, s59, 40960
    s_nop 0
    buffer_load_dwordx4 v3, s[20:23], s96 offen lds
    ds_read_b64_tr_b16 v[180:181], v7 offset:45056
    ds_read_b64_tr_b16 v[182:183], v7 offset:45568
    s_waitcnt lgkmcnt(6)
    v_mfma_f32_32x32x16_bf16 v[128:143], v[168:171], v[52:55], v[128:143]
    ds_read_b64_tr_b16 v[184:185], v7 offset:38912
    ds_read_b64_tr_b16 v[186:187], v7 offset:39424
    s_waitcnt lgkmcnt(6)
    v_mfma_f32_32x32x16_bf16 v[144:159], v[172:175], v[52:55], v[144:159]
    ds_read_b64_tr_b16 v[188:189], v7 offset:47104
    ds_read_b64_tr_b16 v[190:191], v7 offset:47616
    s_waitcnt lgkmcnt(6)
    v_mfma_f32_32x32x16_bf16 v[128:143], v[176:179], v[56:59], v[128:143]
    s_waitcnt vmcnt(11)
    s_cmp_lt_u32 s58, 4
    s_cbranch_scc1 L_vw74
    s_waitcnt vmcnt(7)
L_vw74:
    s_barrier
    ds_read_b64_tr_b16 v[160:161], v6 offset:0
    ds_read_b64_tr_b16 v[162:163], v6 offset:512
    s_waitcnt lgkmcnt(6)
    v_mfma_f32_32x32x16_bf16 v[144:159], v[180:183], v[56:59], v[144:159]
    ds_read_b64_tr_b16 v[164:165], v6 offset:8192
    ds_read_b64_tr_b16 v[166:167], v6 offset:8704
    s_waitcnt lgkmcnt(6)
    v_mfma_f32_32x32x16_bf16 v[128:143], v[184:187], v[60:63], v[128:143]
    ds_read_b64_tr_b16 v[168:169], v6 offset:2048
    ds_read_b64_tr_b16 v[170:171], v6 offset:2560
    s_waitcnt lgkmcnt(6)
    v_mfma_f32_32x32x16_bf16 v[144:159], v[188:191], v[60:63], v[144:159]
    ds_read_b64_tr_b16 v[172:173], v6 offset:10240
    ds_read_b64_tr_b16 v[174:175], v6 offset:10752
    s_waitcnt lgkmcnt(6)
    v_mfma_f32_32x32x16_bf16 v[128:143], v[160:163], v[64:67], v[128:143]
    ds_read_b64_tr_b16 v[176:177], v6 offset:4096
    ds_read_b64_tr_b16 v[178:179], v6 offset:4608
    s_waitcnt lgkmcnt(6)
    v_mfma_f32_32x32x16_bf16 v[144:159], v[164:167], v[64:67], v[144:159]
    ds_read_b64_tr_b16 v[180:181], v6 offset:12288
    ds_read_b64_tr_b16 v[182:183], v6 offset:12800
    s_waitcnt lgkmcnt(6)
    v_mfma_f32_32x32x16_bf16 v[128:143], v[168:171], v[68:71], v[128:143]
    ds_read_b64_tr_b16 v[184:185], v6 offset:6144
    ds_read_b64_tr_b16 v[186:187], v6 offset:6656
    s_waitcnt lgkmcnt(6)
    v_mfma_f32_32x32x16_bf16 v[144:159], v[172:175], v[68:71], v[144:159]
    ds_read_b64_tr_b16 v[188:189], v6 offset:14336
    ds_read_b64_tr_b16 v[190:191], v6 offset:14848
    s_waitcnt lgkmcnt(6)
    v_mfma_f32_32x32x16_bf16 v[128:143], v[176:179], v[72:75], v[128:143]
    s_waitcnt vmcnt(9)
    s_cmp_lt_u32 s58, 4
    s_cbranch_scc1 L_vw75
    s_waitcnt vmcnt(5)
L_vw75:
    s_barrier
    ds_read_b64_tr_b16 v[160:161], v7 offset:57344
    ds_read_b64_tr_b16 v[162:163], v7 offset:57856
    s_waitcnt lgkmcnt(6)
    v_mfma_f32_32x32x16_bf16 v[144:159], v[180:183], v[72:75], v[144:159]
    ds_read_b64_tr_b16 v[164:165], v6 offset:16384
    ds_read_b64_tr_b16 v[166:167], v6 offset:16896
    s_waitcnt lgkmcnt(6)
    v_mfma_f32_32x32x16_bf16 v[128:143], v[184:187], v[76:79], v[128:143]
    ds_read_b64_tr_b16 v[168:169], v7 offset:59392
    ds_read_b64_tr_b16 v[170:171], v7 offset:59904
    s_waitcnt lgkmcnt(6)
    v_mfma_f32_32x32x16_bf16 v[144:159], v[188:191], v[76:79], v[144:159]
    ds_read_b64_tr_b16 v[172:173], v6 offset:18432
    ds_read_b64_tr_b16 v[174:175], v6 offset:18944
    s_waitcnt lgkmcnt(6)
    v_mfma_f32_32x32x16_bf16 v[128:143], v[160:163], v[80:83], v[128:143]
    ds_read_b64_tr_b16 v[176:177], v7 offset:61440
    ds_read_b64_tr_b16 v[178:179], v7 offset:61952
    s_waitcnt lgkmcnt(6)
    v_mfma_f32_32x32x16_bf16 v[144:159], v[164:167], v[80:83], v[144:159]
    ds_read_b64_tr_b16 v[180:181], v6 offset:20480
    ds_read_b64_tr_b16 v[182:183], v6 offset:20992
    s_waitcnt lgkmcnt(6)
    v_mfma_f32_32x32x16_bf16 v[128:143], v[168:171], v[84:87], v[128:143]
    ds_read_b64_tr_b16 v[184:185], v7 offset:63488
    ds_read_b64_tr_b16 v[186:187], v7 offset:64000
    s_waitcnt lgkmcnt(6)
    v_mfma_f32_32x32x16_bf16 v[144:159], v[172:175], v[84:87], v[144:159]
    ds_read_b64_tr_b16 v[188:189], v6 offset:22528
    ds_read_b64_tr_b16 v[190:191], v6 offset:23040
    s_waitcnt lgkmcnt(6)
    v_mfma_f32_32x32x16_bf16 v[128:143], v[176:179], v[88:91], v[128:143]
    s_waitcnt vmcnt(2)
    s_barrier
    s_mov_b32 s60, 15007744
    buffer_load_dwordx2 v[216:217], v242, s[24:27], s60 offen sc1
    buffer_load_dwordx2 v[218:219], v243, s[24:27], s60 offen sc1
    ds_read_b64_tr_b16 v[160:161], v6 offset:24576
    ds_read_b64_tr_b16 v[162:163], v6 offset:25088
    s_waitcnt lgkmcnt(6)
    v_mfma_f32_32x32x16_bf16 v[144:159], v[180:183], v[88:91], v[144:159]
    ds_read_b64_tr_b16 v[164:165], v8 offset:0
    ds_read_b64_tr_b16 v[166:167], v8 offset:512
    s_waitcnt lgkmcnt(6)
    v_mfma_f32_32x32x16_bf16 v[128:143], v[184:187], v[92:95], v[128:143]
    ds_read_b64_tr_b16 v[168:169], v6 offset:26624
    ds_read_b64_tr_b16 v[170:171], v6 offset:27136
    s_waitcnt lgkmcnt(6)
    v_mfma_f32_32x32x16_bf16 v[144:159], v[188:191], v[92:95], v[144:159]
    ds_read_b64_tr_b16 v[172:173], v8 offset:2048
    ds_read_b64_tr_b16 v[174:175], v8 offset:2560
    s_waitcnt lgkmcnt(6)
    v_mfma_f32_32x32x16_bf16 v[128:143], v[160:163], v[96:99], v[128:143]
    ds_read_b64_tr_b16 v[176:177], v6 offset:28672
    ds_read_b64_tr_b16 v[178:179], v6 offset:29184
    s_waitcnt lgkmcnt(6)
    v_mfma_f32_32x32x16_bf16 v[144:159], v[164:167], v[96:99], v[144:159]
    ds_read_b64_tr_b16 v[180:181], v8 offset:4096
    ds_read_b64_tr_b16 v[182:183], v8 offset:4608
    s_waitcnt lgkmcnt(6)
    v_mfma_f32_32x32x16_bf16 v[128:143], v[168:171], v[100:103], v[128:143]
    ds_read_b64_tr_b16 v[184:185], v6 offset:30720
    ds_read_b64_tr_b16 v[186:187], v6 offset:31232
    s_waitcnt lgkmcnt(6)
    v_mfma_f32_32x32x16_bf16 v[144:159], v[172:175], v[100:103], v[144:159]
    ds_read_b64_tr_b16 v[188:189], v8 offset:6144
    ds_read_b64_tr_b16 v[190:191], v8 offset:6656
    s_waitcnt lgkmcnt(6)
    v_mfma_f32_32x32x16_bf16 v[128:143], v[176:179], v[104:107], v[128:143]
    s_waitcnt vmcnt(2)
    s_barrier
    s_mov_b32 s3, 159744
    v_mov_b32 v204, s3
    ds_write_b32 v204, v14
    ds_write_b32 v204, v14 offset:4
    ds_read_b64_tr_b16 v[160:161], v6 offset:32768
    ds_read_b64_tr_b16 v[162:163], v6 offset:33280
    s_waitcnt lgkmcnt(8)
    v_mfma_f32_32x32x16_bf16 v[144:159], v[180:183], v[104:107], v[144:159]
    ds_read_b64_tr_b16 v[164:165], v6 offset:40960
    ds_read_b64_tr_b16 v[166:167], v6 offset:41472
    s_waitcnt lgkmcnt(8)
    v_mfma_f32_32x32x16_bf16 v[128:143], v[184:187], v[108:111], v[128:143]
    ds_read_b64_tr_b16 v[168:169], v6 offset:34816
    ds_read_b64_tr_b16 v[170:171], v6 offset:35328
    s_waitcnt lgkmcnt(8)
    v_mfma_f32_32x32x16_bf16 v[144:159], v[188:191], v[108:111], v[144:159]
    ds_read_b64_tr_b16 v[172:173], v6 offset:43008
    ds_read_b64_tr_b16 v[174:175], v6 offset:43520
    s_waitcnt lgkmcnt(6)
    v_mfma_f32_32x32x16_bf16 v[128:143], v[160:163], v[112:115], v[128:143]
    ds_read_b64_tr_b16 v[176:177], v6 offset:36864
    ds_read_b64_tr_b16 v[178:179], v6 offset:37376
    s_waitcnt lgkmcnt(6)
    v_mfma_f32_32x32x16_bf16 v[144:159], v[164:167], v[112:115], v[144:159]
    ds_read_b64_tr_b16 v[180:181], v6 offset:45056
    ds_read_b64_tr_b16 v[182:183], v6 offset:45568
    s_waitcnt lgkmcnt(6)
    v_mfma_f32_32x32x16_bf16 v[128:143], v[168:171], v[116:119], v[128:143]
    ds_read_b64_tr_b16 v[184:185], v6 offset:38912
    ds_read_b64_tr_b16 v[186:187], v6 offset:39424
    s_waitcnt lgkmcnt(6)
    v_mfma_f32_32x32x16_bf16 v[144:159], v[172:175], v[116:119], v[144:159]
    ds_read_b64_tr_b16 v[188:189], v6 offset:47104
    ds_read_b64_tr_b16 v[190:191], v6 offset:47616
    s_mov_b32 s91, 0
    s_cmp_ge_u32 s58, 4
    s_cbranch_scc1 L_eh76
    s_waitcnt vmcnt(0)
    v_cmp_ne_u32 vcc, s76, v216
    v_cmp_ne_u32 s[4:5], s77, v217
    s_nop 0
    s_or_b64 vcc, vcc, s[4:5]
    s_cbranch_vccnz L_eh76
    v_cmp_ne_u32 vcc, s76, v218
    v_cmp_ne_u32 s[4:5], s77, v219
    s_nop 0
    s_or_b64 vcc, vcc, s[4:5]
    s_cbranch_vccnz L_eh76
    buffer_load_dwordx4 v[48:51], v240, s[44:47], s84 offen sc1
    buffer_load_dwordx4 v[52:55], v248, s[44:47], s84 offen sc1
    buffer_load_dwordx4 v[56:59], v241, s[44:47], s86 offen sc1
    buffer_load_dwordx4 v[60:63], v249, s[44:47], s86 offen sc1
    s_add_u32 s84, s84, 512
    s_and_b32 s84, s84, 8191
    s_mul_i32 s86, s84, 57
    s_lshl_b32 s4, s89, 15
    s_lshl_b32 s5, s83, 11
    s_add_u32 s4, s4, s5
    s_add_u32 s5, s58, 1
    s_and_b32 s5, s5, 3
    s_lshl_b32 s5, s5, 9
    s_add_u32 s5, s5, s4
    s_add_u32 s6, s5, 65536
    buffer_load_dwordx4 v[16:19], v250, s[24:27], s5 offen sc1
    buffer_load_dwordx4 v[20:23], v250, s[24:27], s6 offen sc1
    s_add_u32 s5, s58, 2
    s_and_b32 s5, s5, 3
    s_lshl_b32 s5, s5, 9
    s_add_u32 s5, s5, s4
    s_add_u32 s6, s5, 65536
    buffer_load_dwordx4 v[24:27], v250, s[24:27], s5 offen sc1
    buffer_load_dwordx4 v[28:31], v250, s[24:27], s6 offen sc1
    s_add_u32 s5, s58, 3
    s_and_b32 s5, s5, 3
    s_lshl_b32 s5, s5, 9
    s_add_u32 s5, s5, s4
    s_add_u32 s6, s5, 65536
    buffer_load_dwordx4 v[32:35], v250, s[24:27], s5 offen sc1
    buffer_load_dwordx4 v[36:39], v250, s[24:27], s6 offen sc1
    s_add_u32 s5, s58, 4
    s_and_b32 s5, s5, 3
    s_lshl_b32 s5, s5, 9
    s_add_u32 s5, s5, s4
    s_add_u32 s6, s5, 65536
    buffer_load_dwordx4 v[40:43], v250, s[24:27], s5 offen sc1
    buffer_load_dwordx4 v[44:47], v250, s[24:27], s6 offen sc1
    s_lshl_b32 s4, s83, 2
    s_add_u32 s4, s4, s58
    s_lshl_b32 s4, s4, 7
    s_add_u32 s4, s4, 14942208
    v_and_b32 v246, 31, v1
    v_lshlrev_b32 v246, 2, v246
    buffer_load_dword v246, v246, s[24:27], s4 offen sc1
    s_mov_b32 s91, 1
L_eh76:
    s_waitcnt lgkmcnt(6)
    v_mfma_f32_32x32x16_bf16 v[128:143], v[176:179], v[120:123], v[128:143]
    s_waitcnt lgkmcnt(4)
    v_mfma_f32_32x32x16_bf16 v[144:159], v[180:183], v[120:123], v[144:159]
    s_waitcnt lgkmcnt(2)
    v_mfma_f32_32x32x16_bf16 v[128:143], v[184:187], v[124:127], v[128:143]
    s_waitcnt lgkmcnt(0)
    v_mfma_f32_32x32x16_bf16 v[144:159], v[188:191], v[124:127], v[144:159]
    s_branch L_tail
L_B:
    s_mov_b32 s7, 12
    s_lshl_b32 s66, s7, 7
    s_lshl_b32 s61, s7, 1
    s_lshl_b32 s70, s61, 17
    s_cmp_lt_u32 s7, 7
    s_cselect_b32 s74, 0x3e8b97f6, 1.0
    s_lshl_b32 s78, s61, 6
    s_add_u32 s78, s78, s63
    s_lshl_b32 s78, s78, 3
    s_add_u32 s78, s78, 15007744
    s_mov_b32 s7, 13
    s_lshl_b32 s67, s7, 7
    s_lshl_b32 s61, s7, 1
    s_add_u32 s61, s61, s64
    s_lshl_b32 s71, s61, 17
    s_cmp_lt_u32 s7, 7
    s_cselect_b32 s74, 0x3e8b97f6, 1.0
    s_lshl_b32 s79, s61, 6
    s_add_u32 s79, s79, s63
    s_lshl_b32 s79, s79, 3
    s_add_u32 s79, s79, 15007744
    s_mov_b32 s7, 24
    s_lshl_b32 s68, s7, 7
    s_lshl_b32 s61, s7, 1
    s_add_u32 s61, s61, s64
    s_lshl_b32 s72, s61, 11
    s_mul_i32 s60, s63, 147456
    s_add_u32 s72, s72, s60
    s_add_u32 s72, s72, 5505024
    s_lshl_b32 s80, s63, 6
    s_add_u32 s80, s80, s61
    s_lshl_b32 s80, s80, 3
    s_add_u32 s80, s80, 15032320
    s_mov_b32 s53, s72
    s_mov_b32 s54, s80
    s_cmp_ge_u32 s58, 4
    s_cbranch_scc1 L_g0c77
    s_waitcnt vmcnt(6) lgkmcnt(4)
    s_barrier
    v_add_u32 v212, 0, v208
    v_add_u32 v213, 0, v209
    v_add_u32 v214, 0, v210
    v_add_u32 v215, 0, v211
    ds_read_b128 v[16:19], v212
    ds_read_b128 v[20:23], v213
    ds_read_b128 v[24:27], v214
    ds_read_b128 v[28:31], v215
    s_add_u32 m0, s65, 131072
    s_bfe_u32 s61, s75, 0x40008
    s_mul_i32 s61, s61, 172032
    s_add_u32 s61, s61, s66
    buffer_load_dwordx4 v202, s[12:15], s61 offen lds
    s_add_u32 m0, s65, 132096
    s_add_u32 s61, s61, 21504
    buffer_load_dwordx4 v202, s[12:15], s61 offen lds
    s_add_u32 m0, s55, 32768
    s_bfe_u32 s60, s75, 0x40008
    s_mul_i32 s60, s60, 128
    s_add_u32 s60, s60, s62
    buffer_load_dwordx4 v4, s[8:11], s60 offen lds
    s_add_u32 m0, s55, 33792
    s_nop 0
    buffer_load_dwordx4 v5, s[8:11], s60 offen lds
    s_add_u32 m0, s55, 34816
    s_add_u32 s60, s60, 14336
    buffer_load_dwordx4 v4, s[8:11], s60 offen lds
    s_add_u32 m0, s55, 35840
    s_nop 0
    buffer_load_dwordx4 v5, s[8:11], s60 offen lds
    s_add_u32 m0, s65, 139264
    s_bfe_u32 s61, s75, 0x4000c
    s_mul_i32 s61, s61, 172032
    s_add_u32 s61, s61, s66
    buffer_load_dwordx4 v202, s[12:15], s61 offen lds
    s_add_u32 m0, s65, 140288
    s_add_u32 s61, s61, 21504
    buffer_load_dwordx4 v202, s[12:15], s61 offen lds
    s_add_u32 m0, s55, 49152
    s_bfe_u32 s60, s75, 0x4000c
    s_mul_i32 s60, s60, 128
    s_add_u32 s60, s60, s62
    buffer_load_dwordx4 v4, s[8:11], s60 offen lds
    s_add_u32 m0, s55, 50176
    s_nop 0
    buffer_load_dwordx4 v5, s[8:11], s60 offen lds
    s_add_u32 m0, s55, 51200
    s_add_u32 s60, s60, 14336
    buffer_load_dwordx4 v4, s[8:11], s60 offen lds
    s_add_u32 m0, s55, 52224
    s_nop 0
    buffer_load_dwordx4 v5, s[8:11], s60 offen lds
    s_waitcnt vmcnt(12) lgkmcnt(4)
    s_barrier
    v_add_u32 v212, 16384, v208
    v_add_u32 v213, 16384, v209
    v_add_u32 v214, 16384, v210
    v_add_u32 v215, 16384, v211
    ds_read_b128 v[32:35], v212
    ds_read_b128 v[36:39], v213
    ds_read_b128 v[40:43], v214
    ds_read_b128 v[44:47], v215
    s_add_u32 m0, s65, 147456
    s_bfe_u32 s61, s75, 0x40010
    s_mul_i32 s61, s61, 172032
    s_add_u32 s61, s61, s66
    buffer_load_dwordx4 v202, s[12:15], s61 offen lds
    s_add_u32 m0, s65, 148480
    s_add_u32 s61, s61, 21504
    buffer_load_dwordx4 v202, s[12:15], s61 offen lds
    s_add_u32 m0, s55, 65536
    s_bfe_u32 s60, s75, 0x40010
    s_mul_i32 s60, s60, 128
    s_add_u32 s60, s60, s62
    buffer_load_dwordx4 v4, s[8:11], s60 offen lds
    s_add_u32 m0, s55, 66560
    s_nop 0
    buffer_load_dwordx4 v5, s[8:11], s60 offen lds
    s_add_u32 m0, s55, 67584
    s_add_u32 s60, s60, 14336
    buffer_load_dwordx4 v4, s[8:11], s60 offen lds
    s_add_u32 m0, s55, 68608
    s_nop 0
    buffer_load_dwordx4 v5, s[8:11], s60 offen lds
    s_waitcnt vmcnt(12) lgkmcnt(4)
    s_barrier
    v_add_u32 v212, 32768, v208
    v_add_u32 v213, 32768, v209
    v_add_u32 v214, 32768, v210
    v_add_u32 v215, 32768, v211
    ds_read_b128 v[48:51], v212
    ds_read_b128 v[52:55], v213
    ds_read_b128 v[56:59], v214
    ds_read_b128 v[60:63], v215
    s_add_u32 m0, s65, 155648
    s_bfe_u32 s61, s75, 0x40014
    s_mul_i32 s61, s61, 172032
    s_add_u32 s61, s61, s66
    buffer_load_dwordx4 v202, s[12:15], s61 offen lds
    s_add_u32 m0, s65, 156672
    s_add_u32 s61, s61, 21504
    buffer_load_dwordx4 v202, s[12:15], s61 offen lds
    s_add_u32 m0, s55, 81920
    s_bfe_u32 s60, s75, 0x40014
    s_mul_i32 s60, s60, 128
    s_add_u32 s60, s60, s62
    buffer_load_dwordx4 v4, s[8:11], s60 offen lds
    s_add_u32 m0, s55, 82944
    s_nop 0
    buffer_load_dwordx4 v5, s[8:11], s60 offen lds
    s_add_u32 m0, s55, 83968
    s_add_u32 s60, s60, 14336
    buffer_load_dwordx4 v4, s[8:11], s60 offen lds
    s_add_u32 m0, s55, 84992
    s_nop 0
    buffer_load_dwordx4 v5, s[8:11], s60 offen lds
    s_waitcnt vmcnt(12) lgkmcnt(4)
    s_barrier
    v_add_u32 v212, 49152, v208
    v_add_u32 v213, 49152, v209
    v_add_u32 v214, 49152, v210
    v_add_u32 v215, 49152, v211
    ds_read_b128 v[64:67], v212
    ds_read_b128 v[68:71], v213
    ds_read_b128 v[72:75], v214
    ds_read_b128 v[76:79], v215
    s_add_u32 m0, s65, 114688
    s_bfe_u32 s61, s75, 0x40018
    s_mul_i32 s61, s61, 172032
    s_add_u32 s61, s61, s66
    buffer_load_dwordx4 v202, s[12:15], s61 offen lds
    s_add_u32 m0, s65, 115712
    s_add_u32 s61, s61, 21504
    buffer_load_dwordx4 v202, s[12:15], s61 offen lds
    s_add_u32 m0, s55, 98304
    s_bfe_u32 s60, s75, 0x40018
    s_mul_i32 s60, s60, 128
    s_add_u32 s60, s60, s62
    buffer_load_dwordx4 v4, s[8:11], s60 offen lds
    s_add_u32 m0, s55, 99328
    s_nop 0
    buffer_load_dwordx4 v5, s[8:11], s60 offen lds
    s_add_u32 m0, s55, 100352
    s_add_u32 s60, s60, 14336
    buffer_load_dwordx4 v4, s[8:11], s60 offen lds
    s_add_u32 m0, s55, 101376
    s_nop 0
    buffer_load_dwordx4 v5, s[8:11], s60 offen lds
    s_add_u32 m0, s65, 0
    s_bfe_u32 s60, s75, 0x40000
    s_mul_i32 s60, s60, 172032
    s_add_u32 s60, s60, s67
    buffer_load_dwordx4 v202, s[12:15], s60 offen lds
    s_add_u32 m0, s65, 1024
    s_add_u32 s60, s60, 21504
    buffer_load_dwordx4 v202, s[12:15], s60 offen lds
    s_add_u32 m0, s65, 8192
    s_bfe_u32 s60, s75, 0x40004
    s_mul_i32 s60, s60, 172032
    s_add_u32 s60, s60, s67
    buffer_load_dwordx4 v202, s[12:15], s60 offen lds
    s_add_u32 m0, s65, 9216
    s_add_u32 s60, s60, 21504
    buffer_load_dwordx4 v202, s[12:15], s60 offen lds
    s_waitcnt vmcnt(16) lgkmcnt(4)
    s_barrier
    v_add_u32 v212, 65536, v208
    v_add_u32 v213, 65536, v209
    v_add_u32 v214, 65536, v210
    v_add_u32 v215, 65536, v211
    ds_read_b128 v[80:83], v212
    ds_read_b128 v[84:87], v213
    ds_read_b128 v[88:91], v214
    ds_read_b128 v[92:95], v215
    s_add_u32 m0, s65, 122880
    s_bfe_u32 s60, s75, 0x40008
    s_mul_i32 s60, s60, 172032
    s_add_u32 s60, s60, s67
    buffer_load_dwordx4 v202, s[12:15], s60 offen lds
    s_add_u32 m0, s65, 123904
    s_add_u32 s60, s60, 21504
    buffer_load_dwordx4 v202, s[12:15], s60 offen lds
    s_add_u32 m0, s65, 16384
    s_bfe_u32 s60, s75, 0x4000c
    s_mul_i32 s60, s60, 172032
    s_add_u32 s60, s60, s67
    buffer_load_dwordx4 v202, s[12:15], s60 offen lds
    s_add_u32 m0, s65, 17408
    s_add_u32 s60, s60, 21504
    buffer_load_dwordx4 v202, s[12:15], s60 offen lds
    s_waitcnt vmcnt(14) lgkmcnt(4)
    s_barrier
    v_add_u32 v212, 81920, v208
    v_add_u32 v213, 81920, v209
    v_add_u32 v214, 81920, v210
    v_add_u32 v215, 81920, v211
    ds_read_b128 v[96:99], v212
    ds_read_b128 v[100:103], v213
    ds_read_b128 v[104:107], v214
    ds_read_b128 v[108:111], v215
    s_add_u32 m0, s65, 24576
    s_bfe_u32 s60, s75, 0x40010
    s_mul_i32 s60, s60, 172032
    s_add_u32 s60, s60, s67
    buffer_load_dwordx4 v202, s[12:15], s60 offen lds
    s_add_u32 m0, s65, 25600
    s_add_u32 s60, s60, 21504
    buffer_load_dwordx4 v202, s[12:15], s60 offen lds
    s_add_u32 m0, s65, 131072
    s_bfe_u32 s60, s75, 0x40014
    s_mul_i32 s60, s60, 172032
    s_add_u32 s60, s60, s67
    buffer_load_dwordx4 v202, s[12:15], s60 offen lds
    s_add_u32 m0, s65, 132096
    s_add_u32 s60, s60, 21504
    buffer_load_dwordx4 v202, s[12:15], s60 offen lds
    s_waitcnt vmcnt(12) lgkmcnt(4)
    s_barrier
    v_add_u32 v212, 98304, v208
    v_add_u32 v213, 98304, v209
    v_add_u32 v214, 98304, v210
    v_add_u32 v215, 98304, v211
    ds_read_b128 v[112:115], v212
    ds_read_b128 v[116:119], v213
    ds_read_b128 v[120:123], v214
    ds_read_b128 v[124:127], v215
    s_add_u32 m0, s65, 32768
    s_bfe_u32 s60, s75, 0x40018
    s_mul_i32 s60, s60, 172032
    s_add_u32 s60, s60, s67
    buffer_load_dwordx4 v202, s[12:15], s60 offen lds
    s_add_u32 m0, s65, 33792
    s_add_u32 s60, s60, 21504
    buffer_load_dwordx4 v202, s[12:15], s60 offen lds
    s_bfe_u32 s60, s75, 0x40000
    s_mul_i32 s60, s60, 229376
    s_add_u32 s60, s60, s68
    s_add_u32 s61, s60, 28672
    s_add_u32 m0, s65, 40960
    s_nop 0
    buffer_load_dwordx4 v201, s[16:19], s60 offen lds
    s_add_u32 m0, s65, 41984
    s_nop 0
    buffer_load_dwordx4 v201, s[16:19], s61 offen lds
    s_add_u32 m0, s65, 139264
    s_nop 0
    buffer_load_dwordx4 v201, s[20:23], s60 offen lds
    s_add_u32 m0, s65, 140288
    s_nop 0
    buffer_load_dwordx4 v201, s[20:23], s61 offen lds
    s_branch L_g0j78
L_g0c77:
    s_barrier
    v_add_u32 v212, 0, v208
    v_add_u32 v213, 0, v209
    v_add_u32 v214, 0, v210
    v_add_u32 v215, 0, v211
    ds_read_b128 v[16:19], v212
    ds_read_b128 v[20:23], v213
    ds_read_b128 v[24:27], v214
    ds_read_b128 v[28:31], v215
    ds_read_b64_tr_b16 v[216:217], v204 offset:49152
    ds_read_b64_tr_b16 v[218:219], v204 offset:49664
    ds_read_b64_tr_b16 v[220:221], v7 offset:49152
    ds_read_b64_tr_b16 v[222:223], v7 offset:49664
    ds_read_b64_tr_b16 v[224:225], v204 offset:51200
    ds_read_b64_tr_b16 v[226:227], v204 offset:51712
    ds_read_b64_tr_b16 v[228:229], v7 offset:51200
    ds_read_b64_tr_b16 v[230:231], v7 offset:51712
    ds_read_b64_tr_b16 v[232:233], v204 offset:53248
    ds_read_b64_tr_b16 v[234:235], v204 offset:53760
    ds_read_b64_tr_b16 v[236:237], v7 offset:53248
    ds_read_b64_tr_b16 v[238:239], v7 offset:53760
    ds_read_b64_tr_b16 v[240:241], v204 offset:55296
    ds_read_b64_tr_b16 v[242:243], v204 offset:55808
    ds_read_b64_tr_b16 v[244:245], v7 offset:55296
    ds_read_b64_tr_b16 v[246:247], v7 offset:55808
    s_barrier
    v_add_u32 v212, 16384, v208
    v_add_u32 v213, 16384, v209
    v_add_u32 v214, 16384, v210
    v_add_u32 v215, 16384, v211
    s_waitcnt lgkmcnt(14)
    v_mfma_f32_32x32x16_bf16 v[128:143], v[216:219], v[16:19], 0
    ds_read_b128 v[32:35], v212
    ds_read_b128 v[36:39], v213
    ds_read_b128 v[40:43], v214
    s_waitcnt lgkmcnt(15)
    v_mfma_f32_32x32x16_bf16 v[144:159], v[220:223], v[16:19], 0
    ds_read_b128 v[44:47], v215
    ds_read_b64_tr_b16 v[160:161], v204 offset:57344
    ds_read_b64_tr_b16 v[162:163], v204 offset:57856
    s_waitcnt lgkmcnt(15)
    v_mfma_f32_32x32x16_bf16 v[128:143], v[224:227], v[20:23], v[128:143]
    ds_read_b64_tr_b16 v[164:165], v7 offset:57344
    ds_read_b64_tr_b16 v[166:167], v7 offset:57856
    ds_read_b64_tr_b16 v[168:169], v204 offset:59392
    s_waitcnt lgkmcnt(15)
    v_mfma_f32_32x32x16_bf16 v[144:159], v[228:231], v[20:23], v[144:159]
    ds_read_b64_tr_b16 v[170:171], v204 offset:59904
    ds_read_b64_tr_b16 v[172:173], v7 offset:59392
    ds_read_b64_tr_b16 v[174:175], v7 offset:59904
    s_waitcnt lgkmcnt(15)
    v_mfma_f32_32x32x16_bf16 v[128:143], v[232:235], v[24:27], v[128:143]
    ds_read_b64_tr_b16 v[176:177], v204 offset:61440
    ds_read_b64_tr_b16 v[178:179], v204 offset:61952
    s_waitcnt lgkmcnt(15)
    v_mfma_f32_32x32x16_bf16 v[144:159], v[236:239], v[24:27], v[144:159]
    ds_read_b64_tr_b16 v[180:181], v7 offset:61440
    ds_read_b64_tr_b16 v[182:183], v7 offset:61952
    s_waitcnt lgkmcnt(15)
    v_mfma_f32_32x32x16_bf16 v[128:143], v[240:243], v[28:31], v[128:143]
    ds_read_b64_tr_b16 v[184:185], v204 offset:63488
    ds_read_b64_tr_b16 v[186:187], v204 offset:64000
    s_waitcnt lgkmcnt(15)
    v_mfma_f32_32x32x16_bf16 v[144:159], v[244:247], v[28:31], v[144:159]
    ds_read_b64_tr_b16 v[188:189], v7 offset:63488
    ds_read_b64_tr_b16 v[190:191], v7 offset:64000
    s_barrier
    v_add_u32 v212, 32768, v208
    v_add_u32 v213, 32768, v209
    v_add_u32 v214, 32768, v210
    v_add_u32 v215, 32768, v211
    s_waitcnt lgkmcnt(14)
    v_mfma_f32_32x32x16_bf16 v[128:143], v[160:163], v[32:35], v[128:143]
    ds_read_b128 v[48:51], v212
    ds_read_b128 v[52:55], v213
    ds_read_b128 v[56:59], v214
    s_waitcnt lgkmcnt(15)
    v_mfma_f32_32x32x16_bf16 v[144:159], v[164:167], v[32:35], v[144:159]
    ds_read_b128 v[60:63], v215
    ds_read_b64_tr_b16 v[216:217], v205 offset:0
    ds_read_b64_tr_b16 v[218:219], v205 offset:512
    s_waitcnt lgkmcnt(15)
    v_mfma_f32_32x32x16_bf16 v[128:143], v[168:171], v[36:39], v[128:143]
    ds_read_b64_tr_b16 v[220:221], v8 offset:0
    ds_read_b64_tr_b16 v[222:223], v8 offset:512
    ds_read_b64_tr_b16 v[224:225], v205 offset:2048
    s_waitcnt lgkmcnt(15)
    v_mfma_f32_32x32x16_bf16 v[144:159], v[172:175], v[36:39], v[144:159]
    ds_read_b64_tr_b16 v[226:227], v205 offset:2560
    ds_read_b64_tr_b16 v[228:229], v8 offset:2048
    ds_read_b64_tr_b16 v[230:231], v8 offset:2560
    s_waitcnt lgkmcnt(15)
    v_mfma_f32_32x32x16_bf16 v[128:143], v[176:179], v[40:43], v[128:143]
    ds_read_b64_tr_b16 v[232:233], v205 offset:4096
    ds_read_b64_tr_b16 v[234:235], v205 offset:4608
    s_waitcnt lgkmcnt(15)
    v_mfma_f32_32x32x16_bf16 v[144:159], v[180:183], v[40:43], v[144:159]
    ds_read_b64_tr_b16 v[236:237], v8 offset:4096
    ds_read_b64_tr_b16 v[238:239], v8 offset:4608
    s_waitcnt lgkmcnt(15)
    v_mfma_f32_32x32x16_bf16 v[128:143], v[184:187], v[44:47], v[128:143]
    ds_read_b64_tr_b16 v[240:241], v205 offset:6144
    ds_read_b64_tr_b16 v[242:243], v205 offset:6656
    s_waitcnt lgkmcnt(15)
    v_mfma_f32_32x32x16_bf16 v[144:159], v[188:191], v[44:47], v[144:159]
    ds_read_b64_tr_b16 v[244:245], v8 offset:6144
    ds_read_b64_tr_b16 v[246:247], v8 offset:6656
    s_barrier
    v_add_u32 v212, 49152, v208
    v_add_u32 v213, 49152, v209
    v_add_u32 v214, 49152, v210
    v_add_u32 v215, 49152, v211
    s_waitcnt lgkmcnt(14)
    v_mfma_f32_32x32x16_bf16 v[128:143], v[216:219], v[48:51], v[128:143]
    ds_read_b128 v[64:67], v212
    ds_read_b128 v[68:71], v213
    ds_read_b128 v[72:75], v214
    s_waitcnt lgkmcnt(15)
    v_mfma_f32_32x32x16_bf16 v[144:159], v[220:223], v[48:51], v[144:159]
    ds_read_b128 v[76:79], v215
    ds_read_b64_tr_b16 v[160:161], v205 offset:8192
    ds_read_b64_tr_b16 v[162:163], v205 offset:8704
    s_waitcnt lgkmcnt(15)
    v_mfma_f32_32x32x16_bf16 v[128:143], v[224:227], v[52:55], v[128:143]
    ds_read_b64_tr_b16 v[164:165], v8 offset:8192
    ds_read_b64_tr_b16 v[166:167], v8 offset:8704
    ds_read_b64_tr_b16 v[168:169], v205 offset:10240
    s_waitcnt lgkmcnt(15)
    v_mfma_f32_32x32x16_bf16 v[144:159], v[228:231], v[52:55], v[144:159]
    ds_read_b64_tr_b16 v[170:171], v205 offset:10752
    ds_read_b64_tr_b16 v[172:173], v8 offset:10240
    ds_read_b64_tr_b16 v[174:175], v8 offset:10752
    s_waitcnt lgkmcnt(15)
    v_mfma_f32_32x32x16_bf16 v[128:143], v[232:235], v[56:59], v[128:143]
    ds_read_b64_tr_b16 v[176:177], v205 offset:12288
    ds_read_b64_tr_b16 v[178:179], v205 offset:12800
    s_waitcnt lgkmcnt(15)
    v_mfma_f32_32x32x16_bf16 v[144:159], v[236:239], v[56:59], v[144:159]
    ds_read_b64_tr_b16 v[180:181], v8 offset:12288
    ds_read_b64_tr_b16 v[182:183], v8 offset:12800
    s_waitcnt lgkmcnt(15)
    v_mfma_f32_32x32x16_bf16 v[128:143], v[240:243], v[60:63], v[128:143]
    ds_read_b64_tr_b16 v[184:185], v205 offset:14336
    ds_read_b64_tr_b16 v[186:187], v205 offset:14848
    s_waitcnt lgkmcnt(15)
    v_mfma_f32_32x32x16_bf16 v[144:159], v[244:247], v[60:63], v[144:159]
    ds_read_b64_tr_b16 v[188:189], v8 offset:14336
    ds_read_b64_tr_b16 v[190:191], v8 offset:14848
    s_barrier
    v_add_u32 v212, 65536, v208
    v_add_u32 v213, 65536, v209
    v_add_u32 v214, 65536, v210
    v_add_u32 v215, 65536, v211
    s_waitcnt lgkmcnt(14)
    v_mfma_f32_32x32x16_bf16 v[128:143], v[160:163], v[64:67], v[128:143]
    ds_read_b128 v[80:83], v212
    ds_read_b128 v[84:87], v213
    ds_read_b128 v[88:91], v214
    s_waitcnt lgkmcnt(15)
    v_mfma_f32_32x32x16_bf16 v[144:159], v[164:167], v[64:67], v[144:159]
    ds_read_b128 v[92:95], v215
    ds_read_b64_tr_b16 v[216:217], v205 offset:16384
    ds_read_b64_tr_b16 v[218:219], v205 offset:16896
    s_waitcnt lgkmcnt(15)
    v_mfma_f32_32x32x16_bf16 v[128:143], v[168:171], v[68:71], v[128:143]
    ds_read_b64_tr_b16 v[220:221], v8 offset:16384
    ds_read_b64_tr_b16 v[222:223], v8 offset:16896
    ds_read_b64_tr_b16 v[224:225], v205 offset:18432
    s_waitcnt lgkmcnt(15)
    v_mfma_f32_32x32x16_bf16 v[144:159], v[172:175], v[68:71], v[144:159]
    ds_read_b64_tr_b16 v[226:227], v205 offset:18944
    ds_read_b64_tr_b16 v[228:229], v8 offset:18432
    ds_read_b64_tr_b16 v[230:231], v8 offset:18944
    s_waitcnt lgkmcnt(15)
    v_mfma_f32_32x32x16_bf16 v[128:143], v[176:179], v[72:75], v[128:143]
    ds_read_b64_tr_b16 v[232:233], v205 offset:20480
    ds_read_b64_tr_b16 v[234:235], v205 offset:20992
    s_waitcnt lgkmcnt(15)
    v_mfma_f32_32x32x16_bf16 v[144:159], v[180:183], v[72:75], v[144:159]
    ds_read_b64_tr_b16 v[236:237], v8 offset:20480
    ds_read_b64_tr_b16 v[238:239], v8 offset:20992
    s_waitcnt lgkmcnt(15)
    v_mfma_f32_32x32x16_bf16 v[128:143], v[184:187], v[76:79], v[128:143]
    ds_read_b64_tr_b16 v[240:241], v205 offset:22528
    ds_read_b64_tr_b16 v[242:243], v205 offset:23040
    s_waitcnt lgkmcnt(15)
    v_mfma_f32_32x32x16_bf16 v[144:159], v[188:191], v[76:79], v[144:159]
    ds_read_b64_tr_b16 v[244:245], v8 offset:22528
    ds_read_b64_tr_b16 v[246:247], v8 offset:23040
    s_barrier
    v_add_u32 v212, 81920, v208
    v_add_u32 v213, 81920, v209
    v_add_u32 v214, 81920, v210
    v_add_u32 v215, 81920, v211
    s_waitcnt lgkmcnt(14)
    v_mfma_f32_32x32x16_bf16 v[128:143], v[216:219], v[80:83], v[128:143]
    ds_read_b128 v[96:99], v212
    ds_read_b128 v[100:103], v213
    ds_read_b128 v[104:107], v214
    s_waitcnt lgkmcnt(15)
    v_mfma_f32_32x32x16_bf16 v[144:159], v[220:223], v[80:83], v[144:159]
    ds_read_b128 v[108:111], v215
    ds_read_b64_tr_b16 v[160:161], v205 offset:24576
    ds_read_b64_tr_b16 v[162:163], v205 offset:25088
    s_waitcnt lgkmcnt(15)
    v_mfma_f32_32x32x16_bf16 v[128:143], v[224:227], v[84:87], v[128:143]
    ds_read_b64_tr_b16 v[164:165], v8 offset:24576
    ds_read_b64_tr_b16 v[166:167], v8 offset:25088
    ds_read_b64_tr_b16 v[168:169], v205 offset:26624
    s_waitcnt lgkmcnt(15)
    v_mfma_f32_32x32x16_bf16 v[144:159], v[228:231], v[84:87], v[144:159]
    ds_read_b64_tr_b16 v[170:171], v205 offset:27136
    ds_read_b64_tr_b16 v[172:173], v8 offset:26624
    ds_read_b64_tr_b16 v[174:175], v8 offset:27136
    s_waitcnt lgkmcnt(15)
    v_mfma_f32_32x32x16_bf16 v[128:143], v[232:235], v[88:91], v[128:143]
    ds_read_b64_tr_b16 v[176:177], v205 offset:28672
    ds_read_b64_tr_b16 v[178:179], v205 offset:29184
    s_waitcnt lgkmcnt(15)
    v_mfma_f32_32x32x16_bf16 v[144:159], v[236:239], v[88:91], v[144:159]
    ds_read_b64_tr_b16 v[180:181], v8 offset:28672
    ds_read_b64_tr_b16 v[182:183], v8 offset:29184
    s_waitcnt lgkmcnt(15)
    v_mfma_f32_32x32x16_bf16 v[128:143], v[240:243], v[92:95], v[128:143]
    ds_read_b64_tr_b16 v[184:185], v205 offset:30720
    ds_read_b64_tr_b16 v[186:187], v205 offset:31232
    s_waitcnt lgkmcnt(15)
    v_mfma_f32_32x32x16_bf16 v[144:159], v[244:247], v[92:95], v[144:159]
    ds_read_b64_tr_b16 v[188:189], v8 offset:30720
    ds_read_b64_tr_b16 v[190:191], v8 offset:31232
    s_barrier
    v_add_u32 v212, 98304, v208
    v_add_u32 v213, 98304, v209
    v_add_u32 v214, 98304, v210
    v_add_u32 v215, 98304, v211
    s_waitcnt lgkmcnt(14)
    v_mfma_f32_32x32x16_bf16 v[128:143], v[160:163], v[96:99], v[128:143]
    ds_read_b128 v[112:115], v212
    ds_read_b128 v[116:119], v213
    ds_read_b128 v[120:123], v214
    s_waitcnt lgkmcnt(15)
    v_mfma_f32_32x32x16_bf16 v[144:159], v[164:167], v[96:99], v[144:159]
    ds_read_b128 v[124:127], v215
    ds_read_b64_tr_b16 v[216:217], v204 offset:49152
    ds_read_b64_tr_b16 v[218:219], v204 offset:49664
    s_waitcnt lgkmcnt(15)
    v_mfma_f32_32x32x16_bf16 v[128:143], v[168:171], v[100:103], v[128:143]
    ds_read_b64_tr_b16 v[220:221], v7 offset:49152
    ds_read_b64_tr_b16 v[222:223], v7 offset:49664
    ds_read_b64_tr_b16 v[224:225], v204 offset:51200
    s_waitcnt lgkmcnt(15)
    v_mfma_f32_32x32x16_bf16 v[144:159], v[172:175], v[100:103], v[144:159]
    ds_read_b64_tr_b16 v[226:227], v204 offset:51712
    ds_read_b64_tr_b16 v[228:229], v7 offset:51200
    ds_read_b64_tr_b16 v[230:231], v7 offset:51712
    s_waitcnt lgkmcnt(15)
    v_mfma_f32_32x32x16_bf16 v[128:143], v[176:179], v[104:107], v[128:143]
    ds_read_b64_tr_b16 v[232:233], v204 offset:53248
    ds_read_b64_tr_b16 v[234:235], v204 offset:53760
    s_waitcnt lgkmcnt(15)
    v_mfma_f32_32x32x16_bf16 v[144:159], v[180:183], v[104:107], v[144:159]
    ds_read_b64_tr_b16 v[236:237], v7 offset:53248
    ds_read_b64_tr_b16 v[238:239], v7 offset:53760
    s_waitcnt lgkmcnt(15)
    v_mfma_f32_32x32x16_bf16 v[128:143], v[184:187], v[108:111], v[128:143]
    ds_read_b64_tr_b16 v[240:241], v204 offset:55296
    ds_read_b64_tr_b16 v[242:243], v204 offset:55808
    s_waitcnt lgkmcnt(15)
    v_mfma_f32_32x32x16_bf16 v[144:159], v[188:191], v[108:111], v[144:159]
    ds_read_b64_tr_b16 v[244:245], v7 offset:55296
    ds_read_b64_tr_b16 v[246:247], v7 offset:55808
L_g0j78:
    s_cmp_ge_u32 s58, 4
    s_cbranch_scc1 L_vw79
    s_waitcnt vmcnt(14)
L_vw79:
    s_barrier
    buffer_load_dword v200, v14, s[48:51], 0 offen sc1
    ds_read_b64_tr_b16 v[160:161], v6 offset:0
    ds_read_b64_tr_b16 v[162:163], v6 offset:512
    ds_read_b64_tr_b16 v[164:165], v6 offset:2048
    ds_read_b64_tr_b16 v[166:167], v6 offset:2560
    ds_read_b64_tr_b16 v[168:169], v6 offset:4096
    ds_read_b64_tr_b16 v[170:171], v6 offset:4608
    ds_read_b64_tr_b16 v[172:173], v6 offset:6144
    ds_read_b64_tr_b16 v[174:175], v6 offset:6656
    s_cmp_ge_u32 s58, 4
    s_cbranch_scc1 L_e081
    v_lshrrev_b32 v204, 5, v1
    v_and_b32 v205, 31, v1
    s_and_b32 s60, s2, 7
    s_lshr_b32 s61, s2, 3
    s_and_b32 s82, s61, 1
    s_lshl_b32 s82, s82, 3
    s_add_u32 s82, s82, s60
    s_lshr_b32 s83, s61, 1
    s_mul_i32 s89, s82, 7
    s_lshr_b32 s89, s89, 1
    v_lshlrev_b32 v240, 4, v205
    v_lshl_add_u32 v240, v204, 15, v240
    s_mul_i32 s60, s82, 448
    v_add_u32 v241, s60, v10
    s_mov_b32 s87, 0x4e800000
    s_add_u32 s4, s89, 56
    s_lshl_b32 s4, s4, 15
    s_lshl_b32 s5, s58, 13
    s_add_u32 s4, s4, s5
    s_mov_b32 s85, s4
    v_add_u32 v248, s4, v240
    v_mov_b32 v250, v240
    v_mov_b32 v240, v248
    v_add_u32 v248, 65536, v248
    v_add_u32 v249, 14336, v241
    v_lshlrev_b32 v206, 4, v205
    v_add_u32 v206, 28224, v206
    v_cmp_gt_u32 vcc, 28, v205
    s_nop 1
    v_cndmask_b32 v241, v206, v241, vcc
    v_cndmask_b32 v249, v206, v249, vcc
    s_mul_i32 s4, s58, 466944
    s_add_u32 s4, s4, 16777216
    v_add_u32 v241, s4, v241
    v_add_u32 v249, s4, v249
    s_lshl_b32 s84, s83, 9
    s_mul_i32 s86, s84, 57
    s_and_b32 s60, s82, 1
    v_cmp_le_u32 vcc, s60, v204
    s_nop 1
    v_cndmask_b32 v244, 0, -1, vcc
    v_cmp_ge_u32 vcc, s60, v204
    s_nop 1
    v_cndmask_b32 v245, 0, -1, vcc
    s_add_u32 s4, s89, 56
    s_lshr_b32 s4, s4, 2
    s_add_u32 s5, s89, 59
    s_lshr_b32 s5, s5, 2
    s_mul_i32 s6, s82, 28
    s_add_u32 s7, s6, 27
    s_lshr_b32 s6, s6, 5
    s_lshr_b32 s7, s7, 5
    s_add_u32 s6, s6, 28
    s_add_u32 s7, s7, 28
    v_mov_b32 v242, s7
    v_mov_b32 v206, s6
    v_cmp_gt_u32 vcc, 48, v1
    s_nop 1
    v_cndmask_b32 v242, v242, v206, vcc
    v_mov_b32 v206, s5
    v_cmp_gt_u32 vcc, 32, v1
    s_nop 1
    v_cndmask_b32 v242, v242, v206, vcc
    v_mov_b32 v206, s4
    v_cmp_gt_u32 vcc, 16, v1
    s_nop 1
    v_cndmask_b32 v242, v242, v206, vcc
    v_and_b32 v206, 15, v1
    v_lshl_add_u32 v242, v242, 6, v206
    s_lshl_b32 s4, s58, 4
    v_add_u32 v242, s4, v242
    v_lshlrev_b32 v242, 3, v242
    s_lshr_b32 s4, s89, 2
    s_add_u32 s5, s89, 3
    s_lshr_b32 s5, s5, 2
    s_lshl_b32 s6, s83, 2
    v_and_b32 v206, 3, v1
    v_add_u32 v206, s6, v206
    v_mov_b32 v243, s5
    v_mov_b32 v12, s4
    v_cmp_gt_u32 vcc, 4, v1
    s_nop 1
    v_cndmask_b32 v243, v243, v12, vcc
    v_lshl_add_u32 v243, v243, 6, v206
    v_lshlrev_b32 v243, 3, v243
    v_lshlrev_b32 v206, 9, v206
    v_add_u32 v206, 25024, v206
    v_cmp_gt_u32 vcc, 8, v1
    s_nop 1
    v_cndmask_b32 v243, v206, v243, vcc
    s_branch L_e080
L_e081:
    s_waitcnt lgkmcnt(15)
    v_mfma_f32_32x32x16_bf16 v[128:143], v[216:219], v[112:115], v[128:143]
    s_waitcnt lgkmcnt(15)
    v_mfma_f32_32x32x16_bf16 v[144:159], v[220:223], v[112:115], v[144:159]
    s_waitcnt lgkmcnt(15)
    v_mfma_f32_32x32x16_bf16 v[128:143], v[224:227], v[116:119], v[128:143]
    s_waitcnt lgkmcnt(15)
    v_mfma_f32_32x32x16_bf16 v[144:159], v[228:231], v[116:119], v[144:159]
    s_waitcnt lgkmcnt(14)
    v_mfma_f32_32x32x16_bf16 v[128:143], v[232:235], v[120:123], v[128:143]
    s_waitcnt lgkmcnt(12)
    v_mfma_f32_32x32x16_bf16 v[144:159], v[236:239], v[120:123], v[144:159]
    s_waitcnt lgkmcnt(10)
    v_mfma_f32_32x32x16_bf16 v[128:143], v[240:243], v[124:127], v[128:143]
    s_waitcnt lgkmcnt(8)
    v_mfma_f32_32x32x16_bf16 v[144:159], v[244:247], v[124:127], v[144:159]
    s_nop 9
    v_mul_f32 v128, s74, v128
    v_mul_f32 v129, s74, v129
    v_mul_f32 v130, s74, v130
    v_mul_f32 v131, s74, v131
    v_mul_f32 v132, s74, v132
    v_mul_f32 v133, s74, v133
    v_mul_f32 v134, s74, v134
    v_mul_f32 v135, s74, v135
    v_mul_f32 v136, s74, v136
    v_mul_f32 v137, s74, v137
    v_mul_f32 v138, s74, v138
    v_mul_f32 v139, s74, v139
    v_mul_f32 v140, s74, v140
    v_mul_f32 v141, s74, v141
    v_mul_f32 v142, s74, v142
    v_mul_f32 v143, s74, v143
    v_cvt_pk_bf16_f32 v192, v128, v129
    v_cvt_pk_bf16_f32 v193, v130, v131
    v_cvt_pk_bf16_f32 v194, v132, v133
    v_cvt_pk_bf16_f32 v195, v134, v135
    v_cvt_pk_bf16_f32 v196, v136, v137
    v_cvt_pk_bf16_f32 v197, v138, v139
    v_cvt_pk_bf16_f32 v198, v140, v141
    v_cvt_pk_bf16_f32 v199, v142, v143
    v_permlane32_swap_b32 v192, v194
    v_permlane32_swap_b32 v193, v195
    s_add_u32 s60, s70, 0
    buffer_store_dwordx4 v[192:195], v9, s[24:27], s60 offen sc1
    v_permlane32_swap_b32 v196, v198
    v_permlane32_swap_b32 v197, v199
    s_add_u32 s60, s70, 65536
    buffer_store_dwordx4 v[196:199], v9, s[24:27], s60 offen sc1
    s_add_u32 s70, s70, 131072
    v_mul_f32 v144, s74, v144
    v_mul_f32 v145, s74, v145
    v_mul_f32 v146, s74, v146
    v_mul_f32 v147, s74, v147
    v_mul_f32 v148, s74, v148
    v_mul_f32 v149, s74, v149
    v_mul_f32 v150, s74, v150
    v_mul_f32 v151, s74, v151
    v_mul_f32 v152, s74, v152
    v_mul_f32 v153, s74, v153
    v_mul_f32 v154, s74, v154
    v_mul_f32 v155, s74, v155
    v_mul_f32 v156, s74, v156
    v_mul_f32 v157, s74, v157
    v_mul_f32 v158, s74, v158
    v_mul_f32 v159, s74, v159
    v_cvt_pk_bf16_f32 v192, v144, v145
    v_cvt_pk_bf16_f32 v193, v146, v147
    v_cvt_pk_bf16_f32 v194, v148, v149
    v_cvt_pk_bf16_f32 v195, v150, v151
    v_cvt_pk_bf16_f32 v196, v152, v153
    v_cvt_pk_bf16_f32 v197, v154, v155
    v_cvt_pk_bf16_f32 v198, v156, v157
    v_cvt_pk_bf16_f32 v199, v158, v159
    v_permlane32_swap_b32 v192, v194
    v_permlane32_swap_b32 v193, v195
    s_add_u32 s60, s70, 0
    buffer_store_dwordx4 v[192:195], v9, s[24:27], s60 offen sc1
    v_permlane32_swap_b32 v196, v198
    v_permlane32_swap_b32 v197, v199
    s_add_u32 s60, s70, 65536
    buffer_store_dwordx4 v[196:199], v9, s[24:27], s60 offen sc1
L_e080:
    s_waitcnt lgkmcnt(6)
    v_mfma_f32_32x32x16_bf16 v[128:143], v[160:163], v[16:19], 0
    ds_read_b64_tr_b16 v[176:177], v6 offset:8192
    ds_read_b64_tr_b16 v[178:179], v6 offset:8704
    s_waitcnt lgkmcnt(6)
    v_mfma_f32_32x32x16_bf16 v[128:143], v[164:167], v[20:23], v[128:143]
    ds_read_b64_tr_b16 v[180:181], v6 offset:10240
    ds_read_b64_tr_b16 v[182:183], v6 offset:10752
    s_waitcnt lgkmcnt(6)
    v_mfma_f32_32x32x16_bf16 v[128:143], v[168:171], v[24:27], v[128:143]
    ds_read_b64_tr_b16 v[184:185], v6 offset:12288
    ds_read_b64_tr_b16 v[186:187], v6 offset:12800
    s_waitcnt lgkmcnt(6)
    v_mfma_f32_32x32x16_bf16 v[128:143], v[172:175], v[28:31], v[128:143]
    ds_read_b64_tr_b16 v[188:189], v6 offset:14336
    ds_read_b64_tr_b16 v[190:191], v6 offset:14848
    s_waitcnt lgkmcnt(6)
    v_mfma_f32_32x32x16_bf16 v[128:143], v[176:179], v[32:35], v[128:143]
    s_cmp_ge_u32 s58, 4
    s_cbranch_scc1 L_vw82
    s_waitcnt vmcnt(11)
L_vw82:
    s_barrier
    ds_read_b64_tr_b16 v[160:161], v7 offset:57344
    ds_read_b64_tr_b16 v[162:163], v7 offset:57856
    s_waitcnt lgkmcnt(6)
    v_mfma_f32_32x32x16_bf16 v[128:143], v[180:183], v[36:39], v[128:143]
    s_add_u32 m0, s59, 49152
    s_bfe_u32 s96, s75, 0x40004
    s_mul_i32 s96, s96, 229376
    s_add_u32 s96, s96, s68
    buffer_load_dwordx4 v3, s[16:19], s96 offen lds
    ds_read_b64_tr_b16 v[164:165], v7 offset:59392
    ds_read_b64_tr_b16 v[166:167], v7 offset:59904
    s_waitcnt lgkmcnt(6)
    v_mfma_f32_32x32x16_bf16 v[128:143], v[184:187], v[40:43], v[128:143]
    ds_read_b64_tr_b16 v[168:169], v7 offset:61440
    ds_read_b64_tr_b16 v[170:171], v7 offset:61952
    s_waitcnt lgkmcnt(6)
    v_mfma_f32_32x32x16_bf16 v[128:143], v[188:191], v[44:47], v[128:143]
    ds_read_b64_tr_b16 v[172:173], v7 offset:63488
    ds_read_b64_tr_b16 v[174:175], v7 offset:64000
    s_waitcnt lgkmcnt(6)
    v_mfma_f32_32x32x16_bf16 v[128:143], v[160:163], v[48:51], v[128:143]
    ds_read_b64_tr_b16 v[176:177], v6 offset:16384
    ds_read_b64_tr_b16 v[178:179], v6 offset:16896
    s_waitcnt lgkmcnt(6)
    v_mfma_f32_32x32x16_bf16 v[128:143], v[164:167], v[52:55], v[128:143]
    s_add_u32 m0, s59, 57344
    s_nop 0
    buffer_load_dwordx4 v3, s[20:23], s96 offen lds
    ds_read_b64_tr_b16 v[180:181], v6 offset:18432
    ds_read_b64_tr_b16 v[182:183], v6 offset:18944
    s_waitcnt lgkmcnt(6)
    v_mfma_f32_32x32x16_bf16 v[128:143], v[168:171], v[56:59], v[128:143]
    ds_read_b64_tr_b16 v[184:185], v6 offset:20480
    ds_read_b64_tr_b16 v[186:187], v6 offset:20992
    s_waitcnt lgkmcnt(6)
    v_mfma_f32_32x32x16_bf16 v[128:143], v[172:175], v[60:63], v[128:143]
    ds_read_b64_tr_b16 v[188:189], v6 offset:22528
    ds_read_b64_tr_b16 v[190:191], v6 offset:23040
    s_waitcnt lgkmcnt(6)
    v_mfma_f32_32x32x16_bf16 v[128:143], v[176:179], v[64:67], v[128:143]
    s_cmp_ge_u32 s58, 4
    s_cbranch_scc1 L_vw83
    s_waitcnt vmcnt(9)
L_vw83:
    s_barrier
    ds_read_b64_tr_b16 v[160:161], v6 offset:24576
    ds_read_b64_tr_b16 v[162:163], v6 offset:25088
    s_waitcnt lgkmcnt(6)
    v_mfma_f32_32x32x16_bf16 v[128:143], v[180:183], v[68:71], v[128:143]
    s_add_u32 m0, s59, 147456
    s_bfe_u32 s96, s75, 0x40008
    s_mul_i32 s96, s96, 229376
    s_add_u32 s96, s96, s68
    buffer_load_dwordx4 v3, s[16:19], s96 offen lds
    ds_read_b64_tr_b16 v[164:165], v6 offset:26624
    ds_read_b64_tr_b16 v[166:167], v6 offset:27136
    s_waitcnt lgkmcnt(6)
    v_mfma_f32_32x32x16_bf16 v[128:143], v[184:187], v[72:75], v[128:143]
    ds_read_b64_tr_b16 v[168:169], v6 offset:28672
    ds_read_b64_tr_b16 v[170:171], v6 offset:29184
    s_waitcnt lgkmcnt(6)
    v_mfma_f32_32x32x16_bf16 v[128:143], v[188:191], v[76:79], v[128:143]
    ds_read_b64_tr_b16 v[172:173], v6 offset:30720
    ds_read_b64_tr_b16 v[174:175], v6 offset:31232
    s_waitcnt lgkmcnt(6)
    v_mfma_f32_32x32x16_bf16 v[128:143], v[160:163], v[80:83], v[128:143]
    ds_read_b64_tr_b16 v[176:177], v8 offset:0
    ds_read_b64_tr_b16 v[178:179], v8 offset:512
    s_waitcnt lgkmcnt(6)
    v_mfma_f32_32x32x16_bf16 v[128:143], v[164:167], v[84:87], v[128:143]
    s_add_u32 m0, s59, 65536
    s_nop 0
    buffer_load_dwordx4 v3, s[20:23], s96 offen lds
    ds_read_b64_tr_b16 v[180:181], v8 offset:2048
    ds_read_b64_tr_b16 v[182:183], v8 offset:2560
    s_waitcnt lgkmcnt(6)
    v_mfma_f32_32x32x16_bf16 v[128:143], v[168:171], v[88:91], v[128:143]
    ds_read_b64_tr_b16 v[184:185], v8 offset:4096
    ds_read_b64_tr_b16 v[186:187], v8 offset:4608
    s_waitcnt lgkmcnt(6)
    v_mfma_f32_32x32x16_bf16 v[128:143], v[172:175], v[92:95], v[128:143]
    ds_read_b64_tr_b16 v[188:189], v8 offset:6144
    ds_read_b64_tr_b16 v[190:191], v8 offset:6656
    s_waitcnt lgkmcnt(6)
    v_mfma_f32_32x32x16_bf16 v[128:143], v[176:179], v[96:99], v[128:143]
    s_waitcnt vmcnt(4)
    s_barrier
    v_readfirstlane_b32 s76, v200
    s_nop 0
    s_cmp_lg_u32 s76, 0
    s_cbranch_scc1 L_tagok84
    s_mov_b32 s52, 0x8000
L_tagspin85:
    buffer_load_dword v200, v14, s[48:51], 0 offen sc1
    s_waitcnt vmcnt(0)
    v_readfirstlane_b32 s76, v200
    s_nop 0
    s_cmp_lg_u32 s76, 0
    s_cbranch_scc1 L_tagok84
    s_sleep 2
    s_sub_u32 s52, s52, 1
    s_cmp_lg_u32 s52, 0
    s_cbranch_scc1 L_tagspin85
L_tagok84:
    s_xor_b32 s77, s76, 0x5bd1e995
    v_mov_b32 v222, s76
    v_mov_b32 v223, s77
    s_cmp_lt_u32 s58, 4
    s_cbranch_scc1 L_p086
    s_add_u32 s60, s78, 512
    s_mov_b64 exec, 1
    buffer_store_dwordx2 v[222:223], v14, s[24:27], s78 offen sc1
    s_mov_b64 exec, -1
    s_mov_b64 exec, 1
    buffer_store_dwordx2 v[222:223], v14, s[24:27], s60 offen sc1
    s_mov_b64 exec, -1
L_p086:
    s_cmp_lt_u32 s58, 4
    s_cbranch_scc1 L_rdone87
    v_lshrrev_b32 v204, 5, v1
    v_and_b32 v205, 31, v1
    s_and_b32 s60, s2, 7
    s_lshr_b32 s61, s2, 3
    s_mul_i32 s82, s61, 37
    s_lshr_b32 s82, s82, 8
    s_mul_i32 s83, s82, 7
    s_sub_u32 s83, s61, s83
    s_lshl_b32 s60, s60, 2
    s_add_u32 s82, s82, s60
    s_and_b32 s60, s58, 3
    s_mul_i32 s87, s60, 26624
    v_lshrrev_b32 v206, 3, v1
    v_mul_u32_u24 v240, 896, v206
    v_and_b32 v206, 7, v1
    v_bfe_u32 v12, v1, 4, 1
    v_lshlrev_b32 v12, 2, v12
    v_xor_b32 v206, v206, v12
    v_lshl_add_u32 v240, v206, 4, v240
    v_bfe_u32 v206, v1, 2, 2
    v_lshl_add_u32 v12, v204, 2, v206
    v_lshlrev_b32 v242, 7, v12
    v_lshrrev_b32 v206, 1, v206
    v_lshl_add_u32 v242, v206, 6, v242
    v_bfe_u32 v206, v1, 4, 1
    v_lshl_add_u32 v242, v206, 5, v242
    v_and_b32 v206, 3, v1
    v_lshl_add_u32 v242, v206, 3, v242
    v_xor_b32 v243, 64, v242
    v_add_u32 v242, s87, v242
    v_add_u32 v243, s87, v243
    s_and_b32 s4, s82, 3
    s_lshl_b32 s4, s4, 1
    s_add_u32 s6, s4, s83
    s_cmp_ge_u32 s6, 7
    s_cselect_b32 s4, 7, 0
    s_sub_u32 s6, s6, s4
    s_lshl_b32 s6, s6, 2
    s_mov_b32 s4, 0x6543210
    s_mov_b32 s5, 0x654321
    s_lshr_b64 s[4:5], s[4:5], s6
    s_mov_b32 s88, s4
    s_mul_i32 s4, s60, 14
    v_add_u32 v206, s4, v205
    v_cmp_gt_u32 vcc, 14, v205
    s_nop 1
    v_cndmask_b32 v206, 56, v206, vcc
    s_lshl_b32 s5, s82, 1
    v_add_u32 v12, s5, v204
    v_lshl_add_u32 v244, v12, 6, v206
    v_lshlrev_b32 v244, 3, v244
    v_add_u32 v244, 24576, v244
    s_lshl_b32 s4, s60, 2
    v_and_b32 v206, 3, v1
    v_add_u32 v206, s4, v206
    v_lshl_add_u32 v245, v12, 4, v206
    v_lshlrev_b32 v245, 3, v245
    v_add_u32 v245, 57344, v245
L_rdone87:
    ds_read_b64_tr_b16 v[160:161], v6 offset:32768
    ds_read_b64_tr_b16 v[162:163], v6 offset:33280
    s_waitcnt lgkmcnt(6)
    v_mfma_f32_32x32x16_bf16 v[128:143], v[180:183], v[100:103], v[128:143]
    s_add_u32 m0, s59, 73728
    s_bfe_u32 s96, s75, 0x4000c
    s_mul_i32 s96, s96, 229376
    s_add_u32 s96, s96, s68
    buffer_load_dwordx4 v3, s[16:19], s96 offen lds
    ds_read_b64_tr_b16 v[164:165], v6 offset:34816
    ds_read_b64_tr_b16 v[166:167], v6 offset:35328
    s_waitcnt lgkmcnt(6)
    v_mfma_f32_32x32x16_bf16 v[128:143], v[184:187], v[104:107], v[128:143]
    ds_read_b64_tr_b16 v[168:169], v6 offset:36864
    ds_read_b64_tr_b16 v[170:171], v6 offset:37376
    s_waitcnt lgkmcnt(6)
    v_mfma_f32_32x32x16_bf16 v[128:143], v[188:191], v[108:111], v[128:143]
    s_add_u32 m0, s59, 155648
    s_nop 0
    buffer_load_dwordx4 v3, s[20:23], s96 offen lds
    ds_read_b64_tr_b16 v[172:173], v6 offset:38912
    ds_read_b64_tr_b16 v[174:175], v6 offset:39424
    s_waitcnt lgkmcnt(6)
    v_mfma_f32_32x32x16_bf16 v[128:143], v[160:163], v[112:115], v[128:143]
    s_cmp_ge_u32 s58, 4
    s_cbranch_scc1 L_vw88
    s_waitcnt vmcnt(7)
L_vw88:
    s_barrier
    ds_read_b64_tr_b16 v[176:177], v6 offset:40960
    ds_read_b64_tr_b16 v[178:179], v6 offset:41472
    s_waitcnt lgkmcnt(6)
    v_mfma_f32_32x32x16_bf16 v[128:143], v[164:167], v[116:119], v[128:143]
    s_add_u32 m0, s59, 81920
    s_bfe_u32 s96, s75, 0x40010
    s_mul_i32 s96, s96, 229376
    s_add_u32 s96, s96, s68
    buffer_load_dwordx4 v3, s[16:19], s96 offen lds
    ds_read_b64_tr_b16 v[180:181], v8 offset:8192
    ds_read_b64_tr_b16 v[182:183], v8 offset:8704
    s_waitcnt lgkmcnt(6)
    v_mfma_f32_32x32x16_bf16 v[128:143], v[168:171], v[120:123], v[128:143]
    ds_read_b64_tr_b16 v[184:185], v6 offset:43008
    ds_read_b64_tr_b16 v[186:187], v6 offset:43520
    s_waitcnt lgkmcnt(6)
    v_mfma_f32_32x32x16_bf16 v[128:143], v[172:175], v[124:127], v[128:143]
    ds_read_b64_tr_b16 v[188:189], v8 offset:10240
    ds_read_b64_tr_b16 v[190:191], v8 offset:10752
    s_nop 9
    v_mul_f32 v128, s74, v128
    v_mul_f32 v129, s74, v129
    v_mul_f32 v130, s74, v130
    v_mul_f32 v131, s74, v131
    v_mul_f32 v132, s74, v132
    v_mul_f32 v133, s74, v133
    v_mul_f32 v134, s74, v134
    v_mul_f32 v135, s74, v135
    v_mul_f32 v136, s74, v136
    v_mul_f32 v137, s74, v137
    v_mul_f32 v138, s74, v138
    v_mul_f32 v139, s74, v139
    v_mul_f32 v140, s74, v140
    v_mul_f32 v141, s74, v141
    v_mul_f32 v142, s74, v142
    v_mul_f32 v143, s74, v143
    v_cvt_pk_bf16_f32 v192, v128, v129
    v_cvt_pk_bf16_f32 v193, v130, v131
    v_cvt_pk_bf16_f32 v194, v132, v133
    v_cvt_pk_bf16_f32 v195, v134, v135
    v_cvt_pk_bf16_f32 v196, v136, v137
    v_cvt_pk_bf16_f32 v197, v138, v139
    v_cvt_pk_bf16_f32 v198, v140, v141
    v_cvt_pk_bf16_f32 v199, v142, v143
    v_permlane32_swap_b32 v192, v194
    v_permlane32_swap_b32 v193, v195
    s_add_u32 s60, s71, 0
    buffer_store_dwordx4 v[192:195], v9, s[24:27], s60 offen sc1
    v_permlane32_swap_b32 v196, v198
    v_permlane32_swap_b32 v197, v199
    s_add_u32 s60, s71, 65536
    buffer_store_dwordx4 v[196:199], v9, s[24:27], s60 offen sc1
    s_waitcnt lgkmcnt(6)
    v_mfma_f32_32x32x16_bf16 v[128:143], v[176:179], v[16:19], 0
    ds_read_b64_tr_b16 v[160:161], v6 offset:45056
    ds_read_b64_tr_b16 v[162:163], v6 offset:45568
    s_waitcnt lgkmcnt(6)
    v_mfma_f32_32x32x16_bf16 v[144:159], v[180:183], v[16:19], 0
    s_add_u32 m0, s59, 90112
    s_nop 0
    buffer_load_dwordx4 v3, s[20:23], s96 offen lds
    ds_read_b64_tr_b16 v[164:165], v8 offset:12288
    ds_read_b64_tr_b16 v[166:167], v8 offset:12800
    s_waitcnt lgkmcnt(6)
    v_mfma_f32_32x32x16_bf16 v[128:143], v[184:187], v[20:23], v[128:143]
    ds_read_b64_tr_b16 v[168:169], v6 offset:47104
    ds_read_b64_tr_b16 v[170:171], v6 offset:47616
    s_waitcnt lgkmcnt(6)
    v_mfma_f32_32x32x16_bf16 v[144:159], v[188:191], v[20:23], v[144:159]
    ds_read_b64_tr_b16 v[172:173], v8 offset:14336
    ds_read_b64_tr_b16 v[174:175], v8 offset:14848
    s_waitcnt lgkmcnt(6)
    v_mfma_f32_32x32x16_bf16 v[128:143], v[160:163], v[24:27], v[128:143]
    s_waitcnt vmcnt(8)
    s_barrier
    s_lshl_b32 s60, s2, 13
    v_lshlrev_b32 v192, 7, v1
    s_cmp_lg_u32 s58, 0
    s_cbranch_scc1 L_pwn90
    buffer_load_dword v203, v192, s[28:31], s60 offen
L_pwn90:
    s_cmp_lg_u32 s58, 1
    s_cbranch_scc1 L_pwn91
    buffer_load_dword v203, v192, s[32:35], s60 offen
L_pwn91:
    ds_read_b64_tr_b16 v[176:177], v6 offset:49152
    ds_read_b64_tr_b16 v[178:179], v6 offset:49664
    s_waitcnt lgkmcnt(6)
    v_mfma_f32_32x32x16_bf16 v[144:159], v[164:167], v[24:27], v[144:159]
    s_add_u32 m0, s59, 114688
    s_bfe_u32 s96, s75, 0x40014
    s_mul_i32 s96, s96, 229376
    s_add_u32 s96, s96, s68
    buffer_load_dwordx4 v3, s[16:19], s96 offen lds
    ds_read_b64_tr_b16 v[180:181], v6 offset:57344
    ds_read_b64_tr_b16 v[182:183], v6 offset:57856
    s_waitcnt lgkmcnt(6)
    v_mfma_f32_32x32x16_bf16 v[128:143], v[168:171], v[28:31], v[128:143]
    ds_read_b64_tr_b16 v[184:185], v6 offset:51200
    ds_read_b64_tr_b16 v[186:187], v6 offset:51712
    s_waitcnt lgkmcnt(6)
    v_mfma_f32_32x32x16_bf16 v[144:159], v[172:175], v[28:31], v[144:159]
    ds_read_b64_tr_b16 v[188:189], v6 offset:59392
    ds_read_b64_tr_b16 v[190:191], v6 offset:59904
    s_waitcnt lgkmcnt(6)
    v_mfma_f32_32x32x16_bf16 v[128:143], v[176:179], v[32:35], v[128:143]
    ds_read_b64_tr_b16 v[160:161], v6 offset:53248
    ds_read_b64_tr_b16 v[162:163], v6 offset:53760
    s_waitcnt lgkmcnt(6)
    v_mfma_f32_32x32x16_bf16 v[144:159], v[180:183], v[32:35], v[144:159]
    s_add_u32 m0, s59, 98304
    s_nop 0
    buffer_load_dwordx4 v3, s[20:23], s96 offen lds
    ds_read_b64_tr_b16 v[164:165], v6 offset:61440
    ds_read_b64_tr_b16 v[166:167], v6 offset:61952
    s_waitcnt lgkmcnt(6)
    v_mfma_f32_32x32x16_bf16 v[128:143], v[184:187], v[36:39], v[128:143]
    ds_read_b64_tr_b16 v[168:169], v6 offset:55296
    ds_read_b64_tr_b16 v[170:171], v6 offset:55808
    s_waitcnt lgkmcnt(6)
    v_mfma_f32_32x32x16_bf16 v[144:159], v[188:191], v[36:39], v[144:159]
    ds_read_b64_tr_b16 v[172:173], v6 offset:63488
    ds_read_b64_tr_b16 v[174:175], v6 offset:64000
    s_waitcnt lgkmcnt(6)
    v_mfma_f32_32x32x16_bf16 v[128:143], v[160:163], v[40:43], v[128:143]
    s_waitcnt vmcnt(8)
    s_barrier
    ds_read_b64_tr_b16 v[176:177], v8 offset:16384
    ds_read_b64_tr_b16 v[178:179], v8 offset:16896
    s_waitcnt lgkmcnt(6)
    v_mfma_f32_32x32x16_bf16 v[144:159], v[164:167], v[40:43], v[144:159]
    s_add_u32 m0, s59, 106496
    s_bfe_u32 s96, s75, 0x40018
    s_mul_i32 s96, s96, 229376
    s_add_u32 s96, s96, s68
    buffer_load_dwordx4 v3, s[16:19], s96 offen lds
    ds_read_b64_tr_b16 v[180:181], v7 offset:0
    ds_read_b64_tr_b16 v[182:183], v7 offset:512
    s_waitcnt lgkmcnt(6)
    v_mfma_f32_32x32x16_bf16 v[128:143], v[168:171], v[44:47], v[128:143]
    ds_read_b64_tr_b16 v[184:185], v8 offset:18432
    ds_read_b64_tr_b16 v[186:187], v8 offset:18944
    s_waitcnt lgkmcnt(6)
    v_mfma_f32_32x32x16_bf16 v[144:159], v[172:175], v[44:47], v[144:159]
    ds_read_b64_tr_b16 v[188:189], v7 offset:2048
    ds_read_b64_tr_b16 v[190:191], v7 offset:2560
    s_waitcnt lgkmcnt(6)
    v_mfma_f32_32x32x16_bf16 v[128:143], v[176:179], v[48:51], v[128:143]
    ds_read_b64_tr_b16 v[160:161], v8 offset:20480
    ds_read_b64_tr_b16 v[162:163], v8 offset:20992
    s_waitcnt lgkmcnt(6)
    v_mfma_f32_32x32x16_bf16 v[144:159], v[180:183], v[48:51], v[144:159]
    s_add_u32 m0, s59, 0
    s_nop 0
    buffer_load_dwordx4 v3, s[20:23], s96 offen lds
    ds_read_b64_tr_b16 v[164:165], v7 offset:4096
    ds_read_b64_tr_b16 v[166:167], v7 offset:4608
    s_waitcnt lgkmcnt(6)
    v_mfma_f32_32x32x16_bf16 v[128:143], v[184:187], v[52:55], v[128:143]
    ds_read_b64_tr_b16 v[168:169], v8 offset:22528
    ds_read_b64_tr_b16 v[170:171], v8 offset:23040
    s_waitcnt lgkmcnt(6)
    v_mfma_f32_32x32x16_bf16 v[144:159], v[188:191], v[52:55], v[144:159]
    ds_read_b64_tr_b16 v[172:173], v7 offset:6144
    ds_read_b64_tr_b16 v[174:175], v7 offset:6656
    s_waitcnt lgkmcnt(6)
    v_mfma_f32_32x32x16_bf16 v[128:143], v[160:163], v[56:59], v[128:143]
    s_waitcnt vmcnt(5)
    s_barrier
    s_mov_b64 exec, 1
    buffer_store_dwordx2 v[222:223], v14, s[24:27], s79 offen sc1
    s_mov_b64 exec, -1
    ds_read_b64_tr_b16 v[176:177], v7 offset:8192
    ds_read_b64_tr_b16 v[178:179], v7 offset:8704
    s_waitcnt lgkmcnt(6)
    v_mfma_f32_32x32x16_bf16 v[144:159], v[164:167], v[56:59], v[144:159]
    ds_read_b64_tr_b16 v[180:181], v8 offset:24576
    ds_read_b64_tr_b16 v[182:183], v8 offset:25088
    s_waitcnt lgkmcnt(6)
    v_mfma_f32_32x32x16_bf16 v[128:143], v[168:171], v[60:63], v[128:143]
    ds_read_b64_tr_b16 v[184:185], v7 offset:10240
    ds_read_b64_tr_b16 v[186:187], v7 offset:10752
    s_waitcnt lgkmcnt(6)
    v_mfma_f32_32x32x16_bf16 v[144:159], v[172:175], v[60:63], v[144:159]
    ds_read_b64_tr_b16 v[188:189], v8 offset:26624
    ds_read_b64_tr_b16 v[190:191], v8 offset:27136
    s_waitcnt lgkmcnt(6)
    v_mfma_f32_32x32x16_bf16 v[128:143], v[176:179], v[64:67], v[128:143]
    ds_read_b64_tr_b16 v[160:161], v7 offset:12288
    ds_read_b64_tr_b16 v[162:163], v7 offset:12800
    s_waitcnt lgkmcnt(6)
    v_mfma_f32_32x32x16_bf16 v[144:159], v[180:183], v[64:67], v[144:159]
    ds_read_b64_tr_b16 v[164:165], v8 offset:28672
    ds_read_b64_tr_b16 v[166:167], v8 offset:29184
    s_waitcnt lgkmcnt(6)
    v_mfma_f32_32x32x16_bf16 v[128:143], v[184:187], v[68:71], v[128:143]
    ds_read_b64_tr_b16 v[168:169], v7 offset:14336
    ds_read_b64_tr_b16 v[170:171], v7 offset:14848
    s_waitcnt lgkmcnt(6)
    v_mfma_f32_32x32x16_bf16 v[144:159], v[188:191], v[68:71], v[144:159]
    ds_read_b64_tr_b16 v[172:173], v8 offset:30720
    ds_read_b64_tr_b16 v[174:175], v8 offset:31232
    s_waitcnt lgkmcnt(6)
    v_mfma_f32_32x32x16_bf16 v[128:143], v[160:163], v[72:75], v[128:143]
    s_waitcnt vmcnt(5)
    s_barrier
    ds_read_b64_tr_b16 v[176:177], v7 offset:16384
    ds_read_b64_tr_b16 v[178:179], v7 offset:16896
    s_waitcnt lgkmcnt(6)
    v_mfma_f32_32x32x16_bf16 v[144:159], v[164:167], v[72:75], v[144:159]
    ds_read_b64_tr_b16 v[180:181], v7 offset:24576
    ds_read_b64_tr_b16 v[182:183], v7 offset:25088
    s_waitcnt lgkmcnt(6)
    v_mfma_f32_32x32x16_bf16 v[128:143], v[168:171], v[76:79], v[128:143]
    ds_read_b64_tr_b16 v[184:185], v7 offset:18432
    ds_read_b64_tr_b16 v[186:187], v7 offset:18944
    s_waitcnt lgkmcnt(6)
    v_mfma_f32_32x32x16_bf16 v[144:159], v[172:175], v[76:79], v[144:159]
    ds_read_b64_tr_b16 v[188:189], v7 offset:26624
    ds_read_b64_tr_b16 v[190:191], v7 offset:27136
    s_waitcnt lgkmcnt(6)
    v_mfma_f32_32x32x16_bf16 v[128:143], v[176:179], v[80:83], v[128:143]
    ds_read_b64_tr_b16 v[160:161], v7 offset:20480
    ds_read_b64_tr_b16 v[162:163], v7 offset:20992
    s_waitcnt lgkmcnt(6)
    v_mfma_f32_32x32x16_bf16 v[144:159], v[180:183], v[80:83], v[144:159]
    ds_read_b64_tr_b16 v[164:165], v7 offset:28672
    ds_read_b64_tr_b16 v[166:167], v7 offset:29184
    s_waitcnt lgkmcnt(6)
    v_mfma_f32_32x32x16_bf16 v[128:143], v[184:187], v[84:87], v[128:143]
    ds_read_b64_tr_b16 v[168:169], v7 offset:22528
    ds_read_b64_tr_b16 v[170:171], v7 offset:23040
    s_waitcnt lgkmcnt(6)
    v_mfma_f32_32x32x16_bf16 v[144:159], v[188:191], v[84:87], v[144:159]
    ds_read_b64_tr_b16 v[172:173], v7 offset:30720
    ds_read_b64_tr_b16 v[174:175], v7 offset:31232
    s_waitcnt lgkmcnt(6)
    v_mfma_f32_32x32x16_bf16 v[128:143], v[160:163], v[88:91], v[128:143]
    s_waitcnt vmcnt(3)
    s_barrier
    s_mov_b32 s60, 15007744
    buffer_load_dwordx2 v[216:217], v242, s[24:27], s60 offen sc1
    buffer_load_dwordx2 v[218:219], v243, s[24:27], s60 offen sc1
    ds_read_b64_tr_b16 v[176:177], v7 offset:49152
    ds_read_b64_tr_b16 v[178:179], v7 offset:49664
    s_waitcnt lgkmcnt(6)
    v_mfma_f32_32x32x16_bf16 v[144:159], v[164:167], v[88:91], v[144:159]
    ds_read_b64_tr_b16 v[180:181], v7 offset:32768
    ds_read_b64_tr_b16 v[182:183], v7 offset:33280
    s_waitcnt lgkmcnt(6)
    v_mfma_f32_32x32x16_bf16 v[128:143], v[168:171], v[92:95], v[128:143]
    ds_read_b64_tr_b16 v[184:185], v7 offset:51200
    ds_read_b64_tr_b16 v[186:187], v7 offset:51712
    s_waitcnt lgkmcnt(6)
    v_mfma_f32_32x32x16_bf16 v[144:159], v[172:175], v[92:95], v[144:159]
    ds_read_b64_tr_b16 v[188:189], v7 offset:34816
    ds_read_b64_tr_b16 v[190:191], v7 offset:35328
    s_waitcnt lgkmcnt(6)
    v_mfma_f32_32x32x16_bf16 v[128:143], v[176:179], v[96:99], v[128:143]
    ds_read_b64_tr_b16 v[160:161], v7 offset:53248
    ds_read_b64_tr_b16 v[162:163], v7 offset:53760
    s_waitcnt lgkmcnt(6)
    v_mfma_f32_32x32x16_bf16 v[144:159], v[180:183], v[96:99], v[144:159]
    ds_read_b64_tr_b16 v[164:165], v7 offset:36864
    ds_read_b64_tr_b16 v[166:167], v7 offset:37376
    s_waitcnt lgkmcnt(6)
    v_mfma_f32_32x32x16_bf16 v[128:143], v[184:187], v[100:103], v[128:143]
    ds_read_b64_tr_b16 v[168:169], v7 offset:55296
    ds_read_b64_tr_b16 v[170:171], v7 offset:55808
    s_waitcnt lgkmcnt(6)
    v_mfma_f32_32x32x16_bf16 v[144:159], v[188:191], v[100:103], v[144:159]
    ds_read_b64_tr_b16 v[172:173], v7 offset:38912
    ds_read_b64_tr_b16 v[174:175], v7 offset:39424
    s_waitcnt lgkmcnt(6)
    v_mfma_f32_32x32x16_bf16 v[128:143], v[160:163], v[104:107], v[128:143]
    s_waitcnt vmcnt(3)
    s_barrier
    s_mov_b32 s3, 159744
    v_mov_b32 v204, s3
    ds_write_b32 v204, v14
    ds_write_b32 v204, v14 offset:4
    ds_read_b64_tr_b16 v[176:177], v7 offset:40960
    ds_read_b64_tr_b16 v[178:179], v7 offset:41472
    s_waitcnt lgkmcnt(8)
    v_mfma_f32_32x32x16_bf16 v[144:159], v[164:167], v[104:107], v[144:159]
    ds_read_b64_tr_b16 v[180:181], v6 offset:0
    ds_read_b64_tr_b16 v[182:183], v6 offset:512
    s_waitcnt lgkmcnt(8)
    v_mfma_f32_32x32x16_bf16 v[128:143], v[168:171], v[108:111], v[128:143]
    ds_read_b64_tr_b16 v[184:185], v7 offset:43008
    ds_read_b64_tr_b16 v[186:187], v7 offset:43520
    s_waitcnt lgkmcnt(8)
    v_mfma_f32_32x32x16_bf16 v[144:159], v[172:175], v[108:111], v[144:159]
    ds_read_b64_tr_b16 v[188:189], v6 offset:2048
    ds_read_b64_tr_b16 v[190:191], v6 offset:2560
    s_waitcnt lgkmcnt(6)
    v_mfma_f32_32x32x16_bf16 v[128:143], v[176:179], v[112:115], v[128:143]
    ds_read_b64_tr_b16 v[160:161], v7 offset:45056
    ds_read_b64_tr_b16 v[162:163], v7 offset:45568
    s_waitcnt lgkmcnt(6)
    v_mfma_f32_32x32x16_bf16 v[144:159], v[180:183], v[112:115], v[144:159]
    ds_read_b64_tr_b16 v[164:165], v6 offset:4096
    ds_read_b64_tr_b16 v[166:167], v6 offset:4608
    s_waitcnt lgkmcnt(6)
    v_mfma_f32_32x32x16_bf16 v[128:143], v[184:187], v[116:119], v[128:143]
    ds_read_b64_tr_b16 v[168:169], v7 offset:47104
    ds_read_b64_tr_b16 v[170:171], v7 offset:47616
    s_waitcnt lgkmcnt(6)
    v_mfma_f32_32x32x16_bf16 v[144:159], v[188:191], v[116:119], v[144:159]
    ds_read_b64_tr_b16 v[172:173], v6 offset:6144
    ds_read_b64_tr_b16 v[174:175], v6 offset:6656
    s_mov_b32 s91, 0
    s_cmp_ge_u32 s58, 4
    s_cbranch_scc1 L_eh92
    s_waitcnt vmcnt(0)
    v_cmp_ne_u32 vcc, s76, v216
    v_cmp_ne_u32 s[4:5], s77, v217
    s_nop 0
    s_or_b64 vcc, vcc, s[4:5]
    s_cbranch_vccnz L_eh92
    v_cmp_ne_u32 vcc, s76, v218
    v_cmp_ne_u32 s[4:5], s77, v219
    s_nop 0
    s_or_b64 vcc, vcc, s[4:5]
    s_cbranch_vccnz L_eh92
    buffer_load_dwordx4 v[48:51], v240, s[44:47], s84 offen sc1
    buffer_load_dwordx4 v[52:55], v248, s[44:47], s84 offen sc1
    buffer_load_dwordx4 v[56:59], v241, s[44:47], s86 offen sc1
    buffer_load_dwordx4 v[60:63], v249, s[44:47], s86 offen sc1
    s_add_u32 s84, s84, 512
    s_and_b32 s84, s84, 8191
    s_mul_i32 s86, s84, 57
    s_lshl_b32 s4, s89, 15
    s_lshl_b32 s5, s83, 11
    s_add_u32 s4, s4, s5
    s_add_u32 s5, s58, 1
    s_and_b32 s5, s5, 3
    s_lshl_b32 s5, s5, 9
    s_add_u32 s5, s5, s4
    s_add_u32 s6, s5, 65536
    buffer_load_dwordx4 v[16:19], v250, s[24:27], s5 offen sc1
    buffer_load_dwordx4 v[20:23], v250, s[24:27], s6 offen sc1
    s_add_u32 s5, s58, 2
    s_and_b32 s5, s5, 3
    s_lshl_b32 s5, s5, 9
    s_add_u32 s5, s5, s4
    s_add_u32 s6, s5, 65536
    buffer_load_dwordx4 v[24:27], v250, s[24:27], s5 offen sc1
    buffer_load_dwordx4 v[28:31], v250, s[24:27], s6 offen sc1
    s_add_u32 s5, s58, 3
    s_and_b32 s5, s5, 3
    s_lshl_b32 s5, s5, 9
    s_add_u32 s5, s5, s4
    s_add_u32 s6, s5, 65536
    buffer_load_dwordx4 v[32:35], v250, s[24:27], s5 offen sc1
    buffer_load_dwordx4 v[36:39], v250, s[24:27], s6 offen sc1
    s_add_u32 s5, s58, 4
    s_and_b32 s5, s5, 3
    s_lshl_b32 s5, s5, 9
    s_add_u32 s5, s5, s4
    s_add_u32 s6, s5, 65536
    buffer_load_dwordx4 v[40:43], v250, s[24:27], s5 offen sc1
    buffer_load_dwordx4 v[44:47], v250, s[24:27], s6 offen sc1
    s_lshl_b32 s4, s83, 2
    s_add_u32 s4, s4, s58
    s_lshl_b32 s4, s4, 7
    s_add_u32 s4, s4, 14942208
    v_and_b32 v246, 31, v1
    v_lshlrev_b32 v246, 2, v246
    buffer_load_dword v246, v246, s[24:27], s4 offen sc1
    s_mov_b32 s91, 1
L_eh92:
    s_waitcnt lgkmcnt(6)
    v_mfma_f32_32x32x16_bf16 v[128:143], v[160:163], v[120:123], v[128:143]
    s_waitcnt lgkmcnt(4)
    v_mfma_f32_32x32x16_bf16 v[144:159], v[164:167], v[120:123], v[144:159]
    s_waitcnt lgkmcnt(2)
    v_mfma_f32_32x32x16_bf16 v[128:143], v[168:171], v[124:127], v[128:143]
    s_waitcnt lgkmcnt(0)
    v_mfma_f32_32x32x16_bf16 v[144:159], v[172:175], v[124:127], v[144:159]
    s_branch L_tail
L_exit:
    s_endpgm
L_code_end:
.section .rodata,"a"
.p2align 6
.amdhsa_kernel gated_mix__mha_block__glu_gated_reglu__prompt_kernel
  .amdhsa_next_free_vgpr 256
  .amdhsa_next_free_sgpr 102
  .amdhsa_accum_offset 256
  .amdhsa_group_segment_fixed_size 0
  .amdhsa_kernarg_size 88
  .amdhsa_user_sgpr_count 2
  .amdhsa_user_sgpr_kernarg_segment_ptr 1
  .amdhsa_system_sgpr_workgroup_id_x 1
.end_amdhsa_kernel
```
